```python
import torch

def _softmax(x, axis=-1):
    return torch.softmax(x, dim=axis)
def _gelu(x):
    return torch.nn.functional.gelu(x, approximate="tanh")
def _silu(x):
    return torch.nn.functional.silu(x)
def _sigmoid(x):
    return torch.sigmoid(x)
def _layernorm(x, axis=-1, eps=1e-5):
    m = x.mean(dim=axis, keepdim=True)
    v = x.var(dim=axis, keepdim=True, unbiased=False)
    return (x - m) / torch.sqrt(v + eps)
def _scatter_add(tgt, idx, src, axis=0):
    return tgt.clone().index_add_(axis, idx, src)
def _segment_sum(src, seg, n):
    out = torch.zeros((n,) + src.shape[1:], dtype=src.dtype)
    return out.index_add_(0, seg, src)
def _pad(x, pw):
    flat = tuple(v for pair in reversed(pw) for v in pair)
    return torch.nn.functional.pad(x, flat)

kernel_name = 'gated_mix__spectral_fnet__geglu_ffn__prompt'

def setup_inputs():

    _w = (lambda a: (lambda t: t.to(torch.bfloat16) if t.is_floating_point() else t)(torch.as_tensor(a)))
    def _A_setup():
        B, S, D = 1, 2048, 512
        ns = torch.arange(S)[:, None] * torch.arange(S)[None, :]
        nd = torch.arange(D)[:, None] * torch.arange(D)[None, :]
        Ws_re = torch.cos(-2.0 * torch.pi * ns / S).to(float)
        Ws_im = torch.sin(-2.0 * torch.pi * ns / S).to(float)
        Wd_re = torch.cos(-2.0 * torch.pi * nd / D).to(float)
        Wd_im = torch.sin(-2.0 * torch.pi * nd / D).to(float)
        return {
            "x": _w((lambda *s: torch.randn(*s, dtype=torch.bfloat16) * 0.05)(B, S, D)),
            "dft_seq_re": _w(Ws_re),
            "dft_seq_im": _w(Ws_im),
            "dft_hid_re": _w(Wd_re),
            "dft_hid_im": _w(Wd_im),
        }
    _A_in = _A_setup()

    def _B_setup():
        B, S, D, F = 1, 2048, 512, 1376
        return {
            "x": _w((lambda *s: torch.randn(*s, dtype=torch.bfloat16) * 0.05)(B, S, D)),
            "w_gate": _w((lambda *s: torch.randn(*s, dtype=torch.bfloat16) * 0.8)(D, F)),
            "w_up": _w((lambda *s: torch.randn(*s, dtype=torch.bfloat16) * 0.8)(D, F)),
            "w_down": _w((lambda *s: torch.randn(*s, dtype=torch.bfloat16) * 0.8)(F, D)),
        }
    _B_in = _B_setup()

    return {
        "A_x": _A_in["x"],
        "A_dft_seq_re": _A_in["dft_seq_re"],
        "A_dft_seq_im": _A_in["dft_seq_im"],
        "A_dft_hid_re": _A_in["dft_hid_re"],
        "A_dft_hid_im": _A_in["dft_hid_im"],
        "B_x": _B_in["x"],
        "B_w_gate": _B_in["w_gate"],
        "B_w_up": _B_in["w_up"],
        "B_w_down": _B_in["w_down"],
        "gate_w": _w((lambda *s: torch.randn(*s, dtype=torch.bfloat16) * 0.05)(512) * 16.0),
    }

def reference(A_x, A_dft_seq_re, A_dft_seq_im, A_dft_hid_re, A_dft_hid_im, B_x, B_w_gate, B_w_up, B_w_down, gate_w):
    def _A_ref(x, dft_seq_re, dft_seq_im, dft_hid_re, dft_hid_im):
        a = torch.einsum("bsd,ed->bse", x, dft_hid_re)
        b = torch.einsum("bsd,ed->bse", x, dft_hid_im)
        y = torch.einsum("ts,bse->bte", dft_seq_re, a) - torch.einsum("ts,bse->bte", dft_seq_im, b)
        return y

    def _B_ref(x, w_gate, w_up, w_down):
        return (_gelu(x @ w_gate) * (x @ w_up)) @ w_down

    x = A_x
    g = _sigmoid((x * gate_w).sum(-1, keepdims=True))
    a = _A_ref(x, A_dft_seq_re, A_dft_seq_im, A_dft_hid_re, A_dft_hid_im)
    b = _B_ref(x, B_w_gate, B_w_up, B_w_down)
    return g * a + (1 - g) * b
```

```asm
; @launch grid=(256,1,1) block=(512,1,1) lds=163840
.amdgcn_target "amdgcn-amd-amdhsa--gfx950"
.text
.globl gated_mix__spectral_fnet__geglu_ffn__prompt_kernel
.p2align 8
.type gated_mix__spectral_fnet__geglu_ffn__prompt_kernel,@function
gated_mix__spectral_fnet__geglu_ffn__prompt_kernel:
    s_load_dwordx2 s[24:25], s[0:1], 0
    s_load_dwordx16 s[4:19], s[0:1], 24
    s_load_dwordx4 s[76:79], s[0:1], 88
    v_lshrrev_b32 v2, 6, v0
    v_and_b32 v1, 63, v0
    v_readfirstlane_b32 s20, v2
    s_cmp_ge_u32 s2, 256
    s_cbranch_scc1 L_exit
    s_bfe_u32 s55, s2, 0x30003
    s_bfe_u32 s42, s2, 0x20001
    s_lshr_b32 s44, s2, 6
    s_and_b32 s43, s55, 1
    s_lshl1_add_u32 s43, s42, s43
    s_cmp_eq_u32 s44, 3
    s_cselect_b32 s21, s43, s55
    s_mul_i32 s40, s42, 2
    s_mul_i32 s43, s55, 3
    s_cselect_b32 s43, s43, s40
    s_addc_u32 s49, s43, s21
    s_and_b32 s49, s49, 7
    s_and_b32 s43, s2, 1
    s_lshl3_add_u32 s21, s43, s21
    s_and_b32 s45, s20, 3
    s_and_b32 s40, s45, 1
    s_lshr_b32 s41, s45, 1
    s_lshl1_add_u32 s23, s21, s40
    s_lshl_b32 s43, s41, 5
    s_add_u32 s23, s23, s43
    s_lshl_b32 s48, s45, 12
    s_bitset1_b32 s48, 15
    s_cmp_ge_u32 s20, 4
    s_cbranch_scc1 L1_compw
    v_lshrrev_b32 v16, 3, v1
    s_lshl_b32 s43, s23, 10
    v_lshl_add_u32 v16, v16, 16, s43
    v_lshrrev_b32 v17, 4, v1
    v_and_b32 v18, 7, v1
    v_xor_b32 v18, v17, v18
    v_lshl_add_u32 v10, v18, 4, v16
    v_xor_b32 v11, 0x80040, v10
    v_xor_b32 v12, 0x100000, v10
    v_xor_b32 v13, 0x180040, v10
    s_mov_b32 s26, 0x200000
    s_mov_b32 s27, 0x20000
    s_lshl_b32 s47, s49, 7
    s_mov_b32 m0, s48
    s_cmp_ge_u32 s2, 224
    s_cbranch_scc1 L_epf
    s_waitcnt lgkmcnt(0)
    buffer_load_dwordx4 v10, s[24:27], s47 offen  lds
    s_add_u32 m0, m0, 1024
    s_nop 0
    buffer_load_dwordx4 v11, s[24:27], s47 offen  lds
    s_add_u32 m0, m0, 1024
    s_nop 0
    buffer_load_dwordx4 v12, s[24:27], s47 offen  lds
    s_add_u32 m0, m0, 1024
    s_nop 0
    buffer_load_dwordx4 v13, s[24:27], s47 offen  lds
L_nox:
    s_cmp_eq_u32 s44, 3
    s_cbranch_scc1 L_dl_3
    s_mul_i32 s22, s42, 3
    s_min_u32 s22, s22, 8
    s_add_u32 s22, s22, s44
    s_and_b32 s46, s42, s44
    s_lshr_b32 s46, s46, 1
    s_cbranch_scc0 L_dl_d
    s_and_b32 s22, s42, 1
    s_branch L_dl_d
L_dl_3:
    s_cmp_lt_u32 s55, 2
    s_cselect_b32 s22, 10, 2
    s_lshr_b32 s46, s55, 1
    s_add_u32 s46, s46, 2
    s_min_u32 s46, s46, 4
L_dl_d:
    s_cmp_eq_u32 s46, 0
    s_cselect_b32 s43, 15, 11
    s_cmp_eq_u32 s46, 3
    s_cselect_b32 s43, 7, s43
    s_cselect_b32 s80, 0, -1
    s_bitcmp1_b32 s46, 0
    s_cselect_b64 s[10:11], s[4:5], s[10:11]
    s_cselect_b64 s[12:13], s[6:7], s[12:13]
    s_movk_i32 s47, 2752
    s_cselect_b32 s47, 1024, s47
    s_movk_i32 s82, 256
    s_cselect_b32 s82, 192, s82
    s_cmp_eq_u32 s41, 1
    s_cselect_b64 s[28:29], s[12:13], s[10:11]
    v_lshl_add_u32 v16, s40, 2, v17
    s_mul_i32 s82, s22, s82
    v_mul_u32_u24 v16, s47, v16
    v_and_b32 v18, 15, v1
    v_add_u32 v16, s82, v16
    v_lshlrev_b32 v17, 1, v17
    v_xor_b32 v17, v17, v18
    v_xor_b32 v18, 8, v17
    v_min_u32 v17, s43, v17
    v_min_u32 v18, s43, v18
    v_lshl_add_u32 v2, v17, 4, v16
    v_lshl_add_u32 v3, v18, 4, v16
    s_lshl_b32 s41, s41, 14
    s_lshl_b32 s40, s40, 10
    s_add_u32 s41, s41, s40
    s_lshl_b32 s44, s47, 3
    s_lshl_b32 s30, s47, 9
    s_mov_b32 s31, 0x20000
    s_mov_b32 s66, 0
    s_mov_b32 s67, 0
    s_mul_i32 s40, s49, s44
    s_cmp_lg_u32 s46, 4
    s_cbranch_scc1 L1L_w
    s_branch L_idl2
L_epf:
    s_getpc_b64 s[72:73]
L_pcref0:
    s_sub_u32 s72, s72, L_pcref0-gated_mix__spectral_fnet__geglu_ffn__prompt_kernel
    s_subb_u32 s73, s73, 0
    s_lshl2_add_u32 s43, s55, s45
    s_and_b32 s43, s43, 7
    s_mul_i32 s43, s43, 6400
    v_lshl_add_u32 v36, v1, 7, s43
    v_min_u32 v36, L_exit-gated_mix__spectral_fnet__geglu_ffn__prompt_kernel, v36
    v_mov_b32 v37, s73
    v_add_co_u32 v36, vcc, s72, v36
    s_nop 1
    v_addc_co_u32 v37, vcc, 0, v37, vcc
    global_load_dword v250, v[36:37], off
    s_lshl2_add_u32 s43, s55, s45
    s_bfe_u32 s72, s43, 0x30001
    s_and_b32 s43, s43, 1
    s_and_b32 s73, s2, 1
    s_lshl3_add_u32 s73, s73, s72
    s_lshl4_add_u32 s73, s43, s73
    s_lshl_b32 s73, s73, 11
    s_lshl1_add_u32 s72, s42, s72
    v_and_b32 v38, 31, v1
    v_lshlrev_b32 v38, 16, v38
    v_lshrrev_b32 v39, 5, v1
    v_lshl_add_u32 v38, v39, 10, v38
    s_waitcnt lgkmcnt(0)
    s_add_u32 s72, s72, 1
    s_and_b32 s72, s72, 7
    s_lshl_b32 s74, s72, 7
    s_add_u32 s74, s74, s73
    buffer_load_dword v249, v38, s[24:27], s74 offen
    s_waitcnt lgkmcnt(0)
    s_branch L_nox
L_idl2:
    v_mov_b32 v14, 0
    v_mov_b32 v15, 0
    s_mov_b32 s68, s76
    s_mov_b32 s69, s77
    s_mov_b32 s70, 0x100
    s_mov_b32 s71, 0x20000
    s_lshr_b32 s52, s2, 6
    s_mov_b32 s51, s55
    s_lshl1_add_u32 s56, s52, s51
    s_and_b32 s54, s2, 7
    s_and_b32 s53, s52, 1
    s_lshl1_add_u32 s54, s54, s53
    s_add_u32 s54, s54, 1
    s_sub_u32 s53, 32, s54
    s_cmp_eq_u32 s53, 16
    s_cselect_b32 s53, 0, s53
    s_cmp_ge_u32 s52, 2
    s_cselect_b32 s54, s53, s54
    s_cmp_eq_u32 s46, 4
    s_cselect_b32 s83, 1, 0
    s_add_u32 s56, s56, s2
    s_and_b32 s56, s56, 7
    s_mul_i32 s56, s56, 5
    s_lshr_b32 s56, s56, 2
    v_bfe_u32 v16, v1, 4, 1
    v_lshlrev_b32 v16, 2, v16
    v_and_b32 v17, 7, v1
    v_xor_b32 v16, v16, v17
    v_lshrrev_b32 v17, 3, v1
    v_lshlrev_b32 v17, 10, v17
    v_lshl_add_u32 v28, v16, 4, v17
    s_lshl_b32 s42, s51, 7
    s_lshl_b32 s43, s45, 14
    s_add_u32 s42, s42, s43
    v_add_u32 v28, s42, v28
    v_add_u32 v29, 0x2000, v28
    s_lshl_b32 s59, s45, 11
    s_cmp_lt_u32 s45, 2
    s_cselect_b32 s57, 11, 10
    v_lshrrev_b32 v18, 5, v1
    v_bfe_u32 v16, v1, 2, 2
    v_lshl_add_u32 v16, v18, 3, v16
    v_lshlrev_b32 v16, 7, v16
    v_bfe_u32 v17, v1, 1, 1
    v_lshl_add_u32 v16, v17, 3, v16
    v_and_b32 v17, 1, v1
    v_lshl_add_u32 v16, v17, 5, v16
    v_bfe_u32 v17, v1, 4, 1
    v_lshl_add_u32 v16, v17, 4, v16
    v_bfe_u32 v17, v1, 3, 1
    v_lshl_add_u32 v16, v17, 6, v16
    v_add_u32 v22, s59, v16
    v_xor_b32 v23, 64, v22
    v_add_u32 v24, 65536, v22
    v_add_u32 v25, 65536, v23
    v_add_u32 v26, 131072, v22
    v_add_u32 v27, 131072, v23
    v_lshlrev_b32 v16, 4, v1
    s_mul_i32 s42, s54, 89088
    s_lshl_b32 s43, s45, 10
    s_add_u32 s42, s42, s43
    v_add_u32 v4, s42, v16
    v_add_u32 v5, 2850816, v4
    s_mov_b32 s32, s78
    s_mov_b32 s33, s79
    s_mov_b32 s34, 0x570000
    s_mov_b32 s35, 0x20000
    v_cmp_gt_u32 vcc, 11, v1
    v_subrev_u32 v16, 11, v1
    v_mov_b32 v17, s57
    v_cndmask_b32 v16, v16, v1, vcc
    v_cndmask_b32 v17, v17, 11, vcc
    v_cndmask_b32 v6, 2, 2, vcc
    v_add_u32 v16, s56, v16
    v_sub_u32 v17, v16, v17
    v_min_u32 v16, v16, v17
    v_min_u32 v16, 10, v16
    v_lshlrev_b32 v16, 2, v16
    v_add_u32 v7, 160000, v16
    s_add_u32 s36, s78, 0x800000
    s_addc_u32 s37, s79, 0
    s_mov_b32 s38, 0x8000
    s_mov_b32 s39, 0x20000
    s_mul_i32 s62, s54, 8
    s_and_b32 s43, s51, 1
    s_add_u32 s62, s62, s43
    s_lshl_b32 s62, s62, 7
    v_lshlrev_b32 v8, 4, v1
    s_or_b32 s61, s45, s83
    s_mov_b32 s60, 0
    s_barrier
    s_branch L2W
L1L_loop:
    s_lshl_b32 s47, s49, 7
    s_add_u32 m0, s48, s67
    s_mul_i32 s40, s49, s44
    buffer_load_dwordx4 v10, s[24:27], s47 offen  lds
    s_add_u32 m0, m0, 1024
    s_nop 0
    s_cmp_lg_u32 s66, 1
    s_cbranch_scc1 L1L_nosp
    s_waitcnt vmcnt(5)
    s_barrier
L1L_nosp:
    buffer_load_dwordx4 v11, s[24:27], s47 offen  lds
    s_add_u32 m0, m0, 1024
    s_nop 0
    buffer_load_dwordx4 v12, s[24:27], s47 offen  lds
    s_add_u32 m0, m0, 1024
    s_nop 0
    buffer_load_dwordx4 v13, s[24:27], s47 offen  lds
L1L_w:
    s_add_u32 m0, s41, s67
    s_lshl_b32 s40, s40, 3
    buffer_load_dwordx4 v2, s[28:31], s40 offen lds
    s_add_u32 m0, m0, 2048
    s_add_u32 s40, s40, s44
    buffer_load_dwordx4 v3, s[28:31], s40 offen lds
    s_add_u32 m0, m0, 2048
    s_add_u32 s40, s40, s44
    buffer_load_dwordx4 v2, s[28:31], s40 offen lds
    s_add_u32 m0, m0, 2048
    s_add_u32 s40, s40, s44
    buffer_load_dwordx4 v3, s[28:31], s40 offen lds
    s_add_u32 m0, m0, 2048
    s_add_u32 s40, s40, s44
    s_cmp_eq_u32 s66, 0
    s_cbranch_scc1 L1L_nobar
    s_waitcnt vmcnt(8)
    s_barrier
L1L_nobar:
    buffer_load_dwordx4 v2, s[28:31], s40 offen lds
    s_add_u32 m0, m0, 2048
    s_add_u32 s40, s40, s44
    buffer_load_dwordx4 v3, s[28:31], s40 offen lds
    s_add_u32 m0, m0, 2048
    s_add_u32 s40, s40, s44
    buffer_load_dwordx4 v2, s[28:31], s40 offen lds
    s_add_u32 m0, m0, 2048
    s_add_u32 s40, s40, s44
    buffer_load_dwordx4 v3, s[28:31], s40 offen lds
    s_cmp_lg_u32 s66, 0
    s_cbranch_scc1 L1L_next
    v_mov_b32 v14, 0
    v_mov_b32 v15, 0
    s_mov_b32 s68, s76
    s_mov_b32 s69, s77
    s_mov_b32 s70, 0x100
    s_mov_b32 s71, 0x20000
    s_cmp_eq_u32 s66, s80
    s_cbranch_scc0 L1L_next
    s_mov_b32 s36, s16
    s_mov_b32 s37, s17
    s_mov_b32 s38, 0x400
    s_mov_b32 s39, 0x20000
    s_mov_b32 m0, 160256
    v_lshlrev_b32 v16, 4, v1
    buffer_load_dwordx4 v16, s[36:39], 0 offen lds
    s_add_u32 s36, s4, 0x40000
    s_addc_u32 s37, s5, 0
    s_mov_b32 s38, 0x400
    s_mov_b32 s39, 0x20000
    s_mov_b32 m0, 161280
    s_nop 0
    buffer_load_dwordx4 v16, s[36:39], 0 offen lds
L1L_next:
    s_cmp_lg_u32 s66, 0
    s_cbranch_scc1 L1L_next3
    s_lshr_b32 s52, s2, 6
    s_mov_b32 s51, s55
    s_lshl1_add_u32 s56, s52, s51
    s_and_b32 s54, s2, 7
    s_and_b32 s53, s52, 1
    s_lshl1_add_u32 s54, s54, s53
    s_add_u32 s54, s54, 1
    s_sub_u32 s53, 32, s54
    s_cmp_eq_u32 s53, 16
    s_cselect_b32 s53, 0, s53
    s_cmp_ge_u32 s52, 2
    s_cselect_b32 s54, s53, s54
    s_cmp_eq_u32 s46, 4
    s_cselect_b32 s83, 1, 0
    s_add_u32 s56, s56, s2
    s_and_b32 s56, s56, 7
    s_mul_i32 s56, s56, 5
    s_lshr_b32 s56, s56, 2
    v_bfe_u32 v16, v1, 4, 1
    v_lshlrev_b32 v16, 2, v16
    v_and_b32 v17, 7, v1
    v_xor_b32 v16, v16, v17
    v_lshrrev_b32 v17, 3, v1
    v_lshlrev_b32 v17, 10, v17
    v_lshl_add_u32 v28, v16, 4, v17
    s_lshl_b32 s42, s51, 7
    s_lshl_b32 s43, s45, 14
    s_add_u32 s42, s42, s43
    v_add_u32 v28, s42, v28
    v_add_u32 v29, 0x2000, v28
    s_lshl_b32 s59, s45, 11
    s_cmp_lt_u32 s45, 2
    s_cselect_b32 s57, 11, 10
    v_lshrrev_b32 v18, 5, v1
    v_bfe_u32 v16, v1, 2, 2
    v_lshl_add_u32 v16, v18, 3, v16
    v_lshlrev_b32 v16, 7, v16
    v_bfe_u32 v17, v1, 1, 1
    v_lshl_add_u32 v16, v17, 3, v16
    v_and_b32 v17, 1, v1
    v_lshl_add_u32 v16, v17, 5, v16
    v_bfe_u32 v17, v1, 4, 1
    v_lshl_add_u32 v16, v17, 4, v16
    v_bfe_u32 v17, v1, 3, 1
    v_lshl_add_u32 v16, v17, 6, v16
    v_add_u32 v22, s59, v16
    v_xor_b32 v23, 64, v22
    v_add_u32 v24, 65536, v22
    v_add_u32 v25, 65536, v23
    v_add_u32 v26, 131072, v22
    v_add_u32 v27, 131072, v23
    v_lshlrev_b32 v16, 4, v1
    s_mul_i32 s42, s54, 89088
    s_lshl_b32 s43, s45, 10
    s_add_u32 s42, s42, s43
    v_add_u32 v4, s42, v16
    v_add_u32 v5, 2850816, v4
    s_mov_b32 s32, s78
    s_mov_b32 s33, s79
    s_mov_b32 s34, 0x570000
    s_mov_b32 s35, 0x20000
    v_cmp_gt_u32 vcc, 11, v1
    v_subrev_u32 v16, 11, v1
    v_mov_b32 v17, s57
    v_cndmask_b32 v16, v16, v1, vcc
    v_cndmask_b32 v17, v17, 11, vcc
    v_cndmask_b32 v6, 2, 2, vcc
    v_add_u32 v16, s56, v16
    v_sub_u32 v17, v16, v17
    v_min_u32 v16, v16, v17
    v_min_u32 v16, 10, v16
    v_lshlrev_b32 v16, 2, v16
    v_add_u32 v7, 160000, v16
    s_add_u32 s36, s78, 0x800000
    s_addc_u32 s37, s79, 0
    s_mov_b32 s38, 0x8000
    s_mov_b32 s39, 0x20000
    s_mul_i32 s62, s54, 8
    s_and_b32 s43, s51, 1
    s_add_u32 s62, s62, s43
    s_lshl_b32 s62, s62, 7
    v_lshlrev_b32 v8, 4, v1
    s_or_b32 s61, s45, s83
    s_mov_b32 s60, 0
L1L_next3:
    s_add_u32 s49, s49, 1
    s_and_b32 s49, s49, 7
    s_add_u32 s67, s67, 49152
    s_cmp_eq_u32 s67, 147456
    s_cselect_b32 s67, 0, s67
    s_add_u32 s66, s66, 1
    s_cmp_lt_u32 s66, 8
    s_cbranch_scc1 L1L_loop
L2W:
    s_mov_b32 s28, s14
    s_mov_b32 s29, s15
    s_mov_b32 s30, 0x158000
    s_mov_b32 s31, 0x20000
    s_add_u32 m0, s59, 147456
    s_add_u32 s40, s56, 0
    s_sub_u32 s43, s40, 11
    s_cselect_b32 s40, s40, s43
    s_lshl_b32 s40, s40, 17
    buffer_load_dwordx4 v28, s[28:31], s40 offen lds
    s_add_u32 m0, m0, 1024
    s_nop 0
    buffer_load_dwordx4 v29, s[28:31], s40 offen lds
    s_add_u32 m0, s59, 98304
    s_add_u32 s40, s56, 2
    s_sub_u32 s43, s40, 11
    s_cselect_b32 s40, s40, s43
    s_lshl_b32 s40, s40, 17
    buffer_load_dwordx4 v28, s[28:31], s40 offen lds
    s_add_u32 m0, m0, 1024
    s_nop 0
    buffer_load_dwordx4 v29, s[28:31], s40 offen lds
    s_add_u32 m0, s59, 106496
    s_add_u32 s40, s56, 3
    s_sub_u32 s43, s40, 11
    s_cselect_b32 s40, s40, s43
    s_lshl_b32 s40, s40, 17
    buffer_load_dwordx4 v28, s[28:31], s40 offen lds
    s_add_u32 m0, m0, 1024
    s_nop 0
    buffer_load_dwordx4 v29, s[28:31], s40 offen lds
    s_add_u32 m0, s59, 114688
    s_add_u32 s40, s56, 4
    s_sub_u32 s43, s40, 11
    s_cselect_b32 s40, s40, s43
    s_lshl_b32 s40, s40, 17
    buffer_load_dwordx4 v28, s[28:31], s40 offen lds
    s_add_u32 m0, m0, 1024
    s_nop 0
    buffer_load_dwordx4 v29, s[28:31], s40 offen lds
    s_add_u32 m0, s59, 122880
    s_add_u32 s40, s56, 5
    s_sub_u32 s43, s40, 11
    s_cselect_b32 s40, s40, s43
    s_lshl_b32 s40, s40, 17
    buffer_load_dwordx4 v28, s[28:31], s40 offen lds
    s_add_u32 m0, m0, 1024
    s_nop 0
    buffer_load_dwordx4 v29, s[28:31], s40 offen lds
    s_add_u32 m0, s59, 131072
    s_add_u32 s40, s56, 6
    s_sub_u32 s43, s40, 11
    s_cselect_b32 s40, s40, s43
    s_lshl_b32 s40, s40, 17
    buffer_load_dwordx4 v28, s[28:31], s40 offen lds
    s_add_u32 m0, m0, 1024
    s_nop 0
    buffer_load_dwordx4 v29, s[28:31], s40 offen lds
    s_waitcnt vmcnt(12)
    s_cmp_lg_u32 s83, 0
    s_cbranch_scc1 L2W_nob6
    s_barrier
    s_cmp_lg_u32 s45, 0
    s_cbranch_scc1 L2W_nob6
    buffer_load_dword v14, v15, s[68:71], 0 offen sc1
L2W_nob6:
    s_waitcnt vmcnt(10)
    ds_read_b64_tr_b16 v[32:33], v26 offset:16384
    ds_read_b64_tr_b16 v[34:35], v26 offset:16896
    ds_read_b64_tr_b16 v[36:37], v27 offset:16384
    ds_read_b64_tr_b16 v[38:39], v27 offset:16896
    s_waitcnt lgkmcnt(0)
    s_add_u32 m0, s59, 147456
    s_add_u32 s40, s56, 1
    s_sub_u32 s43, s40, 11
    s_cselect_b32 s40, s40, s43
    s_lshl_b32 s40, s40, 17
    buffer_load_dwordx4 v28, s[28:31], s40 offen lds
    s_add_u32 m0, m0, 1024
    s_nop 0
    buffer_load_dwordx4 v29, s[28:31], s40 offen lds
    s_add_u32 m0, s59, 139264
    s_add_u32 s40, s56, 7
    s_sub_u32 s43, s40, 11
    s_cselect_b32 s40, s40, s43
    s_lshl_b32 s40, s40, 17
    buffer_load_dwordx4 v28, s[28:31], s40 offen lds
    s_add_u32 m0, m0, 1024
    s_nop 0
    buffer_load_dwordx4 v29, s[28:31], s40 offen lds
    s_bitcmp1_b32 s46, 0
    s_cbranch_scc0 L2W_c
    s_barrier
L2W_c:
    s_add_u32 m0, s59, 0
    s_add_u32 s40, s56, 9
    s_sub_u32 s43, s40, 11
    s_cselect_b32 s40, s40, s43
    s_lshl_b32 s40, s40, 17
    buffer_load_dwordx4 v28, s[28:31], s40 offen lds
    s_add_u32 m0, m0, 1024
    s_nop 0
    buffer_load_dwordx4 v29, s[28:31], s40 offen lds
    s_add_u32 m0, s59, 8192
    s_add_u32 s40, s56, 10
    s_sub_u32 s43, s40, 11
    s_cselect_b32 s40, s40, s43
    s_lshl_b32 s40, s40, 17
    buffer_load_dwordx4 v28, s[28:31], s40 offen lds
    s_add_u32 m0, m0, 1024
    s_nop 0
    buffer_load_dwordx4 v29, s[28:31], s40 offen lds
    s_add_u32 m0, s59, 16384
    s_add_u32 s40, s56, 1
    s_sub_u32 s43, s40, s57
    s_cselect_b32 s40, s40, s43
    s_lshl_b32 s40, s40, 17
    s_add_u32 s40, s40, 65536
    buffer_load_dwordx4 v28, s[28:31], s40 offen lds
    s_add_u32 m0, m0, 1024
    s_nop 0
    buffer_load_dwordx4 v29, s[28:31], s40 offen lds
    s_add_u32 m0, s59, 24576
    s_add_u32 s40, s56, 2
    s_sub_u32 s43, s40, s57
    s_cselect_b32 s40, s40, s43
    s_lshl_b32 s40, s40, 17
    s_add_u32 s40, s40, 65536
    buffer_load_dwordx4 v28, s[28:31], s40 offen lds
    s_add_u32 m0, m0, 1024
    s_nop 0
    buffer_load_dwordx4 v29, s[28:31], s40 offen lds
    s_add_u32 m0, s59, 32768
    s_add_u32 s40, s56, 3
    s_sub_u32 s43, s40, s57
    s_cselect_b32 s40, s40, s43
    s_lshl_b32 s40, s40, 17
    s_add_u32 s40, s40, 65536
    buffer_load_dwordx4 v28, s[28:31], s40 offen lds
    s_add_u32 m0, m0, 1024
    s_nop 0
    buffer_load_dwordx4 v29, s[28:31], s40 offen lds
    s_add_u32 m0, s59, 40960
    s_add_u32 s40, s56, 4
    s_sub_u32 s43, s40, s57
    s_cselect_b32 s40, s40, s43
    s_lshl_b32 s40, s40, 17
    s_add_u32 s40, s40, 65536
    buffer_load_dwordx4 v28, s[28:31], s40 offen lds
    s_add_u32 m0, m0, 1024
    s_nop 0
    buffer_load_dwordx4 v29, s[28:31], s40 offen lds
    s_or_b32 s42, s45, s83
    s_cbranch_scc1 L2W_gook
    s_waitcnt vmcnt(16)
    v_cmp_le_u32 vcc, 32, v14
    s_cbranch_vccnz L2W_gook
L2W_go:
    s_sleep 4
    buffer_load_dword v14, v15, s[68:71], 0 offen sc1
    s_waitcnt vmcnt(0)
    v_cmp_gt_u32 vcc, 32, v14
    s_cbranch_vccnz L2W_go
L2W_gook:
    s_cmp_lg_u32 s83, 0
    s_cbranch_scc1 L2W_nob7
    s_barrier
    s_bitcmp1_b32 s46, 0
    s_cbranch_scc0 L2W_nob7
    s_barrier
L2W_nob7:
    s_waitcnt vmcnt(14)
    ds_read_b64_tr_b16 v[40:41], v26 offset:16384
    ds_read_b64_tr_b16 v[42:43], v26 offset:16896
    ds_read_b64_tr_b16 v[44:45], v27 offset:16384
    ds_read_b64_tr_b16 v[46:47], v27 offset:16896
    s_waitcnt lgkmcnt(0)
    s_add_u32 m0, s59, 147456
    s_add_u32 s40, s56, 8
    s_sub_u32 s43, s40, 11
    s_cselect_b32 s40, s40, s43
    s_lshl_b32 s40, s40, 17
    buffer_load_dwordx4 v28, s[28:31], s40 offen lds
    s_add_u32 m0, m0, 1024
    s_nop 0
    buffer_load_dwordx4 v29, s[28:31], s40 offen lds
    s_and_b32 s42, s46, 5
    s_cbranch_scc1 L2W_nt8
    s_waitcnt vmcnt(4)
L2W_nt8:
    s_add_u32 m0, s59, 49152
    s_add_u32 s40, s56, 5
    s_sub_u32 s43, s40, s57
    s_cselect_b32 s40, s40, s43
    s_lshl_b32 s40, s40, 17
    s_add_u32 s40, s40, 65536
    buffer_load_dwordx4 v28, s[28:31], s40 offen lds
    s_add_u32 m0, m0, 1024
    s_nop 0
    buffer_load_dwordx4 v29, s[28:31], s40 offen lds
    s_and_b32 s42, s46, 5
    s_cbranch_scc1 L2W_nt16
    s_waitcnt vmcnt(4)
L2W_nt16:
    s_add_u32 m0, s59, 57344
    s_add_u32 s40, s56, 6
    s_sub_u32 s43, s40, s57
    s_cselect_b32 s40, s40, s43
    s_lshl_b32 s40, s40, 17
    s_add_u32 s40, s40, 65536
    buffer_load_dwordx4 v28, s[28:31], s40 offen lds
    s_add_u32 m0, m0, 1024
    s_nop 0
    buffer_load_dwordx4 v29, s[28:31], s40 offen lds
    s_and_b32 s42, s46, 5
    s_cbranch_scc1 L2W_nt17
    s_waitcnt vmcnt(4)
L2W_nt17:
    s_add_u32 m0, s59, 65536
    s_add_u32 s40, s56, 7
    s_sub_u32 s43, s40, s57
    s_cselect_b32 s40, s40, s43
    s_lshl_b32 s40, s40, 17
    s_add_u32 s40, s40, 65536
    buffer_load_dwordx4 v28, s[28:31], s40 offen lds
    s_add_u32 m0, m0, 1024
    s_nop 0
    buffer_load_dwordx4 v29, s[28:31], s40 offen lds
    s_and_b32 s42, s46, 5
    s_cbranch_scc1 L2W_nt18
    s_waitcnt vmcnt(4)
L2W_nt18:
    s_add_u32 m0, s59, 73728
    s_add_u32 s40, s56, 8
    s_sub_u32 s43, s40, s57
    s_cselect_b32 s40, s40, s43
    s_lshl_b32 s40, s40, 17
    s_add_u32 s40, s40, 65536
    buffer_load_dwordx4 v28, s[28:31], s40 offen lds
    s_add_u32 m0, m0, 1024
    s_nop 0
    buffer_load_dwordx4 v29, s[28:31], s40 offen lds
    s_and_b32 s42, s46, 5
    s_cbranch_scc1 L2W_nt19
    s_waitcnt vmcnt(4)
L2W_nt19:
    s_add_u32 m0, s59, 81920
    s_add_u32 s40, s56, 9
    s_sub_u32 s43, s40, s57
    s_cselect_b32 s40, s40, s43
    s_lshl_b32 s40, s40, 17
    s_add_u32 s40, s40, 65536
    buffer_load_dwordx4 v28, s[28:31], s40 offen lds
    s_add_u32 m0, m0, 1024
    s_nop 0
    buffer_load_dwordx4 v29, s[28:31], s40 offen lds
    s_and_b32 s42, s46, 5
    s_cbranch_scc1 L2W_nt20
    s_waitcnt vmcnt(4)
L2W_nt20:
    s_add_u32 m0, s59, 90112
    s_add_u32 s40, s56, 10
    s_sub_u32 s43, s40, s57
    s_cselect_b32 s40, s40, s43
    s_lshl_b32 s40, s40, 17
    s_add_u32 s40, s40, 65536
    buffer_load_dwordx4 v28, s[28:31], s40 offen lds
    s_add_u32 m0, m0, 1024
    s_nop 0
    buffer_load_dwordx4 v29, s[28:31], s40 offen lds
    s_and_b32 s42, s46, 5
    s_cbranch_scc1 L2W_nt21
    s_waitcnt vmcnt(4)
L2W_nt21:
    s_cmp_ge_u32 s45, 2
    s_cbranch_scc1 L2W_no19
    s_add_u32 m0, s59, 155648
    s_add_u32 s40, s56, 0
    s_sub_u32 s43, s40, s57
    s_cselect_b32 s40, s40, s43
    s_lshl_b32 s40, s40, 17
    s_add_u32 s40, s40, 65536
    buffer_load_dwordx4 v28, s[28:31], s40 offen lds
    s_add_u32 m0, m0, 1024
    s_nop 0
    buffer_load_dwordx4 v29, s[28:31], s40 offen lds
L2W_no19:
    s_cmp_lg_u32 s46, 4
    s_cbranch_scc1 L2W_nopf
    s_sub_u32 s42, s55, 4
    s_lshl_b32 s42, s42, 2
    s_add_u32 s42, s42, s45
    s_lshl_b32 s43, s2, 1
    s_add_u32 s42, s42, s43
    s_and_b32 s42, s42, 15
    s_mul_i32 s42, s42, 98304
    v_lshrrev_b32 v16, 1, v1
    v_lshlrev_b32 v16, 10, v16
    v_and_b32 v17, 1, v1
    v_lshl_add_u32 v16, v17, 7, v16
    buffer_load_dword v250, v16, s[28:31], s42 offen offset:0
    buffer_load_dword v250, v16, s[28:31], s42 offen offset:256
    s_add_u32 s42, s42, 0x8000
    buffer_load_dword v250, v16, s[28:31], s42 offen offset:0
    buffer_load_dword v250, v16, s[28:31], s42 offen offset:256
    s_add_u32 s42, s42, 0x8000
    buffer_load_dword v250, v16, s[28:31], s42 offen offset:0
    buffer_load_dword v250, v16, s[28:31], s42 offen offset:256
    s_add_u32 s42, s42, 0x8000
    s_waitcnt vmcnt(0)
    s_barrier
L2W_nopf:
    s_branch L2W_al
.p2align 12
L2W_al:
    s_waitcnt vmcnt(0)
    s_mov_b32 m0, 160000
    ds_read_b64_tr_b16 v[48:49], v24 offset:32768
    ds_read_b64_tr_b16 v[50:51], v24 offset:33280
    ds_read_b64_tr_b16 v[52:53], v25 offset:32768
    ds_read_b64_tr_b16 v[54:55], v25 offset:33280
    s_bitcmp1_b32 s60, 0
    s_cbranch_scc0 L2W_i0_spin
L2W_i0_ok:
    s_add_u32 s40, s56, 0
    s_sub_u32 s43, s40, 11
    s_cselect_b32 s40, s40, s43
    s_lshl_b32 s40, s40, 13
    buffer_load_dwordx4 v[128:131], v4, s[32:35], s40 offen sc1
    buffer_load_dwordx4 v[132:135], v5, s[32:35], s40 offen sc1
    s_bitcmp1_b32 s60, 1
    s_cbranch_scc0 L2W_i1_spin
L2W_i1_ok:
    s_add_u32 s40, s56, 1
    s_sub_u32 s43, s40, 11
    s_cselect_b32 s40, s40, s43
    s_lshl_b32 s40, s40, 13
    buffer_load_dwordx4 v[136:139], v4, s[32:35], s40 offen sc1
    buffer_load_dwordx4 v[140:143], v5, s[32:35], s40 offen sc1
    s_bitcmp1_b32 s60, 2
    s_cbranch_scc0 L2W_i2_spin
L2W_i2_ok:
    s_add_u32 s40, s56, 2
    s_sub_u32 s43, s40, 11
    s_cselect_b32 s40, s40, s43
    s_lshl_b32 s40, s40, 13
    buffer_load_dwordx4 v[144:147], v4, s[32:35], s40 offen sc1
    buffer_load_dwordx4 v[148:151], v5, s[32:35], s40 offen sc1
    s_bitcmp1_b32 s60, 3
    s_cbranch_scc0 L2W_i3_spin
L2W_i3_ok:
    s_add_u32 s40, s56, 3
    s_sub_u32 s43, s40, 11
    s_cselect_b32 s40, s40, s43
    s_lshl_b32 s40, s40, 13
    buffer_load_dwordx4 v[152:155], v4, s[32:35], s40 offen sc1
    buffer_load_dwordx4 v[156:159], v5, s[32:35], s40 offen sc1
    s_bitcmp1_b32 s60, 4
    s_cbranch_scc0 L2W_i4_spin
L2W_i4_ok:
    s_add_u32 s40, s56, 4
    s_sub_u32 s43, s40, 11
    s_cselect_b32 s40, s40, s43
    s_lshl_b32 s40, s40, 13
    buffer_load_dwordx4 v[160:163], v4, s[32:35], s40 offen sc1
    buffer_load_dwordx4 v[164:167], v5, s[32:35], s40 offen sc1
    s_waitcnt vmcnt(8)
    v_mfma_f32_32x32x16_bf16 v[64:79], v[32:35], v[128:131], 0
    ds_read_b64_tr_b16 v[56:57], v24 offset:40960
    ds_read_b64_tr_b16 v[58:59], v24 offset:41472
    ds_read_b64_tr_b16 v[60:61], v25 offset:40960
    ds_read_b64_tr_b16 v[62:63], v25 offset:41472
    v_mfma_f32_32x32x16_bf16 v[80:95], v[32:35], v[132:135], 0
    s_bitcmp1_b32 s60, 5
    s_cbranch_scc0 L2W_i5_spin
L2W_i5_ok:
    s_add_u32 s40, s56, 5
    s_sub_u32 s43, s40, 11
    s_cselect_b32 s40, s40, s43
    s_lshl_b32 s40, s40, 13
    buffer_load_dwordx4 v[168:171], v4, s[32:35], s40 offen sc1
    v_mfma_f32_32x32x16_bf16 v[96:111], v[36:39], v[128:131], 0
    buffer_load_dwordx4 v[172:175], v5, s[32:35], s40 offen sc1
    v_mfma_f32_32x32x16_bf16 v[112:127], v[36:39], v[132:135], 0
    s_waitcnt vmcnt(8)
    v_mfma_f32_32x32x16_bf16 v[64:79], v[40:43], v[136:139], v[64:79]
    ds_read_b64_tr_b16 v[32:33], v24 offset:49152
    ds_read_b64_tr_b16 v[34:35], v24 offset:49664
    ds_read_b64_tr_b16 v[36:37], v25 offset:49152
    ds_read_b64_tr_b16 v[38:39], v25 offset:49664
    v_mfma_f32_32x32x16_bf16 v[80:95], v[40:43], v[140:143], v[80:95]
    s_bitcmp1_b32 s60, 6
    s_cbranch_scc0 L2W_i6_spin
L2W_i6_ok:
    s_add_u32 s40, s56, 6
    s_sub_u32 s43, s40, 11
    s_cselect_b32 s40, s40, s43
    s_lshl_b32 s40, s40, 13
    buffer_load_dwordx4 v[176:179], v4, s[32:35], s40 offen sc1
    v_mfma_f32_32x32x16_bf16 v[96:111], v[44:47], v[136:139], v[96:111]
    buffer_load_dwordx4 v[180:183], v5, s[32:35], s40 offen sc1
    v_mfma_f32_32x32x16_bf16 v[112:127], v[44:47], v[140:143], v[112:127]
    s_waitcnt vmcnt(8)
    s_waitcnt lgkmcnt(8)
    v_mfma_f32_32x32x16_bf16 v[64:79], v[48:51], v[144:147], v[64:79]
    ds_read_b64_tr_b16 v[40:41], v24 offset:57344
    ds_read_b64_tr_b16 v[42:43], v24 offset:57856
    ds_read_b64_tr_b16 v[44:45], v25 offset:57344
    ds_read_b64_tr_b16 v[46:47], v25 offset:57856
    v_mfma_f32_32x32x16_bf16 v[80:95], v[48:51], v[148:151], v[80:95]
    s_bitcmp1_b32 s60, 7
    s_cbranch_scc0 L2W_i7_spin
L2W_i7_ok:
    s_add_u32 s40, s56, 7
    s_sub_u32 s43, s40, 11
    s_cselect_b32 s40, s40, s43
    s_lshl_b32 s40, s40, 13
    buffer_load_dwordx4 v[128:131], v4, s[32:35], s40 offen sc1
    v_mfma_f32_32x32x16_bf16 v[96:111], v[52:55], v[144:147], v[96:111]
    buffer_load_dwordx4 v[132:135], v5, s[32:35], s40 offen sc1
    v_mfma_f32_32x32x16_bf16 v[112:127], v[52:55], v[148:151], v[112:127]
    s_waitcnt vmcnt(8)
    s_waitcnt lgkmcnt(8)
    v_mfma_f32_32x32x16_bf16 v[64:79], v[56:59], v[152:155], v[64:79]
    ds_read_b64_tr_b16 v[48:49], v26 offset:0
    ds_read_b64_tr_b16 v[50:51], v26 offset:512
    ds_read_b64_tr_b16 v[52:53], v27 offset:0
    ds_read_b64_tr_b16 v[54:55], v27 offset:512
    v_mfma_f32_32x32x16_bf16 v[80:95], v[56:59], v[156:159], v[80:95]
    s_bitcmp1_b32 s60, 8
    s_cbranch_scc0 L2W_i8_spin
L2W_i8_ok:
    s_add_u32 s40, s56, 8
    s_sub_u32 s43, s40, 11
    s_cselect_b32 s40, s40, s43
    s_lshl_b32 s40, s40, 13
    buffer_load_dwordx4 v[136:139], v4, s[32:35], s40 offen sc1
    v_mfma_f32_32x32x16_bf16 v[96:111], v[60:63], v[152:155], v[96:111]
    buffer_load_dwordx4 v[140:143], v5, s[32:35], s40 offen sc1
    v_mfma_f32_32x32x16_bf16 v[112:127], v[60:63], v[156:159], v[112:127]
    s_waitcnt vmcnt(8)
    s_waitcnt lgkmcnt(8)
    v_mfma_f32_32x32x16_bf16 v[64:79], v[32:35], v[160:163], v[64:79]
    ds_read_b64_tr_b16 v[56:57], v26 offset:8192
    ds_read_b64_tr_b16 v[58:59], v26 offset:8704
    ds_read_b64_tr_b16 v[60:61], v27 offset:8192
    ds_read_b64_tr_b16 v[62:63], v27 offset:8704
    v_mfma_f32_32x32x16_bf16 v[80:95], v[32:35], v[164:167], v[80:95]
    s_bitcmp1_b32 s60, 9
    s_cbranch_scc0 L2W_i9_spin
L2W_i9_ok:
    s_add_u32 s40, s56, 9
    s_sub_u32 s43, s40, 11
    s_cselect_b32 s40, s40, s43
    s_lshl_b32 s40, s40, 13
    buffer_load_dwordx4 v[144:147], v4, s[32:35], s40 offen sc1
    v_mfma_f32_32x32x16_bf16 v[96:111], v[36:39], v[160:163], v[96:111]
    buffer_load_dwordx4 v[148:151], v5, s[32:35], s40 offen sc1
    v_mfma_f32_32x32x16_bf16 v[112:127], v[36:39], v[164:167], v[112:127]
    s_waitcnt vmcnt(8)
    s_waitcnt lgkmcnt(8)
    v_mfma_f32_32x32x16_bf16 v[64:79], v[40:43], v[168:171], v[64:79]
    ds_read_b64_tr_b16 v[32:33], v26 offset:16384
    ds_read_b64_tr_b16 v[34:35], v26 offset:16896
    ds_read_b64_tr_b16 v[36:37], v27 offset:16384
    ds_read_b64_tr_b16 v[38:39], v27 offset:16896
    v_mfma_f32_32x32x16_bf16 v[80:95], v[40:43], v[172:175], v[80:95]
    s_bitcmp1_b32 s60, 10
    s_cbranch_scc0 L2W_i10_spin
L2W_i10_ok:
    s_add_u32 s40, s56, 10
    s_sub_u32 s43, s40, 11
    s_cselect_b32 s40, s40, s43
    s_lshl_b32 s40, s40, 13
    buffer_load_dwordx4 v[152:155], v4, s[32:35], s40 offen sc1
    v_mfma_f32_32x32x16_bf16 v[96:111], v[44:47], v[168:171], v[96:111]
    buffer_load_dwordx4 v[156:159], v5, s[32:35], s40 offen sc1
    v_mfma_f32_32x32x16_bf16 v[112:127], v[44:47], v[172:175], v[112:127]
    s_waitcnt vmcnt(8)
    s_waitcnt lgkmcnt(8)
    v_mfma_f32_32x32x16_bf16 v[64:79], v[48:51], v[176:179], v[64:79]
    ds_read_b64_tr_b16 v[40:41], v22 offset:0
    ds_read_b64_tr_b16 v[42:43], v22 offset:512
    ds_read_b64_tr_b16 v[44:45], v23 offset:0
    ds_read_b64_tr_b16 v[46:47], v23 offset:512
    v_mfma_f32_32x32x16_bf16 v[80:95], v[48:51], v[180:183], v[80:95]
    s_bitcmp1_b32 s60, 11
    s_cbranch_scc0 L2W_i11_spin
L2W_i11_ok:
    s_add_u32 s40, s56, 0
    s_sub_u32 s43, s40, s57
    s_cselect_b32 s40, s40, s43
    s_lshl_b32 s40, s40, 13
    s_add_u32 s40, s40, 4096
    buffer_load_dwordx4 v[160:163], v4, s[32:35], s40 offen sc1
    v_mfma_f32_32x32x16_bf16 v[96:111], v[52:55], v[176:179], v[96:111]
    buffer_load_dwordx4 v[164:167], v5, s[32:35], s40 offen sc1
    v_mfma_f32_32x32x16_bf16 v[112:127], v[52:55], v[180:183], v[112:127]
    s_waitcnt vmcnt(8)
    s_waitcnt lgkmcnt(8)
    v_mfma_f32_32x32x16_bf16 v[64:79], v[56:59], v[128:131], v[64:79]
    ds_read_b64_tr_b16 v[48:49], v22 offset:8192
    ds_read_b64_tr_b16 v[50:51], v22 offset:8704
    ds_read_b64_tr_b16 v[52:53], v23 offset:8192
    ds_read_b64_tr_b16 v[54:55], v23 offset:8704
    v_mfma_f32_32x32x16_bf16 v[80:95], v[56:59], v[132:135], v[80:95]
    s_bitcmp1_b32 s60, 12
    s_cbranch_scc0 L2W_i12_spin
L2W_i12_ok:
    s_add_u32 s40, s56, 1
    s_sub_u32 s43, s40, s57
    s_cselect_b32 s40, s40, s43
    s_lshl_b32 s40, s40, 13
    s_add_u32 s40, s40, 4096
    buffer_load_dwordx4 v[168:171], v4, s[32:35], s40 offen sc1
    v_mfma_f32_32x32x16_bf16 v[96:111], v[60:63], v[128:131], v[96:111]
    buffer_load_dwordx4 v[172:175], v5, s[32:35], s40 offen sc1
    v_mfma_f32_32x32x16_bf16 v[112:127], v[60:63], v[132:135], v[112:127]
    s_waitcnt vmcnt(8)
    s_waitcnt lgkmcnt(8)
    v_mfma_f32_32x32x16_bf16 v[64:79], v[32:35], v[136:139], v[64:79]
    ds_read_b64_tr_b16 v[56:57], v26 offset:24576
    ds_read_b64_tr_b16 v[58:59], v26 offset:25088
    ds_read_b64_tr_b16 v[60:61], v27 offset:24576
    ds_read_b64_tr_b16 v[62:63], v27 offset:25088
    v_mfma_f32_32x32x16_bf16 v[80:95], v[32:35], v[140:143], v[80:95]
    s_bitcmp1_b32 s60, 13
    s_cbranch_scc0 L2W_i13_spin
L2W_i13_ok:
    s_add_u32 s40, s56, 2
    s_sub_u32 s43, s40, s57
    s_cselect_b32 s40, s40, s43
    s_lshl_b32 s40, s40, 13
    s_add_u32 s40, s40, 4096
    buffer_load_dwordx4 v[176:179], v4, s[32:35], s40 offen sc1
    v_mfma_f32_32x32x16_bf16 v[96:111], v[36:39], v[136:139], v[96:111]
    buffer_load_dwordx4 v[180:183], v5, s[32:35], s40 offen sc1
    v_mfma_f32_32x32x16_bf16 v[112:127], v[36:39], v[140:143], v[112:127]
    s_waitcnt vmcnt(8)
    s_waitcnt lgkmcnt(8)
    v_mfma_f32_32x32x16_bf16 v[64:79], v[40:43], v[144:147], v[64:79]
    ds_read_b64_tr_b16 v[32:33], v22 offset:16384
    ds_read_b64_tr_b16 v[34:35], v22 offset:16896
    ds_read_b64_tr_b16 v[36:37], v23 offset:16384
    ds_read_b64_tr_b16 v[38:39], v23 offset:16896
    v_mfma_f32_32x32x16_bf16 v[80:95], v[40:43], v[148:151], v[80:95]
    s_bitcmp1_b32 s60, 14
    s_cbranch_scc0 L2W_i14_spin
L2W_i14_ok:
    s_add_u32 s40, s56, 3
    s_sub_u32 s43, s40, s57
    s_cselect_b32 s40, s40, s43
    s_lshl_b32 s40, s40, 13
    s_add_u32 s40, s40, 4096
    buffer_load_dwordx4 v[128:131], v4, s[32:35], s40 offen sc1
    v_mfma_f32_32x32x16_bf16 v[96:111], v[44:47], v[144:147], v[96:111]
    buffer_load_dwordx4 v[132:135], v5, s[32:35], s40 offen sc1
    v_mfma_f32_32x32x16_bf16 v[112:127], v[44:47], v[148:151], v[112:127]
    s_waitcnt vmcnt(8)
    s_waitcnt lgkmcnt(8)
    v_mfma_f32_32x32x16_bf16 v[64:79], v[48:51], v[152:155], v[64:79]
    ds_read_b64_tr_b16 v[40:41], v22 offset:24576
    ds_read_b64_tr_b16 v[42:43], v22 offset:25088
    ds_read_b64_tr_b16 v[44:45], v23 offset:24576
    ds_read_b64_tr_b16 v[46:47], v23 offset:25088
    v_mfma_f32_32x32x16_bf16 v[80:95], v[48:51], v[156:159], v[80:95]
    s_bitcmp1_b32 s60, 15
    s_cbranch_scc0 L2W_i15_spin
L2W_i15_ok:
    s_add_u32 s40, s56, 4
    s_sub_u32 s43, s40, s57
    s_cselect_b32 s40, s40, s43
    s_lshl_b32 s40, s40, 13
    s_add_u32 s40, s40, 4096
    buffer_load_dwordx4 v[136:139], v4, s[32:35], s40 offen sc1
    v_mfma_f32_32x32x16_bf16 v[96:111], v[52:55], v[152:155], v[96:111]
    buffer_load_dwordx4 v[140:143], v5, s[32:35], s40 offen sc1
    v_mfma_f32_32x32x16_bf16 v[112:127], v[52:55], v[156:159], v[112:127]
    s_waitcnt vmcnt(8)
    s_waitcnt lgkmcnt(8)
    s_cmp_ge_u32 s45, 2
    s_cbranch_scc1 L2W_skip0
    v_mfma_f32_32x32x16_bf16 v[64:79], v[56:59], v[160:163], v[64:79]
L2W_skip0:
    ds_read_b64_tr_b16 v[48:49], v22 offset:32768
    ds_read_b64_tr_b16 v[50:51], v22 offset:33280
    ds_read_b64_tr_b16 v[52:53], v23 offset:32768
    ds_read_b64_tr_b16 v[54:55], v23 offset:33280
    s_cmp_ge_u32 s45, 2
    s_cbranch_scc1 L2W_skip1
    v_mfma_f32_32x32x16_bf16 v[80:95], v[56:59], v[164:167], v[80:95]
L2W_skip1:
    s_bitcmp1_b32 s60, 16
    s_cbranch_scc0 L2W_i16_spin
L2W_i16_ok:
    s_add_u32 s40, s56, 5
    s_sub_u32 s43, s40, s57
    s_cselect_b32 s40, s40, s43
    s_lshl_b32 s40, s40, 13
    s_add_u32 s40, s40, 4096
    buffer_load_dwordx4 v[144:147], v4, s[32:35], s40 offen sc1
    s_cmp_ge_u32 s45, 2
    s_cbranch_scc1 L2W_skip2
    v_mfma_f32_32x32x16_bf16 v[96:111], v[60:63], v[160:163], v[96:111]
L2W_skip2:
    buffer_load_dwordx4 v[148:151], v5, s[32:35], s40 offen sc1
    s_cmp_ge_u32 s45, 2
    s_cbranch_scc1 L2W_skip3
    v_mfma_f32_32x32x16_bf16 v[112:127], v[60:63], v[164:167], v[112:127]
L2W_skip3:
    s_waitcnt vmcnt(8)
    s_waitcnt lgkmcnt(8)
    v_mfma_f32_32x32x16_bf16 v[64:79], v[32:35], v[168:171], v[64:79]
    ds_read_b64_tr_b16 v[56:57], v22 offset:40960
    ds_read_b64_tr_b16 v[58:59], v22 offset:41472
    ds_read_b64_tr_b16 v[60:61], v23 offset:40960
    ds_read_b64_tr_b16 v[62:63], v23 offset:41472
    v_mfma_f32_32x32x16_bf16 v[80:95], v[32:35], v[172:175], v[80:95]
    s_bitcmp1_b32 s60, 17
    s_cbranch_scc0 L2W_i17_spin
L2W_i17_ok:
    s_add_u32 s40, s56, 6
    s_sub_u32 s43, s40, s57
    s_cselect_b32 s40, s40, s43
    s_lshl_b32 s40, s40, 13
    s_add_u32 s40, s40, 4096
    buffer_load_dwordx4 v[152:155], v4, s[32:35], s40 offen sc1
    v_mfma_f32_32x32x16_bf16 v[96:111], v[36:39], v[168:171], v[96:111]
    buffer_load_dwordx4 v[156:159], v5, s[32:35], s40 offen sc1
    v_mfma_f32_32x32x16_bf16 v[112:127], v[36:39], v[172:175], v[112:127]
    s_waitcnt vmcnt(8)
    s_waitcnt lgkmcnt(8)
    v_mfma_f32_32x32x16_bf16 v[64:79], v[40:43], v[176:179], v[64:79]
    ds_read_b64_tr_b16 v[32:33], v22 offset:49152
    ds_read_b64_tr_b16 v[34:35], v22 offset:49664
    ds_read_b64_tr_b16 v[36:37], v23 offset:49152
    ds_read_b64_tr_b16 v[38:39], v23 offset:49664
    v_mfma_f32_32x32x16_bf16 v[80:95], v[40:43], v[180:183], v[80:95]
    s_bitcmp1_b32 s60, 18
    s_cbranch_scc0 L2W_i18_spin
L2W_i18_ok:
    s_add_u32 s40, s56, 7
    s_sub_u32 s43, s40, s57
    s_cselect_b32 s40, s40, s43
    s_lshl_b32 s40, s40, 13
    s_add_u32 s40, s40, 4096
    buffer_load_dwordx4 v[160:163], v4, s[32:35], s40 offen sc1
    v_mfma_f32_32x32x16_bf16 v[96:111], v[44:47], v[176:179], v[96:111]
    buffer_load_dwordx4 v[164:167], v5, s[32:35], s40 offen sc1
    v_mfma_f32_32x32x16_bf16 v[112:127], v[44:47], v[180:183], v[112:127]
    s_waitcnt vmcnt(8)
    s_waitcnt lgkmcnt(8)
    v_mfma_f32_32x32x16_bf16 v[64:79], v[48:51], v[128:131], v[64:79]
    ds_read_b64_tr_b16 v[40:41], v22 offset:57344
    ds_read_b64_tr_b16 v[42:43], v22 offset:57856
    ds_read_b64_tr_b16 v[44:45], v23 offset:57344
    ds_read_b64_tr_b16 v[46:47], v23 offset:57856
    v_mfma_f32_32x32x16_bf16 v[80:95], v[48:51], v[132:135], v[80:95]
    s_bitcmp1_b32 s60, 19
    s_cbranch_scc0 L2W_i19_spin
L2W_i19_ok:
    s_add_u32 s40, s56, 8
    s_sub_u32 s43, s40, s57
    s_cselect_b32 s40, s40, s43
    s_lshl_b32 s40, s40, 13
    s_add_u32 s40, s40, 4096
    buffer_load_dwordx4 v[168:171], v4, s[32:35], s40 offen sc1
    v_mfma_f32_32x32x16_bf16 v[96:111], v[52:55], v[128:131], v[96:111]
    buffer_load_dwordx4 v[172:175], v5, s[32:35], s40 offen sc1
    v_mfma_f32_32x32x16_bf16 v[112:127], v[52:55], v[132:135], v[112:127]
    s_waitcnt vmcnt(8)
    s_waitcnt lgkmcnt(8)
    v_mfma_f32_32x32x16_bf16 v[64:79], v[56:59], v[136:139], v[64:79]
    ds_read_b64_tr_b16 v[48:49], v24 offset:0
    ds_read_b64_tr_b16 v[50:51], v24 offset:512
    ds_read_b64_tr_b16 v[52:53], v25 offset:0
    ds_read_b64_tr_b16 v[54:55], v25 offset:512
    v_mfma_f32_32x32x16_bf16 v[80:95], v[56:59], v[140:143], v[80:95]
    s_bitcmp1_b32 s60, 20
    s_cbranch_scc0 L2W_i20_spin
L2W_i20_ok:
    s_add_u32 s40, s56, 9
    s_sub_u32 s43, s40, s57
    s_cselect_b32 s40, s40, s43
    s_lshl_b32 s40, s40, 13
    s_add_u32 s40, s40, 4096
    buffer_load_dwordx4 v[176:179], v4, s[32:35], s40 offen sc1
    v_mfma_f32_32x32x16_bf16 v[96:111], v[60:63], v[136:139], v[96:111]
    buffer_load_dwordx4 v[180:183], v5, s[32:35], s40 offen sc1
    s_barrier
    v_mfma_f32_32x32x16_bf16 v[112:127], v[60:63], v[140:143], v[112:127]
    s_waitcnt vmcnt(8)
    s_waitcnt lgkmcnt(8)
    v_mfma_f32_32x32x16_bf16 v[64:79], v[32:35], v[144:147], v[64:79]
    ds_read_b64_tr_b16 v[56:57], v24 offset:8192
    ds_read_b64_tr_b16 v[58:59], v24 offset:8704
    ds_read_b64_tr_b16 v[60:61], v25 offset:8192
    ds_read_b64_tr_b16 v[62:63], v25 offset:8704
    v_mfma_f32_32x32x16_bf16 v[80:95], v[32:35], v[148:151], v[80:95]
    s_bitcmp1_b32 s60, 21
    s_cbranch_scc0 L2W_i21_spin
L2W_i21_ok:
    s_add_u32 s40, s56, 10
    s_sub_u32 s43, s40, s57
    s_cselect_b32 s40, s40, s43
    s_lshl_b32 s40, s40, 13
    s_add_u32 s40, s40, 4096
    buffer_load_dwordx4 v[128:131], v4, s[32:35], s40 offen sc1
    v_mfma_f32_32x32x16_bf16 v[96:111], v[36:39], v[144:147], v[96:111]
    buffer_load_dwordx4 v[132:135], v5, s[32:35], s40 offen sc1
    v_mfma_f32_32x32x16_bf16 v[112:127], v[36:39], v[148:151], v[112:127]
    s_waitcnt vmcnt(8)
    s_waitcnt lgkmcnt(8)
    v_mfma_f32_32x32x16_bf16 v[64:79], v[40:43], v[152:155], v[64:79]
    ds_read_b64_tr_b16 v[32:33], v24 offset:16384
    ds_read_b64_tr_b16 v[34:35], v24 offset:16896
    ds_read_b64_tr_b16 v[36:37], v25 offset:16384
    ds_read_b64_tr_b16 v[38:39], v25 offset:16896
    v_mfma_f32_32x32x16_bf16 v[80:95], v[40:43], v[156:159], v[80:95]
    v_mfma_f32_32x32x16_bf16 v[96:111], v[44:47], v[152:155], v[96:111]
    v_mfma_f32_32x32x16_bf16 v[112:127], v[44:47], v[156:159], v[112:127]
    s_waitcnt vmcnt(6)
    s_waitcnt lgkmcnt(8)
    v_mfma_f32_32x32x16_bf16 v[64:79], v[48:51], v[160:163], v[64:79]
    ds_read_b64_tr_b16 v[40:41], v24 offset:24576
    ds_read_b64_tr_b16 v[42:43], v24 offset:25088
    ds_read_b64_tr_b16 v[44:45], v25 offset:24576
    ds_read_b64_tr_b16 v[46:47], v25 offset:25088
    v_mfma_f32_32x32x16_bf16 v[80:95], v[48:51], v[164:167], v[80:95]
    v_mfma_f32_32x32x16_bf16 v[96:111], v[52:55], v[160:163], v[96:111]
    v_mfma_f32_32x32x16_bf16 v[112:127], v[52:55], v[164:167], v[112:127]
    s_waitcnt vmcnt(4)
    s_waitcnt lgkmcnt(8)
    v_mfma_f32_32x32x16_bf16 v[64:79], v[56:59], v[168:171], v[64:79]
    v_mfma_f32_32x32x16_bf16 v[80:95], v[56:59], v[172:175], v[80:95]
    v_mfma_f32_32x32x16_bf16 v[96:111], v[60:63], v[168:171], v[96:111]
    v_mfma_f32_32x32x16_bf16 v[112:127], v[60:63], v[172:175], v[112:127]
    s_waitcnt vmcnt(2)
    s_waitcnt lgkmcnt(4)
    v_mfma_f32_32x32x16_bf16 v[64:79], v[32:35], v[176:179], v[64:79]
    v_mfma_f32_32x32x16_bf16 v[80:95], v[32:35], v[180:183], v[80:95]
    v_mfma_f32_32x32x16_bf16 v[96:111], v[36:39], v[176:179], v[96:111]
    v_mfma_f32_32x32x16_bf16 v[112:127], v[36:39], v[180:183], v[112:127]
    s_waitcnt vmcnt(0)
    s_waitcnt lgkmcnt(0)
    v_mfma_f32_32x32x16_bf16 v[64:79], v[40:43], v[128:131], v[64:79]
    v_mfma_f32_32x32x16_bf16 v[80:95], v[40:43], v[132:135], v[80:95]
    v_mfma_f32_32x32x16_bf16 v[96:111], v[44:47], v[128:131], v[96:111]
    v_mfma_f32_32x32x16_bf16 v[112:127], v[44:47], v[132:135], v[112:127]
    v_lshlrev_b32 v16, 4, v1
    v_add_u32 v16, s59, v16
    s_nop 7
    s_nop 3
    ds_write_b128 v16, v[64:67] offset:0
    ds_write_b128 v16, v[68:71] offset:1024
    ds_write_b128 v16, v[72:75] offset:8192
    ds_write_b128 v16, v[76:79] offset:9216
    ds_write_b128 v16, v[80:83] offset:16384
    ds_write_b128 v16, v[84:87] offset:17408
    ds_write_b128 v16, v[88:91] offset:24576
    ds_write_b128 v16, v[92:95] offset:25600
    ds_write_b128 v16, v[96:99] offset:32768
    ds_write_b128 v16, v[100:103] offset:33792
    ds_write_b128 v16, v[104:107] offset:40960
    ds_write_b128 v16, v[108:111] offset:41984
    ds_write_b128 v16, v[112:115] offset:49152
    ds_write_b128 v16, v[116:119] offset:50176
    ds_write_b128 v16, v[120:123] offset:57344
    s_waitcnt lgkmcnt(10)
    ds_write_b128 v16, v[124:127] offset:58368
    s_waitcnt lgkmcnt(0)
    s_barrier
    s_endpgm
L2W_i0_spin:
    ds_read2_b32 v[16:17], v7 offset0:0 offset1:16
    s_waitcnt lgkmcnt(0)
    v_min_u32 v16, v16, v17
    v_cmp_ge_u32 vcc, v16, v6
    s_mov_b32 s60, vcc_lo
    s_bitcmp1_b32 s60, 0
    s_cbranch_scc1 L2W_i0_ok
    s_branch L2W_i0_spin
L2W_i1_spin:
    ds_read2_b32 v[16:17], v7 offset0:0 offset1:16
    s_waitcnt lgkmcnt(0)
    v_min_u32 v16, v16, v17
    v_cmp_ge_u32 vcc, v16, v6
    s_mov_b32 s60, vcc_lo
    s_bitcmp1_b32 s60, 1
    s_cbranch_scc1 L2W_i1_ok
    s_branch L2W_i1_spin
L2W_i2_spin:
    ds_read2_b32 v[16:17], v7 offset0:0 offset1:16
    s_waitcnt lgkmcnt(0)
    v_min_u32 v16, v16, v17
    v_cmp_ge_u32 vcc, v16, v6
    s_mov_b32 s60, vcc_lo
    s_bitcmp1_b32 s60, 2
    s_cbranch_scc1 L2W_i2_ok
    s_branch L2W_i2_spin
L2W_i3_spin:
    ds_read2_b32 v[16:17], v7 offset0:0 offset1:16
    s_waitcnt lgkmcnt(0)
    v_min_u32 v16, v16, v17
    v_cmp_ge_u32 vcc, v16, v6
    s_mov_b32 s60, vcc_lo
    s_bitcmp1_b32 s60, 3
    s_cbranch_scc1 L2W_i3_ok
    s_branch L2W_i3_spin
L2W_i4_spin:
    ds_read2_b32 v[16:17], v7 offset0:0 offset1:16
    s_waitcnt lgkmcnt(0)
    v_min_u32 v16, v16, v17
    v_cmp_ge_u32 vcc, v16, v6
    s_mov_b32 s60, vcc_lo
    s_bitcmp1_b32 s60, 4
    s_cbranch_scc1 L2W_i4_ok
    s_branch L2W_i4_spin
L2W_i5_spin:
    ds_read2_b32 v[16:17], v7 offset0:0 offset1:16
    s_waitcnt lgkmcnt(0)
    v_min_u32 v16, v16, v17
    v_cmp_ge_u32 vcc, v16, v6
    s_mov_b32 s60, vcc_lo
    s_bitcmp1_b32 s60, 5
    s_cbranch_scc1 L2W_i5_ok
    s_branch L2W_i5_spin
L2W_i6_spin:
    ds_read2_b32 v[16:17], v7 offset0:0 offset1:16
    s_waitcnt lgkmcnt(0)
    v_min_u32 v16, v16, v17
    v_cmp_ge_u32 vcc, v16, v6
    s_mov_b32 s60, vcc_lo
    s_bitcmp1_b32 s60, 6
    s_cbranch_scc1 L2W_i6_ok
    s_branch L2W_i6_spin
L2W_i7_spin:
    ds_read2_b32 v[16:17], v7 offset0:0 offset1:16
    s_waitcnt lgkmcnt(0)
    v_min_u32 v16, v16, v17
    v_cmp_ge_u32 vcc, v16, v6
    s_mov_b32 s60, vcc_lo
    s_bitcmp1_b32 s60, 7
    s_cbranch_scc1 L2W_i7_ok
    s_branch L2W_i7_spin
L2W_i8_spin:
    ds_read2_b32 v[16:17], v7 offset0:0 offset1:16
    s_waitcnt lgkmcnt(0)
    v_min_u32 v16, v16, v17
    v_cmp_ge_u32 vcc, v16, v6
    s_mov_b32 s60, vcc_lo
    s_bitcmp1_b32 s60, 8
    s_cbranch_scc1 L2W_i8_ok
    s_branch L2W_i8_spin
L2W_i9_spin:
    ds_read2_b32 v[16:17], v7 offset0:0 offset1:16
    s_waitcnt lgkmcnt(0)
    v_min_u32 v16, v16, v17
    v_cmp_ge_u32 vcc, v16, v6
    s_mov_b32 s60, vcc_lo
    s_bitcmp1_b32 s60, 9
    s_cbranch_scc1 L2W_i9_ok
    s_branch L2W_i9_spin
L2W_i10_spin:
    ds_read2_b32 v[16:17], v7 offset0:0 offset1:16
    s_waitcnt lgkmcnt(0)
    v_min_u32 v16, v16, v17
    v_cmp_ge_u32 vcc, v16, v6
    s_mov_b32 s60, vcc_lo
    s_bitcmp1_b32 s60, 10
    s_cbranch_scc1 L2W_i10_ok
    s_branch L2W_i10_spin
L2W_i11_spin:
    ds_read2_b32 v[16:17], v7 offset0:0 offset1:16
    s_waitcnt lgkmcnt(0)
    v_min_u32 v16, v16, v17
    v_cmp_ge_u32 vcc, v16, v6
    s_mov_b32 s60, vcc_lo
    s_bitcmp1_b32 s60, 11
    s_cbranch_scc1 L2W_i11_ok
    s_branch L2W_i11_spin
L2W_i12_spin:
    ds_read2_b32 v[16:17], v7 offset0:0 offset1:16
    s_waitcnt lgkmcnt(0)
    v_min_u32 v16, v16, v17
    v_cmp_ge_u32 vcc, v16, v6
    s_mov_b32 s60, vcc_lo
    s_bitcmp1_b32 s60, 12
    s_cbranch_scc1 L2W_i12_ok
    s_branch L2W_i12_spin
L2W_i13_spin:
    ds_read2_b32 v[16:17], v7 offset0:0 offset1:16
    s_waitcnt lgkmcnt(0)
    v_min_u32 v16, v16, v17
    v_cmp_ge_u32 vcc, v16, v6
    s_mov_b32 s60, vcc_lo
    s_bitcmp1_b32 s60, 13
    s_cbranch_scc1 L2W_i13_ok
    s_branch L2W_i13_spin
L2W_i14_spin:
    ds_read2_b32 v[16:17], v7 offset0:0 offset1:16
    s_waitcnt lgkmcnt(0)
    v_min_u32 v16, v16, v17
    v_cmp_ge_u32 vcc, v16, v6
    s_mov_b32 s60, vcc_lo
    s_bitcmp1_b32 s60, 14
    s_cbranch_scc1 L2W_i14_ok
    s_branch L2W_i14_spin
L2W_i15_spin:
    ds_read2_b32 v[16:17], v7 offset0:0 offset1:16
    s_waitcnt lgkmcnt(0)
    v_min_u32 v16, v16, v17
    v_cmp_ge_u32 vcc, v16, v6
    s_mov_b32 s60, vcc_lo
    s_bitcmp1_b32 s60, 15
    s_cbranch_scc1 L2W_i15_ok
    s_branch L2W_i15_spin
L2W_i16_spin:
    ds_read2_b32 v[16:17], v7 offset0:0 offset1:16
    s_waitcnt lgkmcnt(0)
    v_min_u32 v16, v16, v17
    v_cmp_ge_u32 vcc, v16, v6
    s_mov_b32 s60, vcc_lo
    s_bitcmp1_b32 s60, 16
    s_cbranch_scc1 L2W_i16_ok
    s_branch L2W_i16_spin
L2W_i17_spin:
    ds_read2_b32 v[16:17], v7 offset0:0 offset1:16
    s_waitcnt lgkmcnt(0)
    v_min_u32 v16, v16, v17
    v_cmp_ge_u32 vcc, v16, v6
    s_mov_b32 s60, vcc_lo
    s_bitcmp1_b32 s60, 17
    s_cbranch_scc1 L2W_i17_ok
    s_branch L2W_i17_spin
L2W_i18_spin:
    ds_read2_b32 v[16:17], v7 offset0:0 offset1:16
    s_waitcnt lgkmcnt(0)
    v_min_u32 v16, v16, v17
    v_cmp_ge_u32 vcc, v16, v6
    s_mov_b32 s60, vcc_lo
    s_bitcmp1_b32 s60, 18
    s_cbranch_scc1 L2W_i18_ok
    s_branch L2W_i18_spin
L2W_i19_spin:
    ds_read2_b32 v[16:17], v7 offset0:0 offset1:16
    s_waitcnt lgkmcnt(0)
    v_min_u32 v16, v16, v17
    v_cmp_ge_u32 vcc, v16, v6
    s_mov_b32 s60, vcc_lo
    s_bitcmp1_b32 s60, 19
    s_cbranch_scc1 L2W_i19_ok
    s_branch L2W_i19_spin
L2W_i20_spin:
    ds_read2_b32 v[16:17], v7 offset0:0 offset1:16
    s_waitcnt lgkmcnt(0)
    v_min_u32 v16, v16, v17
    v_cmp_ge_u32 vcc, v16, v6
    s_mov_b32 s60, vcc_lo
    s_bitcmp1_b32 s60, 20
    s_cbranch_scc1 L2W_i20_ok
    s_branch L2W_i20_spin
L2W_i21_spin:
    ds_read2_b32 v[16:17], v7 offset0:0 offset1:16
    s_waitcnt lgkmcnt(0)
    v_min_u32 v16, v16, v17
    v_cmp_ge_u32 vcc, v16, v6
    s_mov_b32 s60, vcc_lo
    s_bitcmp1_b32 s60, 21
    s_cbranch_scc1 L2W_i21_ok
    s_branch L2W_i21_spin
.p2align 12
L1_compw:
    s_cmp_eq_u32 s44, 3
    s_cbranch_scc1 L_dc_3
    s_mul_i32 s22, s42, 3
    s_min_u32 s22, s22, 8
    s_add_u32 s22, s22, s44
    s_and_b32 s46, s42, s44
    s_lshr_b32 s46, s46, 1
    s_cbranch_scc0 L_dc_d
    s_and_b32 s22, s42, 1
    s_branch L_dc_d
L_dc_3:
    s_cmp_lt_u32 s55, 2
    s_cselect_b32 s22, 10, 2
    s_lshr_b32 s46, s55, 1
    s_add_u32 s46, s46, 2
    s_min_u32 s46, s46, 4
L_dc_d:
    s_lshr_b32 s52, s2, 6
    s_mov_b32 s51, s55
    s_lshl1_add_u32 s56, s52, s51
    s_and_b32 s54, s2, 7
    s_and_b32 s53, s52, 1
    s_lshl1_add_u32 s54, s54, s53
    s_add_u32 s54, s54, 1
    s_sub_u32 s53, 32, s54
    s_cmp_eq_u32 s53, 16
    s_cselect_b32 s53, 0, s53
    s_cmp_ge_u32 s52, 2
    s_cselect_b32 s54, s53, s54
    v_lshlrev_b32 v20, 3, v1
    v_add_u32 v20, 159744, v20
    v_mov_b32 v2, 0
    v_mov_b32 v3, 0
    ds_write_b64 v20, v[2:3]
    s_waitcnt lgkmcnt(0)
    s_and_b32 s63, s23, 31
    s_mul_i32 s63, s63, 256
    s_lshr_b32 s44, s23, 5
    s_lshl_b32 s44, s44, 4
    s_add_u32 s63, s63, s44
    s_add_u32 s63, s63, s22
    s_lshl_b32 s63, s63, 2
    s_cmp_eq_u32 s46, 4
    s_cbranch_scc1 L1C_idle
    v_bfe_u32 v20, v1, 2, 2
    v_lshrrev_b32 v21, 4, v1
    v_lshl_add_u32 v21, v21, 3, v20
    v_lshlrev_b32 v21, 8, v21
    v_bfe_u32 v20, v1, 2, 3
    v_lshl_add_u32 v21, v20, 5, v21
    v_and_b32 v20, 3, v1
    v_lshl_add_u32 v10, v20, 3, v21
    v_and_b32 v20, 15, v1
    v_lshrrev_b32 v21, 1, v20
    v_lshrrev_b32 v22, 4, v1
    v_xor_b32 v21, v21, v22
    v_lshlrev_b32 v21, 4, v21
    v_lshl_add_u32 v20, v20, 7, v21
    v_add_u32 v6, s48, v20
    v_xor_b32 v7, 64, v6
    v_xor_b32 v8, 0x2000, v6
    v_xor_b32 v9, 0x2040, v6
    s_mov_b32 s65, 1
    s_cmp_eq_u32 s46, 2
    s_cbranch_scc1 L1C_ffn6
    s_cmp_lg_u32 s46, 0
    s_cbranch_scc1 L1C_specs
L1C_ffn8:
    s_mul_i32 s41, s41, 4
    s_add_u32 s42, s41, 0
    s_lshl_b32 s42, s42, 5
    v_xor_b32 v2, s42, v10
    s_add_u32 s42, s41, 1
    s_lshl_b32 s42, s42, 5
    v_xor_b32 v3, s42, v10
    s_add_u32 s42, s41, 2
    s_lshl_b32 s42, s42, 5
    v_xor_b32 v4, s42, v10
    s_add_u32 s42, s41, 3
    s_lshl_b32 s42, s42, 5
    v_xor_b32 v5, s42, v10
    v_mov_b32 v24, 0xc0135761
    v_mov_b32 v26, 0xbdd2d3e8
    v_mov_b32 v25, 0xc0135761
    v_mov_b32 v27, 0xbdd2d3e8
    v_lshlrev_b32 v14, 4, v1
    s_mov_b32 s32, s78
    s_mov_b32 s33, s79
    s_mov_b32 s34, 0x570000
    s_mov_b32 s35, 0x20000
    s_lshl3_add_u32 s44, s22, s41
    s_mul_i32 s42, s23, 87
    s_add_u32 s42, s42, s44
    s_lshl_b32 s42, s42, 10
    s_xor_b32 s43, s23, 32
    s_mul_i32 s43, s43, 87
    s_add_u32 s43, s43, s44
    s_lshl_b32 s43, s43, 10
    s_barrier
    ds_read_b128 v[52:55], v6 offset:0
    ds_read_b128 v[56:59], v7 offset:0
    ds_read_b128 v[60:63], v6 offset:2048
    ds_read_b128 v[64:67], v7 offset:2048
    ds_read_b128 v[68:71], v8 offset:0
    ds_read_b128 v[72:75], v9 offset:0
    ds_read_b128 v[76:79], v8 offset:2048
    ds_read_b128 v[80:83], v9 offset:2048
    ds_read_b64_tr_b16 v[28:29], v2 offset:0
    ds_read_b64_tr_b16 v[30:31], v2 offset:1024
    ds_read_b64_tr_b16 v[32:33], v2 offset:16384
    ds_read_b64_tr_b16 v[34:35], v2 offset:17408
    v_add_u32 v6, 49152, v6
    v_add_u32 v7, 49152, v7
    v_add_u32 v8, 49152, v8
    v_add_u32 v9, 49152, v9
    ds_read_b64_tr_b16 v[36:37], v3 offset:0
    ds_read_b64_tr_b16 v[38:39], v3 offset:1024
    ds_read_b64_tr_b16 v[40:41], v3 offset:16384
    s_waitcnt lgkmcnt(10)
    ds_read_b64_tr_b16 v[42:43], v3 offset:17408
    s_waitcnt lgkmcnt(4)
    v_mfma_f32_16x16x32_bf16 v[116:119], v[28:31], v[52:55], 0
    ds_read_b64_tr_b16 v[44:45], v4 offset:0
    v_mfma_f32_16x16x32_bf16 v[124:127], v[32:35], v[52:55], 0
    ds_read_b64_tr_b16 v[46:47], v4 offset:1024
    v_mfma_f32_16x16x32_bf16 v[120:123], v[28:31], v[60:63], 0
    ds_read_b64_tr_b16 v[48:49], v4 offset:16384
    v_mfma_f32_16x16x32_bf16 v[128:131], v[32:35], v[60:63], 0
    ds_read_b64_tr_b16 v[50:51], v4 offset:17408
    v_mfma_f32_16x16x32_bf16 v[132:135], v[28:31], v[68:71], 0
    v_mfma_f32_16x16x32_bf16 v[140:143], v[32:35], v[68:71], 0
    v_mfma_f32_16x16x32_bf16 v[136:139], v[28:31], v[76:79], 0
    v_mfma_f32_16x16x32_bf16 v[144:147], v[32:35], v[76:79], 0
    s_waitcnt lgkmcnt(4)
    v_mfma_f32_16x16x32_bf16 v[148:151], v[36:39], v[52:55], 0
    ds_read_b64_tr_b16 v[28:29], v5 offset:0
    v_mfma_f32_16x16x32_bf16 v[156:159], v[40:43], v[52:55], 0
    ds_read_b64_tr_b16 v[30:31], v5 offset:1024
    v_mfma_f32_16x16x32_bf16 v[152:155], v[36:39], v[60:63], 0
    ds_read_b64_tr_b16 v[32:33], v5 offset:16384
    v_mfma_f32_16x16x32_bf16 v[160:163], v[40:43], v[60:63], 0
    ds_read_b64_tr_b16 v[34:35], v5 offset:17408
    v_mfma_f32_16x16x32_bf16 v[164:167], v[36:39], v[68:71], 0
    v_mfma_f32_16x16x32_bf16 v[172:175], v[40:43], v[68:71], 0
    v_mfma_f32_16x16x32_bf16 v[168:171], v[36:39], v[76:79], 0
    v_mfma_f32_16x16x32_bf16 v[176:179], v[40:43], v[76:79], 0
    s_waitcnt lgkmcnt(4)
    v_mfma_f32_16x16x32_bf16 v[180:183], v[44:47], v[52:55], 0
    v_mfma_f32_16x16x32_bf16 v[188:191], v[48:51], v[52:55], 0
    v_mfma_f32_16x16x32_bf16 v[184:187], v[44:47], v[60:63], 0
    v_mfma_f32_16x16x32_bf16 v[192:195], v[48:51], v[60:63], 0
    s_waitcnt lgkmcnt(0)
    s_barrier
    ds_read_b64_tr_b16 v[36:37], v2 offset:8192
    ds_read_b64_tr_b16 v[38:39], v2 offset:9216
    v_mfma_f32_16x16x32_bf16 v[196:199], v[44:47], v[68:71], 0
    ds_read_b64_tr_b16 v[40:41], v2 offset:24576
    ds_read_b64_tr_b16 v[42:43], v2 offset:25600
    v_mfma_f32_16x16x32_bf16 v[204:207], v[48:51], v[68:71], 0
    v_add_u32 v2, 49152, v2
    v_mfma_f32_16x16x32_bf16 v[200:203], v[44:47], v[76:79], 0
    v_mfma_f32_16x16x32_bf16 v[208:211], v[48:51], v[76:79], 0
    s_waitcnt lgkmcnt(4)
    v_mfma_f32_16x16x32_bf16 v[212:215], v[28:31], v[52:55], 0
    ds_read_b64_tr_b16 v[44:45], v3 offset:8192
    v_mfma_f32_16x16x32_bf16 v[220:223], v[32:35], v[52:55], 0
    ds_read_b64_tr_b16 v[46:47], v3 offset:9216
    v_mfma_f32_16x16x32_bf16 v[216:219], v[28:31], v[60:63], 0
    ds_read_b64_tr_b16 v[48:49], v3 offset:24576
    v_mfma_f32_16x16x32_bf16 v[224:227], v[32:35], v[60:63], 0
    ds_read_b64_tr_b16 v[50:51], v3 offset:25600
    v_mfma_f32_16x16x32_bf16 v[228:231], v[28:31], v[68:71], 0
    v_add_u32 v3, 49152, v3
    v_mfma_f32_16x16x32_bf16 v[236:239], v[32:35], v[68:71], 0
    v_mfma_f32_16x16x32_bf16 v[232:235], v[28:31], v[76:79], 0
    v_mfma_f32_16x16x32_bf16 v[240:243], v[32:35], v[76:79], 0
    s_waitcnt lgkmcnt(4)
    v_mfma_f32_16x16x32_bf16 v[116:119], v[36:39], v[56:59], v[116:119]
    ds_read_b64_tr_b16 v[28:29], v4 offset:8192
    v_mfma_f32_16x16x32_bf16 v[124:127], v[40:43], v[56:59], v[124:127]
    ds_read_b64_tr_b16 v[30:31], v4 offset:9216
    v_mfma_f32_16x16x32_bf16 v[120:123], v[36:39], v[64:67], v[120:123]
    ds_read_b64_tr_b16 v[32:33], v4 offset:24576
    v_mfma_f32_16x16x32_bf16 v[128:131], v[40:43], v[64:67], v[128:131]
    ds_read_b64_tr_b16 v[34:35], v4 offset:25600
    v_mfma_f32_16x16x32_bf16 v[132:135], v[36:39], v[72:75], v[132:135]
    v_add_u32 v4, 49152, v4
    v_mfma_f32_16x16x32_bf16 v[140:143], v[40:43], v[72:75], v[140:143]
    v_mfma_f32_16x16x32_bf16 v[136:139], v[36:39], v[80:83], v[136:139]
    v_mfma_f32_16x16x32_bf16 v[144:147], v[40:43], v[80:83], v[144:147]
    s_waitcnt lgkmcnt(4)
    v_mfma_f32_16x16x32_bf16 v[148:151], v[44:47], v[56:59], v[148:151]
    ds_read_b64_tr_b16 v[36:37], v5 offset:8192
    v_mfma_f32_16x16x32_bf16 v[156:159], v[48:51], v[56:59], v[156:159]
    ds_read_b64_tr_b16 v[38:39], v5 offset:9216
    v_mfma_f32_16x16x32_bf16 v[152:155], v[44:47], v[64:67], v[152:155]
    ds_read_b64_tr_b16 v[40:41], v5 offset:24576
    v_mfma_f32_16x16x32_bf16 v[160:163], v[48:51], v[64:67], v[160:163]
    ds_read_b64_tr_b16 v[42:43], v5 offset:25600
    v_mfma_f32_16x16x32_bf16 v[164:167], v[44:47], v[72:75], v[164:167]
    v_add_u32 v5, 49152, v5
    v_mfma_f32_16x16x32_bf16 v[172:175], v[48:51], v[72:75], v[172:175]
    v_mfma_f32_16x16x32_bf16 v[168:171], v[44:47], v[80:83], v[168:171]
    v_mfma_f32_16x16x32_bf16 v[176:179], v[48:51], v[80:83], v[176:179]
    s_waitcnt lgkmcnt(4)
    v_mfma_f32_16x16x32_bf16 v[180:183], v[28:31], v[56:59], v[180:183]
    v_mfma_f32_16x16x32_bf16 v[188:191], v[32:35], v[56:59], v[188:191]
    v_mfma_f32_16x16x32_bf16 v[184:187], v[28:31], v[64:67], v[184:187]
    v_mfma_f32_16x16x32_bf16 v[192:195], v[32:35], v[64:67], v[192:195]
    s_waitcnt lgkmcnt(0)
    s_barrier
    ds_read_b128 v[84:87], v6 offset:0
    ds_read_b128 v[88:91], v7 offset:0
    v_mfma_f32_16x16x32_bf16 v[196:199], v[28:31], v[72:75], v[196:199]
    ds_read_b128 v[92:95], v6 offset:2048
    ds_read_b128 v[96:99], v7 offset:2048
    v_mfma_f32_16x16x32_bf16 v[204:207], v[32:35], v[72:75], v[204:207]
    ds_read_b128 v[100:103], v8 offset:0
    ds_read_b128 v[104:107], v9 offset:0
    v_mfma_f32_16x16x32_bf16 v[200:203], v[28:31], v[80:83], v[200:203]
    ds_read_b128 v[108:111], v8 offset:2048
    ds_read_b128 v[112:115], v9 offset:2048
    v_mfma_f32_16x16x32_bf16 v[208:211], v[32:35], v[80:83], v[208:211]
    ds_read_b64_tr_b16 v[44:45], v2 offset:0
    ds_read_b64_tr_b16 v[46:47], v2 offset:1024
    s_waitcnt lgkmcnt(10)
    v_mfma_f32_16x16x32_bf16 v[212:215], v[36:39], v[56:59], v[212:215]
    ds_read_b64_tr_b16 v[48:49], v2 offset:8192
    ds_read_b64_tr_b16 v[50:51], v2 offset:9216
    v_mfma_f32_16x16x32_bf16 v[220:223], v[40:43], v[56:59], v[220:223]
    v_add_u32 v6, 49152, v6
    v_add_u32 v7, 49152, v7
    v_mfma_f32_16x16x32_bf16 v[216:219], v[36:39], v[64:67], v[216:219]
    v_add_u32 v8, 49152, v8
    v_add_u32 v9, 49152, v9
    v_mfma_f32_16x16x32_bf16 v[224:227], v[40:43], v[64:67], v[224:227]
    ds_read_b64_tr_b16 v[28:29], v2 offset:16384
    v_mfma_f32_16x16x32_bf16 v[228:231], v[36:39], v[72:75], v[228:231]
    ds_read_b64_tr_b16 v[30:31], v2 offset:17408
    v_mfma_f32_16x16x32_bf16 v[236:239], v[40:43], v[72:75], v[236:239]
    ds_read_b64_tr_b16 v[32:33], v2 offset:24576
    v_mfma_f32_16x16x32_bf16 v[232:235], v[36:39], v[80:83], v[232:235]
    s_waitcnt lgkmcnt(10)
    ds_read_b64_tr_b16 v[34:35], v2 offset:25600
    v_mfma_f32_16x16x32_bf16 v[240:243], v[40:43], v[80:83], v[240:243]
    v_add_u32 v2, 49152, v2
    s_waitcnt lgkmcnt(4)
    v_mfma_f32_16x16x32_bf16 v[116:119], v[44:47], v[84:87], v[116:119]
    ds_read_b64_tr_b16 v[36:37], v3 offset:0
    v_mfma_f32_16x16x32_bf16 v[116:119], v[48:51], v[88:91], v[116:119]
    ds_read_b64_tr_b16 v[38:39], v3 offset:1024
    v_mfma_f32_16x16x32_bf16 v[120:123], v[48:51], v[96:99], v[120:123]
    ds_read_b64_tr_b16 v[40:41], v3 offset:8192
    v_mfma_f32_16x16x32_bf16 v[120:123], v[44:47], v[92:95], v[120:123]
    ds_read_b64_tr_b16 v[42:43], v3 offset:9216
    v_mfma_f32_16x16x32_bf16 v[132:135], v[44:47], v[100:103], v[132:135]
    v_mfma_f32_16x16x32_bf16 v[132:135], v[48:51], v[104:107], v[132:135]
    v_mfma_f32_16x16x32_bf16 v[136:139], v[48:51], v[112:115], v[136:139]
    v_mfma_f32_16x16x32_bf16 v[136:139], v[44:47], v[108:111], v[136:139]
    s_waitcnt lgkmcnt(4)
    v_mfma_f32_16x16x32_bf16 v[124:127], v[28:31], v[84:87], v[124:127]
    ds_read_b64_tr_b16 v[44:45], v3 offset:16384
    v_mfma_f32_16x16x32_bf16 v[124:127], v[32:35], v[88:91], v[124:127]
    ds_read_b64_tr_b16 v[46:47], v3 offset:17408
    v_mfma_f32_16x16x32_bf16 v[128:131], v[32:35], v[96:99], v[128:131]
    ds_read_b64_tr_b16 v[48:49], v3 offset:24576
    v_mfma_f32_16x16x32_bf16 v[128:131], v[28:31], v[92:95], v[128:131]
    ds_read_b64_tr_b16 v[50:51], v3 offset:25600
    v_mfma_f32_16x16x32_bf16 v[140:143], v[28:31], v[100:103], v[140:143]
    v_add_u32 v3, 49152, v3
    v_mfma_f32_16x16x32_bf16 v[140:143], v[32:35], v[104:107], v[140:143]
    v_mfma_f32_16x16x32_bf16 v[144:147], v[32:35], v[112:115], v[144:147]
    v_mfma_f32_16x16x32_bf16 v[144:147], v[28:31], v[108:111], v[144:147]
    s_waitcnt lgkmcnt(4)
    v_mfma_f32_16x16x32_bf16 v[148:151], v[36:39], v[84:87], v[148:151]
    ds_read_b64_tr_b16 v[28:29], v4 offset:0
    v_mfma_f32_16x16x32_bf16 v[148:151], v[40:43], v[88:91], v[148:151]
    ds_read_b64_tr_b16 v[30:31], v4 offset:1024
    v_mfma_f32_16x16x32_bf16 v[152:155], v[40:43], v[96:99], v[152:155]
    ds_read_b64_tr_b16 v[32:33], v4 offset:8192
    v_mfma_f32_16x16x32_bf16 v[152:155], v[36:39], v[92:95], v[152:155]
    ds_read_b64_tr_b16 v[34:35], v4 offset:9216
    v_mfma_f32_16x16x32_bf16 v[164:167], v[36:39], v[100:103], v[164:167]
    v_mfma_f32_16x16x32_bf16 v[164:167], v[40:43], v[104:107], v[164:167]
    v_mfma_f32_16x16x32_bf16 v[168:171], v[40:43], v[112:115], v[168:171]
    v_mfma_f32_16x16x32_bf16 v[168:171], v[36:39], v[108:111], v[168:171]
    s_waitcnt lgkmcnt(4)
    v_mfma_f32_16x16x32_bf16 v[156:159], v[44:47], v[84:87], v[156:159]
    ds_read_b64_tr_b16 v[36:37], v4 offset:16384
    v_mfma_f32_16x16x32_bf16 v[156:159], v[48:51], v[88:91], v[156:159]
    ds_read_b64_tr_b16 v[38:39], v4 offset:17408
    v_mfma_f32_16x16x32_bf16 v[160:163], v[48:51], v[96:99], v[160:163]
    ds_read_b64_tr_b16 v[40:41], v4 offset:24576
    v_mfma_f32_16x16x32_bf16 v[160:163], v[44:47], v[92:95], v[160:163]
    ds_read_b64_tr_b16 v[42:43], v4 offset:25600
    v_mfma_f32_16x16x32_bf16 v[172:175], v[44:47], v[100:103], v[172:175]
    v_add_u32 v4, 49152, v4
    v_mfma_f32_16x16x32_bf16 v[172:175], v[48:51], v[104:107], v[172:175]
    v_mfma_f32_16x16x32_bf16 v[176:179], v[48:51], v[112:115], v[176:179]
    v_mfma_f32_16x16x32_bf16 v[176:179], v[44:47], v[108:111], v[176:179]
    s_waitcnt lgkmcnt(4)
    v_mfma_f32_16x16x32_bf16 v[180:183], v[28:31], v[84:87], v[180:183]
    ds_read_b64_tr_b16 v[44:45], v5 offset:0
    v_mfma_f32_16x16x32_bf16 v[180:183], v[32:35], v[88:91], v[180:183]
    ds_read_b64_tr_b16 v[46:47], v5 offset:1024
    v_mfma_f32_16x16x32_bf16 v[184:187], v[32:35], v[96:99], v[184:187]
    ds_read_b64_tr_b16 v[48:49], v5 offset:8192
    v_mfma_f32_16x16x32_bf16 v[184:187], v[28:31], v[92:95], v[184:187]
    ds_read_b64_tr_b16 v[50:51], v5 offset:9216
    v_mfma_f32_16x16x32_bf16 v[196:199], v[28:31], v[100:103], v[196:199]
    v_mfma_f32_16x16x32_bf16 v[196:199], v[32:35], v[104:107], v[196:199]
    v_mfma_f32_16x16x32_bf16 v[200:203], v[32:35], v[112:115], v[200:203]
    v_mfma_f32_16x16x32_bf16 v[200:203], v[28:31], v[108:111], v[200:203]
    s_waitcnt lgkmcnt(4)
    v_mfma_f32_16x16x32_bf16 v[188:191], v[36:39], v[84:87], v[188:191]
    ds_read_b64_tr_b16 v[28:29], v5 offset:16384
    v_mfma_f32_16x16x32_bf16 v[188:191], v[40:43], v[88:91], v[188:191]
    ds_read_b64_tr_b16 v[30:31], v5 offset:17408
    v_mfma_f32_16x16x32_bf16 v[192:195], v[40:43], v[96:99], v[192:195]
    ds_read_b64_tr_b16 v[32:33], v5 offset:24576
    v_mfma_f32_16x16x32_bf16 v[192:195], v[36:39], v[92:95], v[192:195]
    ds_read_b64_tr_b16 v[34:35], v5 offset:25600
    v_mfma_f32_16x16x32_bf16 v[204:207], v[36:39], v[100:103], v[204:207]
    v_add_u32 v5, 49152, v5
    v_mfma_f32_16x16x32_bf16 v[204:207], v[40:43], v[104:107], v[204:207]
    v_mfma_f32_16x16x32_bf16 v[208:211], v[40:43], v[112:115], v[208:211]
    v_mfma_f32_16x16x32_bf16 v[208:211], v[36:39], v[108:111], v[208:211]
    s_waitcnt lgkmcnt(4)
    v_mfma_f32_16x16x32_bf16 v[212:215], v[44:47], v[84:87], v[212:215]
    v_mfma_f32_16x16x32_bf16 v[212:215], v[48:51], v[88:91], v[212:215]
    v_mfma_f32_16x16x32_bf16 v[216:219], v[48:51], v[96:99], v[216:219]
    v_mfma_f32_16x16x32_bf16 v[216:219], v[44:47], v[92:95], v[216:219]
    s_waitcnt lgkmcnt(0)
    s_barrier
    ds_read_b128 v[52:55], v6 offset:0
    ds_read_b128 v[56:59], v7 offset:0
    v_mfma_f32_16x16x32_bf16 v[228:231], v[44:47], v[100:103], v[228:231]
    ds_read_b128 v[60:63], v6 offset:2048
    ds_read_b128 v[64:67], v7 offset:2048
    v_mfma_f32_16x16x32_bf16 v[228:231], v[48:51], v[104:107], v[228:231]
    ds_read_b128 v[68:71], v8 offset:0
    ds_read_b128 v[72:75], v9 offset:0
    v_mfma_f32_16x16x32_bf16 v[232:235], v[48:51], v[112:115], v[232:235]
    ds_read_b128 v[76:79], v8 offset:2048
    ds_read_b128 v[80:83], v9 offset:2048
    v_mfma_f32_16x16x32_bf16 v[232:235], v[44:47], v[108:111], v[232:235]
    ds_read_b64_tr_b16 v[36:37], v2 offset:0
    ds_read_b64_tr_b16 v[38:39], v2 offset:1024
    s_waitcnt lgkmcnt(10)
    v_mfma_f32_16x16x32_bf16 v[220:223], v[28:31], v[84:87], v[220:223]
    ds_read_b64_tr_b16 v[40:41], v2 offset:8192
    ds_read_b64_tr_b16 v[42:43], v2 offset:9216
    v_mfma_f32_16x16x32_bf16 v[220:223], v[32:35], v[88:91], v[220:223]
    v_subrev_u32 v6, 98304, v6
    v_subrev_u32 v7, 98304, v7
    v_mfma_f32_16x16x32_bf16 v[224:227], v[32:35], v[96:99], v[224:227]
    v_subrev_u32 v8, 98304, v8
    v_subrev_u32 v9, 98304, v9
    v_mfma_f32_16x16x32_bf16 v[224:227], v[28:31], v[92:95], v[224:227]
    ds_read_b64_tr_b16 v[44:45], v2 offset:16384
    v_mfma_f32_16x16x32_bf16 v[236:239], v[28:31], v[100:103], v[236:239]
    ds_read_b64_tr_b16 v[46:47], v2 offset:17408
    v_mfma_f32_16x16x32_bf16 v[236:239], v[32:35], v[104:107], v[236:239]
    ds_read_b64_tr_b16 v[48:49], v2 offset:24576
    v_mfma_f32_16x16x32_bf16 v[240:243], v[32:35], v[112:115], v[240:243]
    s_waitcnt lgkmcnt(10)
    ds_read_b64_tr_b16 v[50:51], v2 offset:25600
    v_mfma_f32_16x16x32_bf16 v[240:243], v[28:31], v[108:111], v[240:243]
    v_subrev_u32 v2, 98304, v2
    s_waitcnt lgkmcnt(4)
    v_mfma_f32_16x16x32_bf16 v[116:119], v[36:39], v[52:55], v[116:119]
    ds_read_b64_tr_b16 v[28:29], v3 offset:0
    v_mfma_f32_16x16x32_bf16 v[116:119], v[40:43], v[56:59], v[116:119]
    ds_read_b64_tr_b16 v[30:31], v3 offset:1024
    v_mfma_f32_16x16x32_bf16 v[120:123], v[40:43], v[64:67], v[120:123]
    ds_read_b64_tr_b16 v[32:33], v3 offset:8192
    v_mfma_f32_16x16x32_bf16 v[120:123], v[36:39], v[60:63], v[120:123]
    ds_read_b64_tr_b16 v[34:35], v3 offset:9216
    v_mfma_f32_16x16x32_bf16 v[132:135], v[36:39], v[68:71], v[132:135]
    v_mfma_f32_16x16x32_bf16 v[132:135], v[40:43], v[72:75], v[132:135]
    v_mfma_f32_16x16x32_bf16 v[136:139], v[40:43], v[80:83], v[136:139]
    v_mfma_f32_16x16x32_bf16 v[136:139], v[36:39], v[76:79], v[136:139]
    s_waitcnt lgkmcnt(4)
    v_mfma_f32_16x16x32_bf16 v[124:127], v[44:47], v[52:55], v[124:127]
    ds_read_b64_tr_b16 v[36:37], v3 offset:16384
    v_mfma_f32_16x16x32_bf16 v[124:127], v[48:51], v[56:59], v[124:127]
    ds_read_b64_tr_b16 v[38:39], v3 offset:17408
    v_mfma_f32_16x16x32_bf16 v[128:131], v[48:51], v[64:67], v[128:131]
    ds_read_b64_tr_b16 v[40:41], v3 offset:24576
    v_mfma_f32_16x16x32_bf16 v[128:131], v[44:47], v[60:63], v[128:131]
    ds_read_b64_tr_b16 v[42:43], v3 offset:25600
    v_mfma_f32_16x16x32_bf16 v[140:143], v[44:47], v[68:71], v[140:143]
    v_subrev_u32 v3, 98304, v3
    v_mfma_f32_16x16x32_bf16 v[140:143], v[48:51], v[72:75], v[140:143]
    v_mfma_f32_16x16x32_bf16 v[144:147], v[48:51], v[80:83], v[144:147]
    v_mfma_f32_16x16x32_bf16 v[144:147], v[44:47], v[76:79], v[144:147]
    s_waitcnt lgkmcnt(4)
    v_mfma_f32_16x16x32_bf16 v[148:151], v[28:31], v[52:55], v[148:151]
    ds_read_b64_tr_b16 v[44:45], v4 offset:0
    v_mfma_f32_16x16x32_bf16 v[148:151], v[32:35], v[56:59], v[148:151]
    ds_read_b64_tr_b16 v[46:47], v4 offset:1024
    v_mfma_f32_16x16x32_bf16 v[152:155], v[32:35], v[64:67], v[152:155]
    ds_read_b64_tr_b16 v[48:49], v4 offset:8192
    v_mfma_f32_16x16x32_bf16 v[152:155], v[28:31], v[60:63], v[152:155]
    ds_read_b64_tr_b16 v[50:51], v4 offset:9216
    v_mfma_f32_16x16x32_bf16 v[164:167], v[28:31], v[68:71], v[164:167]
    v_mfma_f32_16x16x32_bf16 v[164:167], v[32:35], v[72:75], v[164:167]
    v_mfma_f32_16x16x32_bf16 v[168:171], v[32:35], v[80:83], v[168:171]
    v_mfma_f32_16x16x32_bf16 v[168:171], v[28:31], v[76:79], v[168:171]
    s_waitcnt lgkmcnt(4)
    v_mfma_f32_16x16x32_bf16 v[156:159], v[36:39], v[52:55], v[156:159]
    ds_read_b64_tr_b16 v[28:29], v4 offset:16384
    v_mfma_f32_16x16x32_bf16 v[156:159], v[40:43], v[56:59], v[156:159]
    ds_read_b64_tr_b16 v[30:31], v4 offset:17408
    v_mfma_f32_16x16x32_bf16 v[160:163], v[40:43], v[64:67], v[160:163]
    ds_read_b64_tr_b16 v[32:33], v4 offset:24576
    v_mfma_f32_16x16x32_bf16 v[160:163], v[36:39], v[60:63], v[160:163]
    ds_read_b64_tr_b16 v[34:35], v4 offset:25600
    v_mfma_f32_16x16x32_bf16 v[172:175], v[36:39], v[68:71], v[172:175]
    v_subrev_u32 v4, 98304, v4
    v_mfma_f32_16x16x32_bf16 v[172:175], v[40:43], v[72:75], v[172:175]
    v_mfma_f32_16x16x32_bf16 v[176:179], v[40:43], v[80:83], v[176:179]
    v_mfma_f32_16x16x32_bf16 v[176:179], v[36:39], v[76:79], v[176:179]
    s_waitcnt lgkmcnt(4)
    v_mfma_f32_16x16x32_bf16 v[180:183], v[44:47], v[52:55], v[180:183]
    ds_read_b64_tr_b16 v[36:37], v5 offset:0
    v_mfma_f32_16x16x32_bf16 v[180:183], v[48:51], v[56:59], v[180:183]
    ds_read_b64_tr_b16 v[38:39], v5 offset:1024
    v_mfma_f32_16x16x32_bf16 v[184:187], v[48:51], v[64:67], v[184:187]
    ds_read_b64_tr_b16 v[40:41], v5 offset:8192
    v_mfma_f32_16x16x32_bf16 v[184:187], v[44:47], v[60:63], v[184:187]
    ds_read_b64_tr_b16 v[42:43], v5 offset:9216
    v_mfma_f32_16x16x32_bf16 v[196:199], v[44:47], v[68:71], v[196:199]
    v_mfma_f32_16x16x32_bf16 v[196:199], v[48:51], v[72:75], v[196:199]
    v_mfma_f32_16x16x32_bf16 v[200:203], v[48:51], v[80:83], v[200:203]
    v_mfma_f32_16x16x32_bf16 v[200:203], v[44:47], v[76:79], v[200:203]
    s_waitcnt lgkmcnt(4)
    v_mfma_f32_16x16x32_bf16 v[188:191], v[28:31], v[52:55], v[188:191]
    ds_read_b64_tr_b16 v[44:45], v5 offset:16384
    v_mfma_f32_16x16x32_bf16 v[188:191], v[32:35], v[56:59], v[188:191]
    ds_read_b64_tr_b16 v[46:47], v5 offset:17408
    v_mfma_f32_16x16x32_bf16 v[192:195], v[32:35], v[64:67], v[192:195]
    ds_read_b64_tr_b16 v[48:49], v5 offset:24576
    v_mfma_f32_16x16x32_bf16 v[192:195], v[28:31], v[60:63], v[192:195]
    ds_read_b64_tr_b16 v[50:51], v5 offset:25600
    v_mfma_f32_16x16x32_bf16 v[204:207], v[28:31], v[68:71], v[204:207]
    v_subrev_u32 v5, 98304, v5
    v_mfma_f32_16x16x32_bf16 v[204:207], v[32:35], v[72:75], v[204:207]
    v_mfma_f32_16x16x32_bf16 v[208:211], v[32:35], v[80:83], v[208:211]
    v_mfma_f32_16x16x32_bf16 v[208:211], v[28:31], v[76:79], v[208:211]
    s_waitcnt lgkmcnt(4)
    v_mfma_f32_16x16x32_bf16 v[212:215], v[36:39], v[52:55], v[212:215]
    v_mfma_f32_16x16x32_bf16 v[212:215], v[40:43], v[56:59], v[212:215]
    v_mfma_f32_16x16x32_bf16 v[216:219], v[40:43], v[64:67], v[216:219]
    v_mfma_f32_16x16x32_bf16 v[216:219], v[36:39], v[60:63], v[216:219]
    s_waitcnt lgkmcnt(0)
    s_barrier
    ds_read_b128 v[84:87], v6 offset:0
    ds_read_b128 v[88:91], v7 offset:0
    v_mfma_f32_16x16x32_bf16 v[228:231], v[36:39], v[68:71], v[228:231]
    ds_read_b128 v[92:95], v6 offset:2048
    ds_read_b128 v[96:99], v7 offset:2048
    v_mfma_f32_16x16x32_bf16 v[228:231], v[40:43], v[72:75], v[228:231]
    ds_read_b128 v[100:103], v8 offset:0
    ds_read_b128 v[104:107], v9 offset:0
    v_mfma_f32_16x16x32_bf16 v[232:235], v[40:43], v[80:83], v[232:235]
    ds_read_b128 v[108:111], v8 offset:2048
    ds_read_b128 v[112:115], v9 offset:2048
    v_mfma_f32_16x16x32_bf16 v[232:235], v[36:39], v[76:79], v[232:235]
    ds_read_b64_tr_b16 v[28:29], v2 offset:0
    ds_read_b64_tr_b16 v[30:31], v2 offset:1024
    s_waitcnt lgkmcnt(10)
    v_mfma_f32_16x16x32_bf16 v[220:223], v[44:47], v[52:55], v[220:223]
    ds_read_b64_tr_b16 v[32:33], v2 offset:8192
    ds_read_b64_tr_b16 v[34:35], v2 offset:9216
    v_mfma_f32_16x16x32_bf16 v[220:223], v[48:51], v[56:59], v[220:223]
    v_add_u32 v6, 49152, v6
    v_add_u32 v7, 49152, v7
    v_mfma_f32_16x16x32_bf16 v[224:227], v[48:51], v[64:67], v[224:227]
    v_add_u32 v8, 49152, v8
    v_add_u32 v9, 49152, v9
    v_mfma_f32_16x16x32_bf16 v[224:227], v[44:47], v[60:63], v[224:227]
    ds_read_b64_tr_b16 v[36:37], v2 offset:16384
    v_mfma_f32_16x16x32_bf16 v[236:239], v[44:47], v[68:71], v[236:239]
    ds_read_b64_tr_b16 v[38:39], v2 offset:17408
    v_mfma_f32_16x16x32_bf16 v[236:239], v[48:51], v[72:75], v[236:239]
    ds_read_b64_tr_b16 v[40:41], v2 offset:24576
    v_mfma_f32_16x16x32_bf16 v[240:243], v[48:51], v[80:83], v[240:243]
    s_waitcnt lgkmcnt(10)
    ds_read_b64_tr_b16 v[42:43], v2 offset:25600
    v_mfma_f32_16x16x32_bf16 v[240:243], v[44:47], v[76:79], v[240:243]
    v_add_u32 v2, 49152, v2
    s_waitcnt lgkmcnt(4)
    v_mfma_f32_16x16x32_bf16 v[116:119], v[28:31], v[84:87], v[116:119]
    ds_read_b64_tr_b16 v[44:45], v3 offset:0
    v_mfma_f32_16x16x32_bf16 v[116:119], v[32:35], v[88:91], v[116:119]
    ds_read_b64_tr_b16 v[46:47], v3 offset:1024
    v_mfma_f32_16x16x32_bf16 v[120:123], v[32:35], v[96:99], v[120:123]
    ds_read_b64_tr_b16 v[48:49], v3 offset:8192
    v_mfma_f32_16x16x32_bf16 v[120:123], v[28:31], v[92:95], v[120:123]
    ds_read_b64_tr_b16 v[50:51], v3 offset:9216
    v_mfma_f32_16x16x32_bf16 v[132:135], v[28:31], v[100:103], v[132:135]
    v_mfma_f32_16x16x32_bf16 v[132:135], v[32:35], v[104:107], v[132:135]
    v_mfma_f32_16x16x32_bf16 v[136:139], v[32:35], v[112:115], v[136:139]
    v_mfma_f32_16x16x32_bf16 v[136:139], v[28:31], v[108:111], v[136:139]
    s_waitcnt lgkmcnt(4)
    v_mfma_f32_16x16x32_bf16 v[124:127], v[36:39], v[84:87], v[124:127]
    ds_read_b64_tr_b16 v[28:29], v3 offset:16384
    v_mfma_f32_16x16x32_bf16 v[124:127], v[40:43], v[88:91], v[124:127]
    ds_read_b64_tr_b16 v[30:31], v3 offset:17408
    v_mfma_f32_16x16x32_bf16 v[128:131], v[40:43], v[96:99], v[128:131]
    ds_read_b64_tr_b16 v[32:33], v3 offset:24576
    v_mfma_f32_16x16x32_bf16 v[128:131], v[36:39], v[92:95], v[128:131]
    ds_read_b64_tr_b16 v[34:35], v3 offset:25600
    v_mfma_f32_16x16x32_bf16 v[140:143], v[36:39], v[100:103], v[140:143]
    v_add_u32 v3, 49152, v3
    v_mfma_f32_16x16x32_bf16 v[140:143], v[40:43], v[104:107], v[140:143]
    v_mfma_f32_16x16x32_bf16 v[144:147], v[40:43], v[112:115], v[144:147]
    v_mfma_f32_16x16x32_bf16 v[144:147], v[36:39], v[108:111], v[144:147]
    s_waitcnt lgkmcnt(4)
    v_mfma_f32_16x16x32_bf16 v[148:151], v[44:47], v[84:87], v[148:151]
    ds_read_b64_tr_b16 v[36:37], v4 offset:0
    v_mfma_f32_16x16x32_bf16 v[148:151], v[48:51], v[88:91], v[148:151]
    ds_read_b64_tr_b16 v[38:39], v4 offset:1024
    v_mfma_f32_16x16x32_bf16 v[152:155], v[48:51], v[96:99], v[152:155]
    ds_read_b64_tr_b16 v[40:41], v4 offset:8192
    v_mfma_f32_16x16x32_bf16 v[152:155], v[44:47], v[92:95], v[152:155]
    ds_read_b64_tr_b16 v[42:43], v4 offset:9216
    v_mfma_f32_16x16x32_bf16 v[164:167], v[44:47], v[100:103], v[164:167]
    v_mfma_f32_16x16x32_bf16 v[164:167], v[48:51], v[104:107], v[164:167]
    v_mfma_f32_16x16x32_bf16 v[168:171], v[48:51], v[112:115], v[168:171]
    v_mfma_f32_16x16x32_bf16 v[168:171], v[44:47], v[108:111], v[168:171]
    s_waitcnt lgkmcnt(4)
    v_mfma_f32_16x16x32_bf16 v[156:159], v[28:31], v[84:87], v[156:159]
    ds_read_b64_tr_b16 v[44:45], v4 offset:16384
    v_mfma_f32_16x16x32_bf16 v[156:159], v[32:35], v[88:91], v[156:159]
    ds_read_b64_tr_b16 v[46:47], v4 offset:17408
    v_mfma_f32_16x16x32_bf16 v[160:163], v[32:35], v[96:99], v[160:163]
    ds_read_b64_tr_b16 v[48:49], v4 offset:24576
    v_mfma_f32_16x16x32_bf16 v[160:163], v[28:31], v[92:95], v[160:163]
    ds_read_b64_tr_b16 v[50:51], v4 offset:25600
    v_mfma_f32_16x16x32_bf16 v[172:175], v[28:31], v[100:103], v[172:175]
    v_add_u32 v4, 49152, v4
    v_mfma_f32_16x16x32_bf16 v[172:175], v[32:35], v[104:107], v[172:175]
    v_mfma_f32_16x16x32_bf16 v[176:179], v[32:35], v[112:115], v[176:179]
    v_mfma_f32_16x16x32_bf16 v[176:179], v[28:31], v[108:111], v[176:179]
    s_waitcnt lgkmcnt(4)
    v_mfma_f32_16x16x32_bf16 v[180:183], v[36:39], v[84:87], v[180:183]
    ds_read_b64_tr_b16 v[28:29], v5 offset:0
    v_mfma_f32_16x16x32_bf16 v[180:183], v[40:43], v[88:91], v[180:183]
    ds_read_b64_tr_b16 v[30:31], v5 offset:1024
    v_mfma_f32_16x16x32_bf16 v[184:187], v[40:43], v[96:99], v[184:187]
    ds_read_b64_tr_b16 v[32:33], v5 offset:8192
    v_mfma_f32_16x16x32_bf16 v[184:187], v[36:39], v[92:95], v[184:187]
    ds_read_b64_tr_b16 v[34:35], v5 offset:9216
    v_mfma_f32_16x16x32_bf16 v[196:199], v[36:39], v[100:103], v[196:199]
    v_mfma_f32_16x16x32_bf16 v[196:199], v[40:43], v[104:107], v[196:199]
    v_mfma_f32_16x16x32_bf16 v[200:203], v[40:43], v[112:115], v[200:203]
    v_mfma_f32_16x16x32_bf16 v[200:203], v[36:39], v[108:111], v[200:203]
    s_waitcnt lgkmcnt(4)
    v_mfma_f32_16x16x32_bf16 v[188:191], v[44:47], v[84:87], v[188:191]
    ds_read_b64_tr_b16 v[36:37], v5 offset:16384
    v_mfma_f32_16x16x32_bf16 v[188:191], v[48:51], v[88:91], v[188:191]
    ds_read_b64_tr_b16 v[38:39], v5 offset:17408
    v_mfma_f32_16x16x32_bf16 v[192:195], v[48:51], v[96:99], v[192:195]
    ds_read_b64_tr_b16 v[40:41], v5 offset:24576
    v_mfma_f32_16x16x32_bf16 v[192:195], v[44:47], v[92:95], v[192:195]
    ds_read_b64_tr_b16 v[42:43], v5 offset:25600
    v_mfma_f32_16x16x32_bf16 v[204:207], v[44:47], v[100:103], v[204:207]
    v_add_u32 v5, 49152, v5
    v_mfma_f32_16x16x32_bf16 v[204:207], v[48:51], v[104:107], v[204:207]
    v_mfma_f32_16x16x32_bf16 v[208:211], v[48:51], v[112:115], v[208:211]
    v_mfma_f32_16x16x32_bf16 v[208:211], v[44:47], v[108:111], v[208:211]
    s_waitcnt lgkmcnt(4)
    v_mfma_f32_16x16x32_bf16 v[212:215], v[28:31], v[84:87], v[212:215]
    v_mfma_f32_16x16x32_bf16 v[212:215], v[32:35], v[88:91], v[212:215]
    v_mfma_f32_16x16x32_bf16 v[216:219], v[32:35], v[96:99], v[216:219]
    v_mfma_f32_16x16x32_bf16 v[216:219], v[28:31], v[92:95], v[216:219]
    s_waitcnt lgkmcnt(0)
    s_barrier
    ds_read_b128 v[52:55], v6 offset:0
    ds_read_b128 v[56:59], v7 offset:0
    v_mfma_f32_16x16x32_bf16 v[228:231], v[28:31], v[100:103], v[228:231]
    ds_read_b128 v[60:63], v6 offset:2048
    ds_read_b128 v[64:67], v7 offset:2048
    v_mfma_f32_16x16x32_bf16 v[228:231], v[32:35], v[104:107], v[228:231]
    ds_read_b128 v[68:71], v8 offset:0
    ds_read_b128 v[72:75], v9 offset:0
    v_mfma_f32_16x16x32_bf16 v[232:235], v[32:35], v[112:115], v[232:235]
    ds_read_b128 v[76:79], v8 offset:2048
    ds_read_b128 v[80:83], v9 offset:2048
    v_mfma_f32_16x16x32_bf16 v[232:235], v[28:31], v[108:111], v[232:235]
    ds_read_b64_tr_b16 v[44:45], v2 offset:0
    ds_read_b64_tr_b16 v[46:47], v2 offset:1024
    s_waitcnt lgkmcnt(10)
    v_mfma_f32_16x16x32_bf16 v[220:223], v[36:39], v[84:87], v[220:223]
    ds_read_b64_tr_b16 v[48:49], v2 offset:8192
    ds_read_b64_tr_b16 v[50:51], v2 offset:9216
    v_mfma_f32_16x16x32_bf16 v[220:223], v[40:43], v[88:91], v[220:223]
    v_add_u32 v6, 49152, v6
    v_add_u32 v7, 49152, v7
    v_mfma_f32_16x16x32_bf16 v[224:227], v[40:43], v[96:99], v[224:227]
    v_add_u32 v8, 49152, v8
    v_add_u32 v9, 49152, v9
    v_mfma_f32_16x16x32_bf16 v[224:227], v[36:39], v[92:95], v[224:227]
    ds_read_b64_tr_b16 v[28:29], v2 offset:16384
    v_mfma_f32_16x16x32_bf16 v[236:239], v[36:39], v[100:103], v[236:239]
    ds_read_b64_tr_b16 v[30:31], v2 offset:17408
    v_mfma_f32_16x16x32_bf16 v[236:239], v[40:43], v[104:107], v[236:239]
    ds_read_b64_tr_b16 v[32:33], v2 offset:24576
    v_mfma_f32_16x16x32_bf16 v[240:243], v[40:43], v[112:115], v[240:243]
    s_waitcnt lgkmcnt(10)
    ds_read_b64_tr_b16 v[34:35], v2 offset:25600
    v_mfma_f32_16x16x32_bf16 v[240:243], v[36:39], v[108:111], v[240:243]
    v_add_u32 v2, 49152, v2
    s_waitcnt lgkmcnt(4)
    v_mfma_f32_16x16x32_bf16 v[116:119], v[44:47], v[52:55], v[116:119]
    ds_read_b64_tr_b16 v[36:37], v3 offset:0
    v_mfma_f32_16x16x32_bf16 v[116:119], v[48:51], v[56:59], v[116:119]
    ds_read_b64_tr_b16 v[38:39], v3 offset:1024
    v_mfma_f32_16x16x32_bf16 v[120:123], v[48:51], v[64:67], v[120:123]
    ds_read_b64_tr_b16 v[40:41], v3 offset:8192
    v_mfma_f32_16x16x32_bf16 v[120:123], v[44:47], v[60:63], v[120:123]
    ds_read_b64_tr_b16 v[42:43], v3 offset:9216
    v_mfma_f32_16x16x32_bf16 v[132:135], v[44:47], v[68:71], v[132:135]
    v_mfma_f32_16x16x32_bf16 v[132:135], v[48:51], v[72:75], v[132:135]
    v_mfma_f32_16x16x32_bf16 v[136:139], v[48:51], v[80:83], v[136:139]
    v_mfma_f32_16x16x32_bf16 v[136:139], v[44:47], v[76:79], v[136:139]
    s_waitcnt lgkmcnt(4)
    v_mfma_f32_16x16x32_bf16 v[124:127], v[28:31], v[52:55], v[124:127]
    ds_read_b64_tr_b16 v[44:45], v3 offset:16384
    v_mfma_f32_16x16x32_bf16 v[124:127], v[32:35], v[56:59], v[124:127]
    ds_read_b64_tr_b16 v[46:47], v3 offset:17408
    v_mfma_f32_16x16x32_bf16 v[128:131], v[32:35], v[64:67], v[128:131]
    ds_read_b64_tr_b16 v[48:49], v3 offset:24576
    v_mfma_f32_16x16x32_bf16 v[128:131], v[28:31], v[60:63], v[128:131]
    ds_read_b64_tr_b16 v[50:51], v3 offset:25600
    v_mfma_f32_16x16x32_bf16 v[140:143], v[28:31], v[68:71], v[140:143]
    v_add_u32 v3, 49152, v3
    v_mfma_f32_16x16x32_bf16 v[140:143], v[32:35], v[72:75], v[140:143]
    v_mfma_f32_16x16x32_bf16 v[144:147], v[32:35], v[80:83], v[144:147]
    v_mfma_f32_16x16x32_bf16 v[144:147], v[28:31], v[76:79], v[144:147]
    s_waitcnt lgkmcnt(4)
    v_mfma_f32_16x16x32_bf16 v[148:151], v[36:39], v[52:55], v[148:151]
    ds_read_b64_tr_b16 v[28:29], v4 offset:0
    v_mfma_f32_16x16x32_bf16 v[148:151], v[40:43], v[56:59], v[148:151]
    ds_read_b64_tr_b16 v[30:31], v4 offset:1024
    v_mfma_f32_16x16x32_bf16 v[152:155], v[40:43], v[64:67], v[152:155]
    ds_read_b64_tr_b16 v[32:33], v4 offset:8192
    v_mfma_f32_16x16x32_bf16 v[152:155], v[36:39], v[60:63], v[152:155]
    ds_read_b64_tr_b16 v[34:35], v4 offset:9216
    v_mfma_f32_16x16x32_bf16 v[164:167], v[36:39], v[68:71], v[164:167]
    v_mfma_f32_16x16x32_bf16 v[164:167], v[40:43], v[72:75], v[164:167]
    v_mfma_f32_16x16x32_bf16 v[168:171], v[40:43], v[80:83], v[168:171]
    v_mfma_f32_16x16x32_bf16 v[168:171], v[36:39], v[76:79], v[168:171]
    s_waitcnt lgkmcnt(4)
    v_mfma_f32_16x16x32_bf16 v[156:159], v[44:47], v[52:55], v[156:159]
    ds_read_b64_tr_b16 v[36:37], v4 offset:16384
    v_mfma_f32_16x16x32_bf16 v[156:159], v[48:51], v[56:59], v[156:159]
    ds_read_b64_tr_b16 v[38:39], v4 offset:17408
    v_mfma_f32_16x16x32_bf16 v[160:163], v[48:51], v[64:67], v[160:163]
    ds_read_b64_tr_b16 v[40:41], v4 offset:24576
    v_mfma_f32_16x16x32_bf16 v[160:163], v[44:47], v[60:63], v[160:163]
    ds_read_b64_tr_b16 v[42:43], v4 offset:25600
    v_mfma_f32_16x16x32_bf16 v[172:175], v[44:47], v[68:71], v[172:175]
    v_add_u32 v4, 49152, v4
    v_mfma_f32_16x16x32_bf16 v[172:175], v[48:51], v[72:75], v[172:175]
    v_mfma_f32_16x16x32_bf16 v[176:179], v[48:51], v[80:83], v[176:179]
    v_mfma_f32_16x16x32_bf16 v[176:179], v[44:47], v[76:79], v[176:179]
    s_waitcnt lgkmcnt(4)
    v_mfma_f32_16x16x32_bf16 v[180:183], v[28:31], v[52:55], v[180:183]
    ds_read_b64_tr_b16 v[44:45], v5 offset:0
    v_mfma_f32_16x16x32_bf16 v[180:183], v[32:35], v[56:59], v[180:183]
    ds_read_b64_tr_b16 v[46:47], v5 offset:1024
    v_mfma_f32_16x16x32_bf16 v[184:187], v[32:35], v[64:67], v[184:187]
    ds_read_b64_tr_b16 v[48:49], v5 offset:8192
    v_mfma_f32_16x16x32_bf16 v[184:187], v[28:31], v[60:63], v[184:187]
    ds_read_b64_tr_b16 v[50:51], v5 offset:9216
    v_mfma_f32_16x16x32_bf16 v[196:199], v[28:31], v[68:71], v[196:199]
    v_mfma_f32_16x16x32_bf16 v[196:199], v[32:35], v[72:75], v[196:199]
    v_mfma_f32_16x16x32_bf16 v[200:203], v[32:35], v[80:83], v[200:203]
    v_mfma_f32_16x16x32_bf16 v[200:203], v[28:31], v[76:79], v[200:203]
    s_waitcnt lgkmcnt(4)
    v_mfma_f32_16x16x32_bf16 v[188:191], v[36:39], v[52:55], v[188:191]
    ds_read_b64_tr_b16 v[28:29], v5 offset:16384
    v_mfma_f32_16x16x32_bf16 v[188:191], v[40:43], v[56:59], v[188:191]
    ds_read_b64_tr_b16 v[30:31], v5 offset:17408
    v_mfma_f32_16x16x32_bf16 v[192:195], v[40:43], v[64:67], v[192:195]
    ds_read_b64_tr_b16 v[32:33], v5 offset:24576
    v_mfma_f32_16x16x32_bf16 v[192:195], v[36:39], v[60:63], v[192:195]
    ds_read_b64_tr_b16 v[34:35], v5 offset:25600
    v_mfma_f32_16x16x32_bf16 v[204:207], v[36:39], v[68:71], v[204:207]
    v_add_u32 v5, 49152, v5
    v_mfma_f32_16x16x32_bf16 v[204:207], v[40:43], v[72:75], v[204:207]
    v_mfma_f32_16x16x32_bf16 v[208:211], v[40:43], v[80:83], v[208:211]
    v_mfma_f32_16x16x32_bf16 v[208:211], v[36:39], v[76:79], v[208:211]
    s_waitcnt lgkmcnt(4)
    v_mfma_f32_16x16x32_bf16 v[212:215], v[44:47], v[52:55], v[212:215]
    v_mfma_f32_16x16x32_bf16 v[212:215], v[48:51], v[56:59], v[212:215]
    v_mfma_f32_16x16x32_bf16 v[216:219], v[48:51], v[64:67], v[216:219]
    v_mfma_f32_16x16x32_bf16 v[216:219], v[44:47], v[60:63], v[216:219]
    s_waitcnt lgkmcnt(0)
    s_barrier
    ds_read_b128 v[84:87], v6 offset:0
    ds_read_b128 v[88:91], v7 offset:0
    v_mfma_f32_16x16x32_bf16 v[228:231], v[44:47], v[68:71], v[228:231]
    ds_read_b128 v[92:95], v6 offset:2048
    ds_read_b128 v[96:99], v7 offset:2048
    v_mfma_f32_16x16x32_bf16 v[228:231], v[48:51], v[72:75], v[228:231]
    ds_read_b128 v[100:103], v8 offset:0
    ds_read_b128 v[104:107], v9 offset:0
    v_mfma_f32_16x16x32_bf16 v[232:235], v[48:51], v[80:83], v[232:235]
    ds_read_b128 v[108:111], v8 offset:2048
    ds_read_b128 v[112:115], v9 offset:2048
    v_mfma_f32_16x16x32_bf16 v[232:235], v[44:47], v[76:79], v[232:235]
    ds_read_b64_tr_b16 v[36:37], v2 offset:0
    ds_read_b64_tr_b16 v[38:39], v2 offset:1024
    s_waitcnt lgkmcnt(10)
    v_mfma_f32_16x16x32_bf16 v[220:223], v[28:31], v[52:55], v[220:223]
    ds_read_b64_tr_b16 v[40:41], v2 offset:8192
    ds_read_b64_tr_b16 v[42:43], v2 offset:9216
    v_mfma_f32_16x16x32_bf16 v[220:223], v[32:35], v[56:59], v[220:223]
    v_subrev_u32 v6, 98304, v6
    v_subrev_u32 v7, 98304, v7
    v_mfma_f32_16x16x32_bf16 v[224:227], v[32:35], v[64:67], v[224:227]
    v_subrev_u32 v8, 98304, v8
    v_subrev_u32 v9, 98304, v9
    v_mfma_f32_16x16x32_bf16 v[224:227], v[28:31], v[60:63], v[224:227]
    ds_read_b64_tr_b16 v[44:45], v2 offset:16384
    v_mfma_f32_16x16x32_bf16 v[236:239], v[28:31], v[68:71], v[236:239]
    ds_read_b64_tr_b16 v[46:47], v2 offset:17408
    v_mfma_f32_16x16x32_bf16 v[236:239], v[32:35], v[72:75], v[236:239]
    ds_read_b64_tr_b16 v[48:49], v2 offset:24576
    v_mfma_f32_16x16x32_bf16 v[240:243], v[32:35], v[80:83], v[240:243]
    s_waitcnt lgkmcnt(10)
    ds_read_b64_tr_b16 v[50:51], v2 offset:25600
    v_mfma_f32_16x16x32_bf16 v[240:243], v[28:31], v[76:79], v[240:243]
    v_subrev_u32 v2, 98304, v2
    s_waitcnt lgkmcnt(4)
    v_mfma_f32_16x16x32_bf16 v[116:119], v[36:39], v[84:87], v[116:119]
    ds_read_b64_tr_b16 v[28:29], v3 offset:0
    v_mfma_f32_16x16x32_bf16 v[116:119], v[40:43], v[88:91], v[116:119]
    ds_read_b64_tr_b16 v[30:31], v3 offset:1024
    v_mfma_f32_16x16x32_bf16 v[120:123], v[40:43], v[96:99], v[120:123]
    ds_read_b64_tr_b16 v[32:33], v3 offset:8192
    v_mfma_f32_16x16x32_bf16 v[120:123], v[36:39], v[92:95], v[120:123]
    ds_read_b64_tr_b16 v[34:35], v3 offset:9216
    v_mfma_f32_16x16x32_bf16 v[132:135], v[36:39], v[100:103], v[132:135]
    v_mfma_f32_16x16x32_bf16 v[132:135], v[40:43], v[104:107], v[132:135]
    v_mfma_f32_16x16x32_bf16 v[136:139], v[40:43], v[112:115], v[136:139]
    v_mfma_f32_16x16x32_bf16 v[136:139], v[36:39], v[108:111], v[136:139]
    s_waitcnt lgkmcnt(4)
    v_mfma_f32_16x16x32_bf16 v[124:127], v[44:47], v[84:87], v[124:127]
    ds_read_b64_tr_b16 v[36:37], v3 offset:16384
    v_mfma_f32_16x16x32_bf16 v[124:127], v[48:51], v[88:91], v[124:127]
    ds_read_b64_tr_b16 v[38:39], v3 offset:17408
    v_mfma_f32_16x16x32_bf16 v[128:131], v[48:51], v[96:99], v[128:131]
    ds_read_b64_tr_b16 v[40:41], v3 offset:24576
    v_mfma_f32_16x16x32_bf16 v[128:131], v[44:47], v[92:95], v[128:131]
    ds_read_b64_tr_b16 v[42:43], v3 offset:25600
    v_mfma_f32_16x16x32_bf16 v[140:143], v[44:47], v[100:103], v[140:143]
    v_subrev_u32 v3, 98304, v3
    v_mfma_f32_16x16x32_bf16 v[140:143], v[48:51], v[104:107], v[140:143]
    v_mfma_f32_16x16x32_bf16 v[144:147], v[48:51], v[112:115], v[144:147]
    v_mfma_f32_16x16x32_bf16 v[144:147], v[44:47], v[108:111], v[144:147]
    s_waitcnt lgkmcnt(4)
    v_mfma_f32_16x16x32_bf16 v[148:151], v[28:31], v[84:87], v[148:151]
    ds_read_b64_tr_b16 v[44:45], v4 offset:0
    v_mfma_f32_16x16x32_bf16 v[148:151], v[32:35], v[88:91], v[148:151]
    ds_read_b64_tr_b16 v[46:47], v4 offset:1024
    v_mfma_f32_16x16x32_bf16 v[152:155], v[32:35], v[96:99], v[152:155]
    ds_read_b64_tr_b16 v[48:49], v4 offset:8192
    v_mfma_f32_16x16x32_bf16 v[152:155], v[28:31], v[92:95], v[152:155]
    ds_read_b64_tr_b16 v[50:51], v4 offset:9216
    v_mfma_f32_16x16x32_bf16 v[164:167], v[28:31], v[100:103], v[164:167]
    v_mfma_f32_16x16x32_bf16 v[164:167], v[32:35], v[104:107], v[164:167]
    v_mfma_f32_16x16x32_bf16 v[168:171], v[32:35], v[112:115], v[168:171]
    v_mfma_f32_16x16x32_bf16 v[168:171], v[28:31], v[108:111], v[168:171]
    s_waitcnt lgkmcnt(4)
    v_mfma_f32_16x16x32_bf16 v[156:159], v[36:39], v[84:87], v[156:159]
    ds_read_b64_tr_b16 v[28:29], v4 offset:16384
    v_mfma_f32_16x16x32_bf16 v[156:159], v[40:43], v[88:91], v[156:159]
    ds_read_b64_tr_b16 v[30:31], v4 offset:17408
    v_mfma_f32_16x16x32_bf16 v[160:163], v[40:43], v[96:99], v[160:163]
    ds_read_b64_tr_b16 v[32:33], v4 offset:24576
    v_mfma_f32_16x16x32_bf16 v[160:163], v[36:39], v[92:95], v[160:163]
    ds_read_b64_tr_b16 v[34:35], v4 offset:25600
    v_mfma_f32_16x16x32_bf16 v[172:175], v[36:39], v[100:103], v[172:175]
    v_subrev_u32 v4, 98304, v4
    v_mfma_f32_16x16x32_bf16 v[172:175], v[40:43], v[104:107], v[172:175]
    v_mfma_f32_16x16x32_bf16 v[176:179], v[40:43], v[112:115], v[176:179]
    v_mfma_f32_16x16x32_bf16 v[176:179], v[36:39], v[108:111], v[176:179]
    s_waitcnt lgkmcnt(4)
    v_mfma_f32_16x16x32_bf16 v[180:183], v[44:47], v[84:87], v[180:183]
    ds_read_b64_tr_b16 v[36:37], v5 offset:0
    v_mfma_f32_16x16x32_bf16 v[180:183], v[48:51], v[88:91], v[180:183]
    ds_read_b64_tr_b16 v[38:39], v5 offset:1024
    v_mfma_f32_16x16x32_bf16 v[184:187], v[48:51], v[96:99], v[184:187]
    ds_read_b64_tr_b16 v[40:41], v5 offset:8192
    v_mfma_f32_16x16x32_bf16 v[184:187], v[44:47], v[92:95], v[184:187]
    ds_read_b64_tr_b16 v[42:43], v5 offset:9216
    v_mfma_f32_16x16x32_bf16 v[196:199], v[44:47], v[100:103], v[196:199]
    v_mfma_f32_16x16x32_bf16 v[196:199], v[48:51], v[104:107], v[196:199]
    v_mfma_f32_16x16x32_bf16 v[200:203], v[48:51], v[112:115], v[200:203]
    v_mfma_f32_16x16x32_bf16 v[200:203], v[44:47], v[108:111], v[200:203]
    s_waitcnt lgkmcnt(4)
    v_mfma_f32_16x16x32_bf16 v[188:191], v[28:31], v[84:87], v[188:191]
    ds_read_b64_tr_b16 v[44:45], v5 offset:16384
    v_mfma_f32_16x16x32_bf16 v[188:191], v[32:35], v[88:91], v[188:191]
    ds_read_b64_tr_b16 v[46:47], v5 offset:17408
    v_mfma_f32_16x16x32_bf16 v[192:195], v[32:35], v[96:99], v[192:195]
    ds_read_b64_tr_b16 v[48:49], v5 offset:24576
    v_mfma_f32_16x16x32_bf16 v[192:195], v[28:31], v[92:95], v[192:195]
    ds_read_b64_tr_b16 v[50:51], v5 offset:25600
    v_mfma_f32_16x16x32_bf16 v[204:207], v[28:31], v[100:103], v[204:207]
    v_subrev_u32 v5, 98304, v5
    v_mfma_f32_16x16x32_bf16 v[204:207], v[32:35], v[104:107], v[204:207]
    v_mfma_f32_16x16x32_bf16 v[208:211], v[32:35], v[112:115], v[208:211]
    v_mfma_f32_16x16x32_bf16 v[208:211], v[28:31], v[108:111], v[208:211]
    s_waitcnt lgkmcnt(4)
    v_mfma_f32_16x16x32_bf16 v[212:215], v[36:39], v[84:87], v[212:215]
    v_mfma_f32_16x16x32_bf16 v[212:215], v[40:43], v[88:91], v[212:215]
    v_mfma_f32_16x16x32_bf16 v[216:219], v[40:43], v[96:99], v[216:219]
    v_mfma_f32_16x16x32_bf16 v[216:219], v[36:39], v[92:95], v[216:219]
    s_waitcnt lgkmcnt(0)
    s_barrier
    ds_read_b128 v[52:55], v6 offset:0
    ds_read_b128 v[56:59], v7 offset:0
    v_mfma_f32_16x16x32_bf16 v[228:231], v[36:39], v[100:103], v[228:231]
    ds_read_b128 v[60:63], v6 offset:2048
    ds_read_b128 v[64:67], v7 offset:2048
    v_mfma_f32_16x16x32_bf16 v[228:231], v[40:43], v[104:107], v[228:231]
    ds_read_b128 v[68:71], v8 offset:0
    ds_read_b128 v[72:75], v9 offset:0
    v_mfma_f32_16x16x32_bf16 v[232:235], v[40:43], v[112:115], v[232:235]
    ds_read_b128 v[76:79], v8 offset:2048
    ds_read_b128 v[80:83], v9 offset:2048
    v_mfma_f32_16x16x32_bf16 v[232:235], v[36:39], v[108:111], v[232:235]
    ds_read_b64_tr_b16 v[28:29], v2 offset:0
    ds_read_b64_tr_b16 v[30:31], v2 offset:1024
    s_waitcnt lgkmcnt(10)
    v_mfma_f32_16x16x32_bf16 v[220:223], v[44:47], v[84:87], v[220:223]
    ds_read_b64_tr_b16 v[32:33], v2 offset:8192
    ds_read_b64_tr_b16 v[34:35], v2 offset:9216
    v_mfma_f32_16x16x32_bf16 v[220:223], v[48:51], v[88:91], v[220:223]
    v_add_u32 v6, 49152, v6
    v_add_u32 v7, 49152, v7
    v_mfma_f32_16x16x32_bf16 v[224:227], v[48:51], v[96:99], v[224:227]
    v_add_u32 v8, 49152, v8
    v_add_u32 v9, 49152, v9
    v_mfma_f32_16x16x32_bf16 v[224:227], v[44:47], v[92:95], v[224:227]
    ds_read_b64_tr_b16 v[36:37], v2 offset:16384
    v_mfma_f32_16x16x32_bf16 v[236:239], v[44:47], v[100:103], v[236:239]
    ds_read_b64_tr_b16 v[38:39], v2 offset:17408
    v_mfma_f32_16x16x32_bf16 v[236:239], v[48:51], v[104:107], v[236:239]
    ds_read_b64_tr_b16 v[40:41], v2 offset:24576
    v_mfma_f32_16x16x32_bf16 v[240:243], v[48:51], v[112:115], v[240:243]
    s_waitcnt lgkmcnt(10)
    ds_read_b64_tr_b16 v[42:43], v2 offset:25600
    v_mfma_f32_16x16x32_bf16 v[240:243], v[44:47], v[108:111], v[240:243]
    v_add_u32 v2, 49152, v2
    s_waitcnt lgkmcnt(4)
    v_mfma_f32_16x16x32_bf16 v[116:119], v[28:31], v[52:55], v[116:119]
    ds_read_b64_tr_b16 v[44:45], v3 offset:0
    v_mfma_f32_16x16x32_bf16 v[116:119], v[32:35], v[56:59], v[116:119]
    ds_read_b64_tr_b16 v[46:47], v3 offset:1024
    v_mfma_f32_16x16x32_bf16 v[120:123], v[32:35], v[64:67], v[120:123]
    ds_read_b64_tr_b16 v[48:49], v3 offset:8192
    v_mfma_f32_16x16x32_bf16 v[120:123], v[28:31], v[60:63], v[120:123]
    ds_read_b64_tr_b16 v[50:51], v3 offset:9216
    v_mfma_f32_16x16x32_bf16 v[132:135], v[28:31], v[68:71], v[132:135]
    v_mfma_f32_16x16x32_bf16 v[132:135], v[32:35], v[72:75], v[132:135]
    v_mfma_f32_16x16x32_bf16 v[136:139], v[32:35], v[80:83], v[136:139]
    v_mfma_f32_16x16x32_bf16 v[136:139], v[28:31], v[76:79], v[136:139]
    s_waitcnt lgkmcnt(4)
    v_mfma_f32_16x16x32_bf16 v[124:127], v[36:39], v[52:55], v[124:127]
    ds_read_b64_tr_b16 v[28:29], v3 offset:16384
    v_mfma_f32_16x16x32_bf16 v[124:127], v[40:43], v[56:59], v[124:127]
    ds_read_b64_tr_b16 v[30:31], v3 offset:17408
    v_mfma_f32_16x16x32_bf16 v[128:131], v[40:43], v[64:67], v[128:131]
    ds_read_b64_tr_b16 v[32:33], v3 offset:24576
    v_mfma_f32_16x16x32_bf16 v[128:131], v[36:39], v[60:63], v[128:131]
    ds_read_b64_tr_b16 v[34:35], v3 offset:25600
    v_mfma_f32_16x16x32_bf16 v[140:143], v[36:39], v[68:71], v[140:143]
    v_add_u32 v3, 49152, v3
    v_mfma_f32_16x16x32_bf16 v[140:143], v[40:43], v[72:75], v[140:143]
    v_mfma_f32_16x16x32_bf16 v[144:147], v[40:43], v[80:83], v[144:147]
    v_mfma_f32_16x16x32_bf16 v[144:147], v[36:39], v[76:79], v[144:147]
    s_waitcnt lgkmcnt(4)
    v_mfma_f32_16x16x32_bf16 v[148:151], v[44:47], v[52:55], v[148:151]
    ds_read_b64_tr_b16 v[36:37], v4 offset:0
    v_mfma_f32_16x16x32_bf16 v[148:151], v[48:51], v[56:59], v[148:151]
    ds_read_b64_tr_b16 v[38:39], v4 offset:1024
    v_mfma_f32_16x16x32_bf16 v[152:155], v[48:51], v[64:67], v[152:155]
    ds_read_b64_tr_b16 v[40:41], v4 offset:8192
    v_mfma_f32_16x16x32_bf16 v[152:155], v[44:47], v[60:63], v[152:155]
    ds_read_b64_tr_b16 v[42:43], v4 offset:9216
    v_mfma_f32_16x16x32_bf16 v[164:167], v[44:47], v[68:71], v[164:167]
    v_mfma_f32_16x16x32_bf16 v[164:167], v[48:51], v[72:75], v[164:167]
    v_mfma_f32_16x16x32_bf16 v[168:171], v[48:51], v[80:83], v[168:171]
    v_mfma_f32_16x16x32_bf16 v[168:171], v[44:47], v[76:79], v[168:171]
    s_waitcnt lgkmcnt(4)
    v_mfma_f32_16x16x32_bf16 v[156:159], v[28:31], v[52:55], v[156:159]
    ds_read_b64_tr_b16 v[44:45], v4 offset:16384
    v_mfma_f32_16x16x32_bf16 v[156:159], v[32:35], v[56:59], v[156:159]
    ds_read_b64_tr_b16 v[46:47], v4 offset:17408
    v_mfma_f32_16x16x32_bf16 v[160:163], v[32:35], v[64:67], v[160:163]
    ds_read_b64_tr_b16 v[48:49], v4 offset:24576
    v_mfma_f32_16x16x32_bf16 v[160:163], v[28:31], v[60:63], v[160:163]
    ds_read_b64_tr_b16 v[50:51], v4 offset:25600
    v_mfma_f32_16x16x32_bf16 v[172:175], v[28:31], v[68:71], v[172:175]
    v_add_u32 v4, 49152, v4
    v_mfma_f32_16x16x32_bf16 v[172:175], v[32:35], v[72:75], v[172:175]
    v_mfma_f32_16x16x32_bf16 v[176:179], v[32:35], v[80:83], v[176:179]
    v_mfma_f32_16x16x32_bf16 v[176:179], v[28:31], v[76:79], v[176:179]
    s_waitcnt lgkmcnt(4)
    v_mfma_f32_16x16x32_bf16 v[180:183], v[36:39], v[52:55], v[180:183]
    ds_read_b64_tr_b16 v[28:29], v5 offset:0
    v_mfma_f32_16x16x32_bf16 v[180:183], v[40:43], v[56:59], v[180:183]
    ds_read_b64_tr_b16 v[30:31], v5 offset:1024
    v_mfma_f32_16x16x32_bf16 v[184:187], v[40:43], v[64:67], v[184:187]
    ds_read_b64_tr_b16 v[32:33], v5 offset:8192
    v_mfma_f32_16x16x32_bf16 v[184:187], v[36:39], v[60:63], v[184:187]
    ds_read_b64_tr_b16 v[34:35], v5 offset:9216
    v_mfma_f32_16x16x32_bf16 v[196:199], v[36:39], v[68:71], v[196:199]
    v_mfma_f32_16x16x32_bf16 v[196:199], v[40:43], v[72:75], v[196:199]
    v_mfma_f32_16x16x32_bf16 v[200:203], v[40:43], v[80:83], v[200:203]
    v_mfma_f32_16x16x32_bf16 v[200:203], v[36:39], v[76:79], v[200:203]
    s_waitcnt lgkmcnt(4)
    v_mfma_f32_16x16x32_bf16 v[188:191], v[44:47], v[52:55], v[188:191]
    ds_read_b64_tr_b16 v[36:37], v5 offset:16384
    v_mfma_f32_16x16x32_bf16 v[188:191], v[48:51], v[56:59], v[188:191]
    ds_read_b64_tr_b16 v[38:39], v5 offset:17408
    v_mfma_f32_16x16x32_bf16 v[192:195], v[48:51], v[64:67], v[192:195]
    ds_read_b64_tr_b16 v[40:41], v5 offset:24576
    v_mfma_f32_16x16x32_bf16 v[192:195], v[44:47], v[60:63], v[192:195]
    ds_read_b64_tr_b16 v[42:43], v5 offset:25600
    v_mfma_f32_16x16x32_bf16 v[204:207], v[44:47], v[68:71], v[204:207]
    v_add_u32 v5, 49152, v5
    v_mfma_f32_16x16x32_bf16 v[204:207], v[48:51], v[72:75], v[204:207]
    v_mfma_f32_16x16x32_bf16 v[208:211], v[48:51], v[80:83], v[208:211]
    v_mfma_f32_16x16x32_bf16 v[208:211], v[44:47], v[76:79], v[208:211]
    s_waitcnt lgkmcnt(4)
    v_mfma_f32_16x16x32_bf16 v[212:215], v[28:31], v[52:55], v[212:215]
    v_mfma_f32_16x16x32_bf16 v[212:215], v[32:35], v[56:59], v[212:215]
    v_mfma_f32_16x16x32_bf16 v[216:219], v[32:35], v[64:67], v[216:219]
    v_mfma_f32_16x16x32_bf16 v[216:219], v[28:31], v[60:63], v[216:219]
    s_waitcnt lgkmcnt(0)
    s_barrier
    ds_read_b128 v[84:87], v6 offset:0
    ds_read_b128 v[88:91], v7 offset:0
    v_mfma_f32_16x16x32_bf16 v[228:231], v[28:31], v[68:71], v[228:231]
    ds_read_b128 v[92:95], v6 offset:2048
    ds_read_b128 v[96:99], v7 offset:2048
    v_mfma_f32_16x16x32_bf16 v[228:231], v[32:35], v[72:75], v[228:231]
    ds_read_b128 v[100:103], v8 offset:0
    ds_read_b128 v[104:107], v9 offset:0
    v_mfma_f32_16x16x32_bf16 v[232:235], v[32:35], v[80:83], v[232:235]
    ds_read_b128 v[108:111], v8 offset:2048
    ds_read_b128 v[112:115], v9 offset:2048
    v_mfma_f32_16x16x32_bf16 v[232:235], v[28:31], v[76:79], v[232:235]
    ds_read_b64_tr_b16 v[44:45], v2 offset:0
    ds_read_b64_tr_b16 v[46:47], v2 offset:1024
    s_waitcnt lgkmcnt(10)
    v_mfma_f32_16x16x32_bf16 v[220:223], v[36:39], v[52:55], v[220:223]
    ds_read_b64_tr_b16 v[48:49], v2 offset:8192
    v_mfma_f32_16x16x32_bf16 v[220:223], v[40:43], v[56:59], v[220:223]
    ds_read_b64_tr_b16 v[50:51], v2 offset:9216
    v_mfma_f32_16x16x32_bf16 v[224:227], v[40:43], v[64:67], v[224:227]
    ds_read_b64_tr_b16 v[28:29], v2 offset:16384
    v_mfma_f32_16x16x32_bf16 v[224:227], v[36:39], v[60:63], v[224:227]
    ds_read_b64_tr_b16 v[30:31], v2 offset:17408
    v_mfma_f32_16x16x32_bf16 v[236:239], v[36:39], v[68:71], v[236:239]
    ds_read_b64_tr_b16 v[32:33], v2 offset:24576
    v_mfma_f32_16x16x32_bf16 v[236:239], v[40:43], v[72:75], v[236:239]
    s_waitcnt lgkmcnt(10)
    ds_read_b64_tr_b16 v[34:35], v2 offset:25600
    v_mfma_f32_16x16x32_bf16 v[240:243], v[40:43], v[80:83], v[240:243]
    v_mfma_f32_16x16x32_bf16 v[240:243], v[36:39], v[76:79], v[240:243]
    s_waitcnt lgkmcnt(4)
    v_mfma_f32_16x16x32_bf16 v[116:119], v[44:47], v[84:87], v[116:119]
    ds_read_b64_tr_b16 v[36:37], v3 offset:0
    v_mfma_f32_16x16x32_bf16 v[116:119], v[48:51], v[88:91], v[116:119]
    ds_read_b64_tr_b16 v[38:39], v3 offset:1024
    v_mfma_f32_16x16x32_bf16 v[120:123], v[48:51], v[96:99], v[120:123]
    ds_read_b64_tr_b16 v[40:41], v3 offset:8192
    v_mfma_f32_16x16x32_bf16 v[120:123], v[44:47], v[92:95], v[120:123]
    ds_read_b64_tr_b16 v[42:43], v3 offset:9216
    v_mfma_f32_16x16x32_bf16 v[132:135], v[44:47], v[100:103], v[132:135]
    v_mfma_f32_16x16x32_bf16 v[132:135], v[48:51], v[104:107], v[132:135]
    v_mfma_f32_16x16x32_bf16 v[136:139], v[48:51], v[112:115], v[136:139]
    v_mfma_f32_16x16x32_bf16 v[136:139], v[44:47], v[108:111], v[136:139]
    s_waitcnt lgkmcnt(4)
    v_mfma_f32_16x16x32_bf16 v[124:127], v[28:31], v[84:87], v[124:127]
    ds_read_b64_tr_b16 v[44:45], v3 offset:16384
    v_mfma_f32_16x16x32_bf16 v[124:127], v[32:35], v[88:91], v[124:127]
    ds_read_b64_tr_b16 v[46:47], v3 offset:17408
    v_mfma_f32_16x16x32_bf16 v[128:131], v[32:35], v[96:99], v[128:131]
    ds_read_b64_tr_b16 v[48:49], v3 offset:24576
    v_mfma_f32_16x16x32_bf16 v[128:131], v[28:31], v[92:95], v[128:131]
    ds_read_b64_tr_b16 v[50:51], v3 offset:25600
    v_mfma_f32_16x16x32_bf16 v[140:143], v[28:31], v[100:103], v[140:143]
    v_mfma_f32_16x16x32_bf16 v[140:143], v[32:35], v[104:107], v[140:143]
    v_mfma_f32_16x16x32_bf16 v[144:147], v[32:35], v[112:115], v[144:147]
    v_mfma_f32_16x16x32_bf16 v[144:147], v[28:31], v[108:111], v[144:147]
    s_waitcnt lgkmcnt(4)
    v_mfma_f32_16x16x32_bf16 v[148:151], v[36:39], v[84:87], v[148:151]
    ds_read_b64_tr_b16 v[28:29], v4 offset:0
    v_mfma_f32_16x16x32_bf16 v[148:151], v[40:43], v[88:91], v[148:151]
    ds_read_b64_tr_b16 v[30:31], v4 offset:1024
    v_mfma_f32_16x16x32_bf16 v[152:155], v[40:43], v[96:99], v[152:155]
    ds_read_b64_tr_b16 v[32:33], v4 offset:8192
    v_mfma_f32_16x16x32_bf16 v[152:155], v[36:39], v[92:95], v[152:155]
    ds_read_b64_tr_b16 v[34:35], v4 offset:9216
    v_mfma_f32_16x16x32_bf16 v[164:167], v[36:39], v[100:103], v[164:167]
    v_mfma_f32_16x16x32_bf16 v[164:167], v[40:43], v[104:107], v[164:167]
    v_mfma_f32_16x16x32_bf16 v[168:171], v[40:43], v[112:115], v[168:171]
    v_mfma_f32_16x16x32_bf16 v[168:171], v[36:39], v[108:111], v[168:171]
    s_waitcnt lgkmcnt(4)
    v_mfma_f32_16x16x32_bf16 v[156:159], v[44:47], v[84:87], v[156:159]
    ds_read_b64_tr_b16 v[36:37], v4 offset:16384
    v_mfma_f32_16x16x32_bf16 v[156:159], v[48:51], v[88:91], v[156:159]
    ds_read_b64_tr_b16 v[38:39], v4 offset:17408
    v_mfma_f32_16x16x32_bf16 v[160:163], v[48:51], v[96:99], v[160:163]
    ds_read_b64_tr_b16 v[40:41], v4 offset:24576
    v_mfma_f32_16x16x32_bf16 v[160:163], v[44:47], v[92:95], v[160:163]
    ds_read_b64_tr_b16 v[42:43], v4 offset:25600
    v_mfma_f32_16x16x32_bf16 v[172:175], v[44:47], v[100:103], v[172:175]
    v_mfma_f32_16x16x32_bf16 v[172:175], v[48:51], v[104:107], v[172:175]
    v_mfma_f32_16x16x32_bf16 v[176:179], v[48:51], v[112:115], v[176:179]
    v_mfma_f32_16x16x32_bf16 v[176:179], v[44:47], v[108:111], v[176:179]
    s_waitcnt lgkmcnt(4)
    v_mfma_f32_16x16x32_bf16 v[180:183], v[28:31], v[84:87], v[180:183]
    ds_read_b64_tr_b16 v[44:45], v5 offset:0
    v_mfma_f32_16x16x32_bf16 v[180:183], v[32:35], v[88:91], v[180:183]
    ds_read_b64_tr_b16 v[46:47], v5 offset:1024
    v_mfma_f32_16x16x32_bf16 v[184:187], v[32:35], v[96:99], v[184:187]
    ds_read_b64_tr_b16 v[48:49], v5 offset:8192
    v_mfma_f32_16x16x32_bf16 v[184:187], v[28:31], v[92:95], v[184:187]
    ds_read_b64_tr_b16 v[50:51], v5 offset:9216
    v_mfma_f32_16x16x32_bf16 v[196:199], v[28:31], v[100:103], v[196:199]
    v_mfma_f32_16x16x32_bf16 v[196:199], v[32:35], v[104:107], v[196:199]
    v_mfma_f32_16x16x32_bf16 v[200:203], v[32:35], v[112:115], v[200:203]
    v_mfma_f32_16x16x32_bf16 v[200:203], v[28:31], v[108:111], v[200:203]
    s_waitcnt lgkmcnt(4)
    v_mfma_f32_16x16x32_bf16 v[188:191], v[36:39], v[84:87], v[188:191]
    ds_read_b64_tr_b16 v[28:29], v5 offset:16384
    v_mfma_f32_16x16x32_bf16 v[188:191], v[40:43], v[88:91], v[188:191]
    ds_read_b64_tr_b16 v[30:31], v5 offset:17408
    v_mfma_f32_16x16x32_bf16 v[192:195], v[40:43], v[96:99], v[192:195]
    ds_read_b64_tr_b16 v[32:33], v5 offset:24576
    v_mfma_f32_16x16x32_bf16 v[192:195], v[36:39], v[92:95], v[192:195]
    ds_read_b64_tr_b16 v[34:35], v5 offset:25600
    v_mfma_f32_16x16x32_bf16 v[204:207], v[36:39], v[100:103], v[204:207]
    v_mfma_f32_16x16x32_bf16 v[204:207], v[40:43], v[104:107], v[204:207]
    v_mfma_f32_16x16x32_bf16 v[208:211], v[40:43], v[112:115], v[208:211]
    v_mfma_f32_16x16x32_bf16 v[208:211], v[36:39], v[108:111], v[208:211]
    s_waitcnt lgkmcnt(4)
    v_mfma_f32_16x16x32_bf16 v[212:215], v[44:47], v[84:87], v[212:215]
    v_mfma_f32_16x16x32_bf16 v[212:215], v[48:51], v[88:91], v[212:215]
    v_mfma_f32_16x16x32_bf16 v[216:219], v[48:51], v[96:99], v[216:219]
    v_mfma_f32_16x16x32_bf16 v[216:219], v[44:47], v[92:95], v[216:219]
    s_waitcnt lgkmcnt(0)
    s_barrier
    v_mfma_f32_16x16x32_bf16 v[228:231], v[44:47], v[100:103], v[228:231]
    v_mfma_f32_16x16x32_bf16 v[228:231], v[48:51], v[104:107], v[228:231]
    v_mfma_f32_16x16x32_bf16 v[232:235], v[48:51], v[112:115], v[232:235]
    v_mfma_f32_16x16x32_bf16 v[232:235], v[44:47], v[108:111], v[232:235]
    s_waitcnt lgkmcnt(0)
    v_mfma_f32_16x16x32_bf16 v[220:223], v[28:31], v[84:87], v[220:223]
    v_mfma_f32_16x16x32_bf16 v[220:223], v[32:35], v[88:91], v[220:223]
    v_mfma_f32_16x16x32_bf16 v[224:227], v[32:35], v[96:99], v[224:227]
    v_mfma_f32_16x16x32_bf16 v[224:227], v[28:31], v[92:95], v[224:227]
    v_mfma_f32_16x16x32_bf16 v[236:239], v[28:31], v[100:103], v[236:239]
    v_mfma_f32_16x16x32_bf16 v[236:239], v[32:35], v[104:107], v[236:239]
    v_mfma_f32_16x16x32_bf16 v[240:243], v[32:35], v[112:115], v[240:243]
    v_mfma_f32_16x16x32_bf16 v[240:243], v[28:31], v[108:111], v[240:243]
    s_nop 7
    v_pk_mul_f32 v[244:245], v[116:117], v[116:117]
    v_pk_mul_f32 v[246:247], v[118:119], v[118:119]
    v_pk_mul_f32 v[248:249], v[120:121], v[120:121]
    v_pk_mul_f32 v[250:251], v[122:123], v[122:123]
    v_pk_fma_f32 v[244:245], v[244:245], v[26:27], v[24:25]
    v_pk_fma_f32 v[246:247], v[246:247], v[26:27], v[24:25]
    v_pk_fma_f32 v[248:249], v[248:249], v[26:27], v[24:25]
    v_pk_fma_f32 v[250:251], v[250:251], v[26:27], v[24:25]
    v_pk_mul_f32 v[244:245], v[244:245], v[116:117]
    v_pk_mul_f32 v[246:247], v[246:247], v[118:119]
    v_pk_mul_f32 v[248:249], v[248:249], v[120:121]
    v_pk_mul_f32 v[250:251], v[250:251], v[122:123]
    v_exp_f32 v244, v244
    v_exp_f32 v245, v245
    v_exp_f32 v246, v246
    v_exp_f32 v247, v247
    v_exp_f32 v248, v248
    v_exp_f32 v249, v249
    v_exp_f32 v250, v250
    v_exp_f32 v251, v251
    v_pk_mul_f32 v[124:125], v[116:117], v[124:125]
    v_pk_mul_f32 v[126:127], v[118:119], v[126:127]
    v_pk_mul_f32 v[128:129], v[120:121], v[128:129]
    v_pk_mul_f32 v[130:131], v[122:123], v[130:131]
    v_pk_add_f32 v[244:245], v[244:245], 1.0 op_sel_hi:[1,0]
    v_pk_add_f32 v[246:247], v[246:247], 1.0 op_sel_hi:[1,0]
    v_pk_add_f32 v[248:249], v[248:249], 1.0 op_sel_hi:[1,0]
    v_pk_add_f32 v[250:251], v[250:251], 1.0 op_sel_hi:[1,0]
    v_rcp_f32 v244, v244
    v_rcp_f32 v245, v245
    v_rcp_f32 v246, v246
    v_rcp_f32 v247, v247
    v_rcp_f32 v248, v248
    v_rcp_f32 v249, v249
    v_rcp_f32 v250, v250
    v_rcp_f32 v251, v251
    v_pk_mul_f32 v[124:125], v[124:125], v[244:245]
    v_pk_mul_f32 v[126:127], v[126:127], v[246:247]
    v_pk_mul_f32 v[128:129], v[128:129], v[248:249]
    v_pk_mul_f32 v[130:131], v[130:131], v[250:251]
    v_cvt_pk_bf16_f32 v116, v124, v125
    v_cvt_pk_bf16_f32 v118, v128, v129
    v_cvt_pk_bf16_f32 v117, v126, v127
    v_cvt_pk_bf16_f32 v119, v130, v131
    v_permlane16_swap_b32 v116, v118
    s_nop 0
    v_permlane16_swap_b32 v117, v119
    buffer_store_dwordx4 v[116:119], v14, s[32:35], s42 offen offset:0 sc1
    v_pk_mul_f32 v[244:245], v[132:133], v[132:133]
    v_pk_mul_f32 v[246:247], v[134:135], v[134:135]
    v_pk_mul_f32 v[248:249], v[136:137], v[136:137]
    v_pk_mul_f32 v[250:251], v[138:139], v[138:139]
    v_pk_fma_f32 v[244:245], v[244:245], v[26:27], v[24:25]
    v_pk_fma_f32 v[246:247], v[246:247], v[26:27], v[24:25]
    v_pk_fma_f32 v[248:249], v[248:249], v[26:27], v[24:25]
    v_pk_fma_f32 v[250:251], v[250:251], v[26:27], v[24:25]
    v_pk_mul_f32 v[244:245], v[244:245], v[132:133]
    v_pk_mul_f32 v[246:247], v[246:247], v[134:135]
    v_pk_mul_f32 v[248:249], v[248:249], v[136:137]
    v_pk_mul_f32 v[250:251], v[250:251], v[138:139]
    v_exp_f32 v244, v244
    v_exp_f32 v245, v245
    v_exp_f32 v246, v246
    v_exp_f32 v247, v247
    v_exp_f32 v248, v248
    v_exp_f32 v249, v249
    v_exp_f32 v250, v250
    v_exp_f32 v251, v251
    v_pk_mul_f32 v[140:141], v[132:133], v[140:141]
    v_pk_mul_f32 v[142:143], v[134:135], v[142:143]
    v_pk_mul_f32 v[144:145], v[136:137], v[144:145]
    v_pk_mul_f32 v[146:147], v[138:139], v[146:147]
    v_pk_add_f32 v[244:245], v[244:245], 1.0 op_sel_hi:[1,0]
    v_pk_add_f32 v[246:247], v[246:247], 1.0 op_sel_hi:[1,0]
    v_pk_add_f32 v[248:249], v[248:249], 1.0 op_sel_hi:[1,0]
    v_pk_add_f32 v[250:251], v[250:251], 1.0 op_sel_hi:[1,0]
    v_rcp_f32 v244, v244
    v_rcp_f32 v245, v245
    v_rcp_f32 v246, v246
    v_rcp_f32 v247, v247
    v_rcp_f32 v248, v248
    v_rcp_f32 v249, v249
    v_rcp_f32 v250, v250
    v_rcp_f32 v251, v251
    v_pk_mul_f32 v[140:141], v[140:141], v[244:245]
    v_pk_mul_f32 v[142:143], v[142:143], v[246:247]
    v_pk_mul_f32 v[144:145], v[144:145], v[248:249]
    v_pk_mul_f32 v[146:147], v[146:147], v[250:251]
    v_cvt_pk_bf16_f32 v132, v140, v141
    v_cvt_pk_bf16_f32 v134, v144, v145
    v_cvt_pk_bf16_f32 v133, v142, v143
    v_cvt_pk_bf16_f32 v135, v146, v147
    v_permlane16_swap_b32 v132, v134
    s_nop 0
    v_permlane16_swap_b32 v133, v135
    buffer_store_dwordx4 v[132:135], v14, s[32:35], s43 offen offset:0 sc1
    v_pk_mul_f32 v[244:245], v[148:149], v[148:149]
    v_pk_mul_f32 v[246:247], v[150:151], v[150:151]
    v_pk_mul_f32 v[248:249], v[152:153], v[152:153]
    v_pk_mul_f32 v[250:251], v[154:155], v[154:155]
    v_pk_fma_f32 v[244:245], v[244:245], v[26:27], v[24:25]
    v_pk_fma_f32 v[246:247], v[246:247], v[26:27], v[24:25]
    v_pk_fma_f32 v[248:249], v[248:249], v[26:27], v[24:25]
    v_pk_fma_f32 v[250:251], v[250:251], v[26:27], v[24:25]
    v_pk_mul_f32 v[244:245], v[244:245], v[148:149]
    v_pk_mul_f32 v[246:247], v[246:247], v[150:151]
    v_pk_mul_f32 v[248:249], v[248:249], v[152:153]
    v_pk_mul_f32 v[250:251], v[250:251], v[154:155]
    v_exp_f32 v244, v244
    v_exp_f32 v245, v245
    v_exp_f32 v246, v246
    v_exp_f32 v247, v247
    v_exp_f32 v248, v248
    v_exp_f32 v249, v249
    v_exp_f32 v250, v250
    v_exp_f32 v251, v251
    v_pk_mul_f32 v[156:157], v[148:149], v[156:157]
    v_pk_mul_f32 v[158:159], v[150:151], v[158:159]
    v_pk_mul_f32 v[160:161], v[152:153], v[160:161]
    v_pk_mul_f32 v[162:163], v[154:155], v[162:163]
    v_pk_add_f32 v[244:245], v[244:245], 1.0 op_sel_hi:[1,0]
    v_pk_add_f32 v[246:247], v[246:247], 1.0 op_sel_hi:[1,0]
    v_pk_add_f32 v[248:249], v[248:249], 1.0 op_sel_hi:[1,0]
    v_pk_add_f32 v[250:251], v[250:251], 1.0 op_sel_hi:[1,0]
    v_rcp_f32 v244, v244
    v_rcp_f32 v245, v245
    v_rcp_f32 v246, v246
    v_rcp_f32 v247, v247
    v_rcp_f32 v248, v248
    v_rcp_f32 v249, v249
    v_rcp_f32 v250, v250
    v_rcp_f32 v251, v251
    v_pk_mul_f32 v[156:157], v[156:157], v[244:245]
    v_pk_mul_f32 v[158:159], v[158:159], v[246:247]
    v_pk_mul_f32 v[160:161], v[160:161], v[248:249]
    v_pk_mul_f32 v[162:163], v[162:163], v[250:251]
    v_cvt_pk_bf16_f32 v148, v156, v157
    v_cvt_pk_bf16_f32 v150, v160, v161
    v_cvt_pk_bf16_f32 v149, v158, v159
    v_cvt_pk_bf16_f32 v151, v162, v163
    v_permlane16_swap_b32 v148, v150
    s_nop 0
    v_permlane16_swap_b32 v149, v151
    buffer_store_dwordx4 v[148:151], v14, s[32:35], s42 offen offset:1024 sc1
    v_pk_mul_f32 v[244:245], v[164:165], v[164:165]
    v_pk_mul_f32 v[246:247], v[166:167], v[166:167]
    v_pk_mul_f32 v[248:249], v[168:169], v[168:169]
    v_pk_mul_f32 v[250:251], v[170:171], v[170:171]
    v_pk_fma_f32 v[244:245], v[244:245], v[26:27], v[24:25]
    v_pk_fma_f32 v[246:247], v[246:247], v[26:27], v[24:25]
    v_pk_fma_f32 v[248:249], v[248:249], v[26:27], v[24:25]
    v_pk_fma_f32 v[250:251], v[250:251], v[26:27], v[24:25]
    v_pk_mul_f32 v[244:245], v[244:245], v[164:165]
    v_pk_mul_f32 v[246:247], v[246:247], v[166:167]
    v_pk_mul_f32 v[248:249], v[248:249], v[168:169]
    v_pk_mul_f32 v[250:251], v[250:251], v[170:171]
    v_exp_f32 v244, v244
    v_exp_f32 v245, v245
    v_exp_f32 v246, v246
    v_exp_f32 v247, v247
    v_exp_f32 v248, v248
    v_exp_f32 v249, v249
    v_exp_f32 v250, v250
    v_exp_f32 v251, v251
    v_pk_mul_f32 v[172:173], v[164:165], v[172:173]
    v_pk_mul_f32 v[174:175], v[166:167], v[174:175]
    v_pk_mul_f32 v[176:177], v[168:169], v[176:177]
    v_pk_mul_f32 v[178:179], v[170:171], v[178:179]
    v_pk_add_f32 v[244:245], v[244:245], 1.0 op_sel_hi:[1,0]
    v_pk_add_f32 v[246:247], v[246:247], 1.0 op_sel_hi:[1,0]
    v_pk_add_f32 v[248:249], v[248:249], 1.0 op_sel_hi:[1,0]
    v_pk_add_f32 v[250:251], v[250:251], 1.0 op_sel_hi:[1,0]
    v_rcp_f32 v244, v244
    v_rcp_f32 v245, v245
    v_rcp_f32 v246, v246
    v_rcp_f32 v247, v247
    v_rcp_f32 v248, v248
    v_rcp_f32 v249, v249
    v_rcp_f32 v250, v250
    v_rcp_f32 v251, v251
    v_pk_mul_f32 v[172:173], v[172:173], v[244:245]
    v_pk_mul_f32 v[174:175], v[174:175], v[246:247]
    v_pk_mul_f32 v[176:177], v[176:177], v[248:249]
    v_pk_mul_f32 v[178:179], v[178:179], v[250:251]
    v_cvt_pk_bf16_f32 v164, v172, v173
    v_cvt_pk_bf16_f32 v166, v176, v177
    v_cvt_pk_bf16_f32 v165, v174, v175
    v_cvt_pk_bf16_f32 v167, v178, v179
    v_permlane16_swap_b32 v164, v166
    s_nop 0
    v_permlane16_swap_b32 v165, v167
    buffer_store_dwordx4 v[164:167], v14, s[32:35], s43 offen offset:1024 sc1
    v_pk_mul_f32 v[244:245], v[180:181], v[180:181]
    v_pk_mul_f32 v[246:247], v[182:183], v[182:183]
    v_pk_mul_f32 v[248:249], v[184:185], v[184:185]
    v_pk_mul_f32 v[250:251], v[186:187], v[186:187]
    v_pk_fma_f32 v[244:245], v[244:245], v[26:27], v[24:25]
    v_pk_fma_f32 v[246:247], v[246:247], v[26:27], v[24:25]
    v_pk_fma_f32 v[248:249], v[248:249], v[26:27], v[24:25]
    v_pk_fma_f32 v[250:251], v[250:251], v[26:27], v[24:25]
    v_pk_mul_f32 v[244:245], v[244:245], v[180:181]
    v_pk_mul_f32 v[246:247], v[246:247], v[182:183]
    v_pk_mul_f32 v[248:249], v[248:249], v[184:185]
    v_pk_mul_f32 v[250:251], v[250:251], v[186:187]
    v_exp_f32 v244, v244
    v_exp_f32 v245, v245
    v_exp_f32 v246, v246
    v_exp_f32 v247, v247
    v_exp_f32 v248, v248
    v_exp_f32 v249, v249
    v_exp_f32 v250, v250
    v_exp_f32 v251, v251
    v_pk_mul_f32 v[188:189], v[180:181], v[188:189]
    v_pk_mul_f32 v[190:191], v[182:183], v[190:191]
    v_pk_mul_f32 v[192:193], v[184:185], v[192:193]
    v_pk_mul_f32 v[194:195], v[186:187], v[194:195]
    v_pk_add_f32 v[244:245], v[244:245], 1.0 op_sel_hi:[1,0]
    v_pk_add_f32 v[246:247], v[246:247], 1.0 op_sel_hi:[1,0]
    v_pk_add_f32 v[248:249], v[248:249], 1.0 op_sel_hi:[1,0]
    v_pk_add_f32 v[250:251], v[250:251], 1.0 op_sel_hi:[1,0]
    v_rcp_f32 v244, v244
    v_rcp_f32 v245, v245
    v_rcp_f32 v246, v246
    v_rcp_f32 v247, v247
    v_rcp_f32 v248, v248
    v_rcp_f32 v249, v249
    v_rcp_f32 v250, v250
    v_rcp_f32 v251, v251
    v_pk_mul_f32 v[188:189], v[188:189], v[244:245]
    v_pk_mul_f32 v[190:191], v[190:191], v[246:247]
    v_pk_mul_f32 v[192:193], v[192:193], v[248:249]
    v_pk_mul_f32 v[194:195], v[194:195], v[250:251]
    v_cvt_pk_bf16_f32 v180, v188, v189
    v_cvt_pk_bf16_f32 v182, v192, v193
    v_cvt_pk_bf16_f32 v181, v190, v191
    v_cvt_pk_bf16_f32 v183, v194, v195
    v_permlane16_swap_b32 v180, v182
    s_nop 0
    v_permlane16_swap_b32 v181, v183
    buffer_store_dwordx4 v[180:183], v14, s[32:35], s42 offen offset:2048 sc1
    v_pk_mul_f32 v[244:245], v[196:197], v[196:197]
    v_pk_mul_f32 v[246:247], v[198:199], v[198:199]
    v_pk_mul_f32 v[248:249], v[200:201], v[200:201]
    v_pk_mul_f32 v[250:251], v[202:203], v[202:203]
    v_pk_fma_f32 v[244:245], v[244:245], v[26:27], v[24:25]
    v_pk_fma_f32 v[246:247], v[246:247], v[26:27], v[24:25]
    v_pk_fma_f32 v[248:249], v[248:249], v[26:27], v[24:25]
    v_pk_fma_f32 v[250:251], v[250:251], v[26:27], v[24:25]
    v_pk_mul_f32 v[244:245], v[244:245], v[196:197]
    v_pk_mul_f32 v[246:247], v[246:247], v[198:199]
    v_pk_mul_f32 v[248:249], v[248:249], v[200:201]
    v_pk_mul_f32 v[250:251], v[250:251], v[202:203]
    v_exp_f32 v244, v244
    v_exp_f32 v245, v245
    v_exp_f32 v246, v246
    v_exp_f32 v247, v247
    v_exp_f32 v248, v248
    v_exp_f32 v249, v249
    v_exp_f32 v250, v250
    v_exp_f32 v251, v251
    v_pk_mul_f32 v[204:205], v[196:197], v[204:205]
    v_pk_mul_f32 v[206:207], v[198:199], v[206:207]
    v_pk_mul_f32 v[208:209], v[200:201], v[208:209]
    v_pk_mul_f32 v[210:211], v[202:203], v[210:211]
    v_pk_add_f32 v[244:245], v[244:245], 1.0 op_sel_hi:[1,0]
    v_pk_add_f32 v[246:247], v[246:247], 1.0 op_sel_hi:[1,0]
    v_pk_add_f32 v[248:249], v[248:249], 1.0 op_sel_hi:[1,0]
    v_pk_add_f32 v[250:251], v[250:251], 1.0 op_sel_hi:[1,0]
    v_rcp_f32 v244, v244
    v_rcp_f32 v245, v245
    v_rcp_f32 v246, v246
    v_rcp_f32 v247, v247
    v_rcp_f32 v248, v248
    v_rcp_f32 v249, v249
    v_rcp_f32 v250, v250
    v_rcp_f32 v251, v251
    v_pk_mul_f32 v[204:205], v[204:205], v[244:245]
    v_pk_mul_f32 v[206:207], v[206:207], v[246:247]
    v_pk_mul_f32 v[208:209], v[208:209], v[248:249]
    v_pk_mul_f32 v[210:211], v[210:211], v[250:251]
    v_cvt_pk_bf16_f32 v196, v204, v205
    v_cvt_pk_bf16_f32 v198, v208, v209
    v_cvt_pk_bf16_f32 v197, v206, v207
    v_cvt_pk_bf16_f32 v199, v210, v211
    v_permlane16_swap_b32 v196, v198
    s_nop 0
    v_permlane16_swap_b32 v197, v199
    buffer_store_dwordx4 v[196:199], v14, s[32:35], s43 offen offset:2048 sc1
    v_pk_mul_f32 v[244:245], v[212:213], v[212:213]
    v_pk_mul_f32 v[246:247], v[214:215], v[214:215]
    v_pk_mul_f32 v[248:249], v[216:217], v[216:217]
    v_pk_mul_f32 v[250:251], v[218:219], v[218:219]
    v_pk_fma_f32 v[244:245], v[244:245], v[26:27], v[24:25]
    v_pk_fma_f32 v[246:247], v[246:247], v[26:27], v[24:25]
    v_pk_fma_f32 v[248:249], v[248:249], v[26:27], v[24:25]
    v_pk_fma_f32 v[250:251], v[250:251], v[26:27], v[24:25]
    v_pk_mul_f32 v[244:245], v[244:245], v[212:213]
    v_pk_mul_f32 v[246:247], v[246:247], v[214:215]
    v_pk_mul_f32 v[248:249], v[248:249], v[216:217]
    v_pk_mul_f32 v[250:251], v[250:251], v[218:219]
    v_exp_f32 v244, v244
    v_exp_f32 v245, v245
    v_exp_f32 v246, v246
    v_exp_f32 v247, v247
    v_exp_f32 v248, v248
    v_exp_f32 v249, v249
    v_exp_f32 v250, v250
    v_exp_f32 v251, v251
    v_pk_mul_f32 v[220:221], v[212:213], v[220:221]
    v_pk_mul_f32 v[222:223], v[214:215], v[222:223]
    v_pk_mul_f32 v[224:225], v[216:217], v[224:225]
    v_pk_mul_f32 v[226:227], v[218:219], v[226:227]
    v_pk_add_f32 v[244:245], v[244:245], 1.0 op_sel_hi:[1,0]
    v_pk_add_f32 v[246:247], v[246:247], 1.0 op_sel_hi:[1,0]
    v_pk_add_f32 v[248:249], v[248:249], 1.0 op_sel_hi:[1,0]
    v_pk_add_f32 v[250:251], v[250:251], 1.0 op_sel_hi:[1,0]
    v_rcp_f32 v244, v244
    v_rcp_f32 v245, v245
    v_rcp_f32 v246, v246
    v_rcp_f32 v247, v247
    v_rcp_f32 v248, v248
    v_rcp_f32 v249, v249
    v_rcp_f32 v250, v250
    v_rcp_f32 v251, v251
    v_pk_mul_f32 v[220:221], v[220:221], v[244:245]
    v_pk_mul_f32 v[222:223], v[222:223], v[246:247]
    v_pk_mul_f32 v[224:225], v[224:225], v[248:249]
    v_pk_mul_f32 v[226:227], v[226:227], v[250:251]
    v_cvt_pk_bf16_f32 v212, v220, v221
    v_cvt_pk_bf16_f32 v214, v224, v225
    v_cvt_pk_bf16_f32 v213, v222, v223
    v_cvt_pk_bf16_f32 v215, v226, v227
    v_permlane16_swap_b32 v212, v214
    s_nop 0
    v_permlane16_swap_b32 v213, v215
    buffer_store_dwordx4 v[212:215], v14, s[32:35], s42 offen offset:3072 sc1
    v_pk_mul_f32 v[244:245], v[228:229], v[228:229]
    v_pk_mul_f32 v[246:247], v[230:231], v[230:231]
    v_pk_mul_f32 v[248:249], v[232:233], v[232:233]
    v_pk_mul_f32 v[250:251], v[234:235], v[234:235]
    v_pk_fma_f32 v[244:245], v[244:245], v[26:27], v[24:25]
    v_pk_fma_f32 v[246:247], v[246:247], v[26:27], v[24:25]
    v_pk_fma_f32 v[248:249], v[248:249], v[26:27], v[24:25]
    v_pk_fma_f32 v[250:251], v[250:251], v[26:27], v[24:25]
    v_pk_mul_f32 v[244:245], v[244:245], v[228:229]
    v_pk_mul_f32 v[246:247], v[246:247], v[230:231]
    v_pk_mul_f32 v[248:249], v[248:249], v[232:233]
    v_pk_mul_f32 v[250:251], v[250:251], v[234:235]
    v_exp_f32 v244, v244
    v_exp_f32 v245, v245
    v_exp_f32 v246, v246
    v_exp_f32 v247, v247
    v_exp_f32 v248, v248
    v_exp_f32 v249, v249
    v_exp_f32 v250, v250
    v_exp_f32 v251, v251
    v_pk_mul_f32 v[236:237], v[228:229], v[236:237]
    v_pk_mul_f32 v[238:239], v[230:231], v[238:239]
    v_pk_mul_f32 v[240:241], v[232:233], v[240:241]
    v_pk_mul_f32 v[242:243], v[234:235], v[242:243]
    v_pk_add_f32 v[244:245], v[244:245], 1.0 op_sel_hi:[1,0]
    v_pk_add_f32 v[246:247], v[246:247], 1.0 op_sel_hi:[1,0]
    v_pk_add_f32 v[248:249], v[248:249], 1.0 op_sel_hi:[1,0]
    v_pk_add_f32 v[250:251], v[250:251], 1.0 op_sel_hi:[1,0]
    v_rcp_f32 v244, v244
    v_rcp_f32 v245, v245
    v_rcp_f32 v246, v246
    v_rcp_f32 v247, v247
    v_rcp_f32 v248, v248
    v_rcp_f32 v249, v249
    v_rcp_f32 v250, v250
    v_rcp_f32 v251, v251
    v_pk_mul_f32 v[236:237], v[236:237], v[244:245]
    v_pk_mul_f32 v[238:239], v[238:239], v[246:247]
    v_pk_mul_f32 v[240:241], v[240:241], v[248:249]
    v_pk_mul_f32 v[242:243], v[242:243], v[250:251]
    v_cvt_pk_bf16_f32 v228, v236, v237
    v_cvt_pk_bf16_f32 v230, v240, v241
    v_cvt_pk_bf16_f32 v229, v238, v239
    v_cvt_pk_bf16_f32 v231, v242, v243
    v_permlane16_swap_b32 v228, v230
    s_nop 0
    v_permlane16_swap_b32 v229, v231
    buffer_store_dwordx4 v[228:231], v14, s[32:35], s43 offen offset:3072 sc1
    s_branch L2C
L2C:
    s_and_b32 s42, s45, 1
    s_lshl_b32 s42, s42, 5
    s_add_u32 s42, s42, s54
    s_lshr_b32 s43, s45, 1
    s_lshl_b32 s43, s43, 5
    s_lshl_b32 s44, s51, 6
    s_add_u32 s43, s43, s44
    v_bfe_u32 v20, v1, 2, 1
    v_lshlrev_b32 v20, 4, v20
    v_and_or_b32 v20, v1, 3, v20
    v_bfe_u32 v21, v1, 3, 2
    v_lshlrev_b32 v21, 2, v21
    v_add3_u32 v20, v20, v21, s43
    v_and_b32 v21, 31, v1
    s_lshl_b32 s44, s42, 7
    v_lshl_add_u32 v25, v21, 2, s44
    v_lshl_add_u32 v21, v21, 6, s42
    v_lshrrev_b32 v22, 5, v1
    v_lshlrev_b32 v24, 10, v21
    v_lshl_add_u32 v24, v22, 5, v24
    s_lshl_b32 s44, s43, 1
    v_add_u32 v24, s44, v24
    s_mov_b32 s64, s54
    s_cmp_lt_u32 s51, 4
    s_cbranch_scc1 L2C_nomirror
    v_sub_u32 v20, 0x200, v20
    v_sub_u32 v21, 0x800, v21
    v_and_b32 v21, 0x7ff, v21
    s_sub_u32 s64, 32, s54
    s_and_b32 s64, s64, 31
L2C_nomirror:
    v_mul_u32_u24 v23, 33792, v22
    v_lshl_add_u32 v23, v20, 4, v23
    s_mul_i32 s64, s64, 67712
    v_cvt_f32_u32 v26, v21
    v_mul_f32 v26, 0xba000000, v26
    v_cvt_f32_u32 v27, v22
    v_mul_f32 v27, 0x41800000, v27
    v_mul_f32 v27, v26, v27
    s_bitcmp1_b32 s65, 1
    s_cbranch_scc1 L2C_t23s
    v_fmamk_f32 v2, v26, 0x41000000, v27
    v_fmamk_f32 v3, v26, 0x41100000, v27
    v_fmamk_f32 v4, v26, 0x42200000, v27
    v_fmamk_f32 v5, v26, 0x42240000, v27
    v_fmamk_f32 v6, v26, 0x41200000, v27
    v_fmamk_f32 v7, v26, 0x41300000, v27
    v_fmamk_f32 v8, v26, 0x42280000, v27
    v_fmamk_f32 v9, v26, 0x422c0000, v27
    v_fract_f32 v2, v2
    v_fract_f32 v3, v3
    v_fract_f32 v4, v4
    v_fract_f32 v5, v5
    v_fract_f32 v6, v6
    v_fract_f32 v7, v7
    v_fract_f32 v8, v8
    v_fract_f32 v9, v9
    v_sin_f32 v10, v2
    v_sin_f32 v11, v3
    v_sin_f32 v12, v4
    v_sin_f32 v13, v5
    v_sin_f32 v14, v6
    v_sin_f32 v15, v7
    v_sin_f32 v16, v8
    v_sin_f32 v17, v9
    v_cos_f32 v2, v2
    v_cos_f32 v3, v3
    v_cos_f32 v4, v4
    v_cos_f32 v5, v5
    v_cos_f32 v6, v6
    v_cos_f32 v7, v7
    v_cos_f32 v8, v8
    v_cos_f32 v9, v9
    s_nop 0
    v_cvt_pk_bf16_f32 v224, v2, v10
    v_cvt_pk_bf16_f32 v225, v3, v11
    v_cvt_pk_bf16_f32 v226, v4, v12
    v_cvt_pk_bf16_f32 v227, v5, v13
    v_cvt_pk_bf16_f32 v228, v6, v14
    v_cvt_pk_bf16_f32 v229, v7, v15
    v_cvt_pk_bf16_f32 v230, v8, v16
    v_cvt_pk_bf16_f32 v231, v9, v17
    v_fmamk_f32 v2, v26, 0x41400000, v27
    v_fmamk_f32 v3, v26, 0x41500000, v27
    v_fmamk_f32 v4, v26, 0x42300000, v27
    v_fmamk_f32 v5, v26, 0x42340000, v27
    v_fmamk_f32 v6, v26, 0x41600000, v27
    v_fmamk_f32 v7, v26, 0x41700000, v27
    v_fmamk_f32 v8, v26, 0x42380000, v27
    v_fmamk_f32 v9, v26, 0x423c0000, v27
    v_fract_f32 v2, v2
    v_fract_f32 v3, v3
    v_fract_f32 v4, v4
    v_fract_f32 v5, v5
    v_fract_f32 v6, v6
    v_fract_f32 v7, v7
    v_fract_f32 v8, v8
    v_fract_f32 v9, v9
    v_sin_f32 v10, v2
    v_sin_f32 v11, v3
    v_sin_f32 v12, v4
    v_sin_f32 v13, v5
    v_sin_f32 v14, v6
    v_sin_f32 v15, v7
    v_sin_f32 v16, v8
    v_sin_f32 v17, v9
    v_cos_f32 v2, v2
    v_cos_f32 v3, v3
    v_cos_f32 v4, v4
    v_cos_f32 v5, v5
    v_cos_f32 v6, v6
    v_cos_f32 v7, v7
    v_cos_f32 v8, v8
    v_cos_f32 v9, v9
    s_nop 0
    v_cvt_pk_bf16_f32 v232, v2, v10
    v_cvt_pk_bf16_f32 v233, v3, v11
    v_cvt_pk_bf16_f32 v234, v4, v12
    v_cvt_pk_bf16_f32 v235, v5, v13
    v_cvt_pk_bf16_f32 v236, v6, v14
    v_cvt_pk_bf16_f32 v237, v7, v15
    v_cvt_pk_bf16_f32 v238, v8, v16
    v_cvt_pk_bf16_f32 v239, v9, v17
L2C_t23s:
    s_add_u32 s36, s78, 0x800000
    s_addc_u32 s37, s79, 0
    s_mov_b32 s38, 0x8000
    s_mov_b32 s39, 0x20000
    v_mov_b32 v20, 159744
    v_mov_b32 v21, 1
    v_lshlrev_b32 v22, 7, v1
    v_mov_b32 v28, 2
    s_waitcnt vmcnt(0)
    s_bitcmp1_b32 s65, 0
    s_cbranch_scc0 L2C_noh
    s_mov_b64 exec, 3
    buffer_store_dword v28, v22, s[36:39], s63 offen sc1
L2C_noh:
    s_bitcmp1_b32 s65, 1
    s_cbranch_scc0 L2C_noz
    s_mov_b64 exec, 1
    ds_add_rtn_u32 v19, v20, v21
    s_and_b32 s42, s22, 1
    s_lshl4_add_u32 s42, s42, s21
    s_mul_i32 s42, s42, 1024
    s_lshr_b32 s43, s22, 1
    s_lshl_b32 s43, s43, 7
    s_add_u32 s42, s42, s43
    s_waitcnt lgkmcnt(0)
    v_cmp_ne_u32 vcc, 3, v19
    s_cbranch_vccnz L2C_noz
    buffer_store_dword v28, v22, s[36:39], s42 offen offset:256 sc1
L2C_noz:
    s_mov_b64 exec, -1
    s_bitcmp1_b32 s65, 1
    s_cbranch_scc0 L2C_nob9
    s_barrier
L2C_nob9:
    v_and_b32 v19, 15, v1
    v_min_u32 v19, 10, v19
    v_and_or_b32 v19, v1, 16, v19
    s_mov_b32 s43, 160000
    v_lshl_add_u32 v20, v19, 2, s43
    v_min_u32 v28, 47, v1
    s_mov_b32 s43, 159808
    v_lshl_add_u32 v28, v28, 2, s43
    s_mul_i32 s42, s54, 8
    s_and_b32 s43, s51, 1
    s_add_u32 s42, s42, s43
    s_lshl_b32 s42, s42, 7
    v_lshl_add_u32 v22, v1, 4, s42
    s_mov_b32 m0, 160000
    s_cmp_lg_u32 s45, 0
    s_cbranch_scc1 L2C_rest
L2C_wh:
    s_mov_b64 exec, 0xff
    buffer_load_dwordx4 v22, s[36:39], 0 offen sc1 lds
    s_mov_b64 exec, -1
    s_waitcnt vmcnt(1)
    s_sleep 4
    ds_read_b32 v19, v20
    s_waitcnt lgkmcnt(0)
    v_cmp_ne_u32 vcc, 2, v19
    s_cbranch_vccnz L2C_wh
    v_and_b32 v22, 31, v1
    v_mul_u32_u24 v22, 1024, v22
    v_lshrrev_b32 v19, 5, v1
    v_lshl_add_u32 v22, v19, 7, v22
    s_mov_b32 m0, 159808
    v_add_u32 v22, 0x100, v22
    s_mov_b32 exec_hi, 0xffff
    buffer_load_dword v22, s[36:39], 0 offen sc1 lds
    s_mov_b64 exec, -1
L2C_rest:
    v_fmamk_f32 v2, v26, 0x0, v27
    v_fmamk_f32 v3, v26, 0x3f800000, v27
    v_fmamk_f32 v4, v26, 0x42000000, v27
    v_fmamk_f32 v5, v26, 0x42040000, v27
    v_fmamk_f32 v6, v26, 0x40000000, v27
    v_fmamk_f32 v7, v26, 0x40400000, v27
    v_fmamk_f32 v8, v26, 0x42080000, v27
    v_fmamk_f32 v9, v26, 0x420c0000, v27
    v_fract_f32 v2, v2
    v_fract_f32 v3, v3
    v_fract_f32 v4, v4
    v_fract_f32 v5, v5
    v_fract_f32 v6, v6
    v_fract_f32 v7, v7
    v_fract_f32 v8, v8
    v_fract_f32 v9, v9
    v_sin_f32 v10, v2
    v_sin_f32 v11, v3
    v_sin_f32 v12, v4
    v_sin_f32 v13, v5
    v_sin_f32 v14, v6
    v_sin_f32 v15, v7
    v_sin_f32 v16, v8
    v_sin_f32 v17, v9
    v_cos_f32 v2, v2
    v_cos_f32 v3, v3
    v_cos_f32 v4, v4
    v_cos_f32 v5, v5
    v_cos_f32 v6, v6
    v_cos_f32 v7, v7
    v_cos_f32 v8, v8
    v_cos_f32 v9, v9
    s_nop 0
    v_cvt_pk_bf16_f32 v208, v2, v10
    v_cvt_pk_bf16_f32 v209, v3, v11
    v_cvt_pk_bf16_f32 v210, v4, v12
    v_cvt_pk_bf16_f32 v211, v5, v13
    v_cvt_pk_bf16_f32 v212, v6, v14
    v_cvt_pk_bf16_f32 v213, v7, v15
    v_cvt_pk_bf16_f32 v214, v8, v16
    v_cvt_pk_bf16_f32 v215, v9, v17
    v_fmamk_f32 v2, v26, 0x40800000, v27
    v_fmamk_f32 v3, v26, 0x40a00000, v27
    v_fmamk_f32 v4, v26, 0x42100000, v27
    v_fmamk_f32 v5, v26, 0x42140000, v27
    v_fmamk_f32 v6, v26, 0x40c00000, v27
    v_fmamk_f32 v7, v26, 0x40e00000, v27
    v_fmamk_f32 v8, v26, 0x42180000, v27
    v_fmamk_f32 v9, v26, 0x421c0000, v27
    v_fract_f32 v2, v2
    v_fract_f32 v3, v3
    v_fract_f32 v4, v4
    v_fract_f32 v5, v5
    v_fract_f32 v6, v6
    v_fract_f32 v7, v7
    v_fract_f32 v8, v8
    v_fract_f32 v9, v9
    v_sin_f32 v10, v2
    v_sin_f32 v11, v3
    v_sin_f32 v12, v4
    v_sin_f32 v13, v5
    v_sin_f32 v14, v6
    v_sin_f32 v15, v7
    v_sin_f32 v16, v8
    v_sin_f32 v17, v9
    v_cos_f32 v2, v2
    v_cos_f32 v3, v3
    v_cos_f32 v4, v4
    v_cos_f32 v5, v5
    v_cos_f32 v6, v6
    v_cos_f32 v7, v7
    v_cos_f32 v8, v8
    v_cos_f32 v9, v9
    s_nop 0
    v_cvt_pk_bf16_f32 v216, v2, v10
    v_cvt_pk_bf16_f32 v217, v3, v11
    v_cvt_pk_bf16_f32 v218, v4, v12
    v_cvt_pk_bf16_f32 v219, v5, v13
    v_cvt_pk_bf16_f32 v220, v6, v14
    v_cvt_pk_bf16_f32 v221, v7, v15
    v_cvt_pk_bf16_f32 v222, v8, v16
    v_cvt_pk_bf16_f32 v223, v9, v17
    s_bitcmp1_b32 s65, 1
    s_cbranch_scc0 L2C_t23d
    v_fmamk_f32 v2, v26, 0x41000000, v27
    v_fmamk_f32 v3, v26, 0x41100000, v27
    v_fmamk_f32 v4, v26, 0x42200000, v27
    v_fmamk_f32 v5, v26, 0x42240000, v27
    v_fmamk_f32 v6, v26, 0x41200000, v27
    v_fmamk_f32 v7, v26, 0x41300000, v27
    v_fmamk_f32 v8, v26, 0x42280000, v27
    v_fmamk_f32 v9, v26, 0x422c0000, v27
    v_fract_f32 v2, v2
    v_fract_f32 v3, v3
    v_fract_f32 v4, v4
    v_fract_f32 v5, v5
    v_fract_f32 v6, v6
    v_fract_f32 v7, v7
    v_fract_f32 v8, v8
    v_fract_f32 v9, v9
    v_sin_f32 v10, v2
    v_sin_f32 v11, v3
    v_sin_f32 v12, v4
    v_sin_f32 v13, v5
    v_sin_f32 v14, v6
    v_sin_f32 v15, v7
    v_sin_f32 v16, v8
    v_sin_f32 v17, v9
    v_cos_f32 v2, v2
    v_cos_f32 v3, v3
    v_cos_f32 v4, v4
    v_cos_f32 v5, v5
    v_cos_f32 v6, v6
    v_cos_f32 v7, v7
    v_cos_f32 v8, v8
    v_cos_f32 v9, v9
    s_nop 0
    v_cvt_pk_bf16_f32 v224, v2, v10
    v_cvt_pk_bf16_f32 v225, v3, v11
    v_cvt_pk_bf16_f32 v226, v4, v12
    v_cvt_pk_bf16_f32 v227, v5, v13
    v_cvt_pk_bf16_f32 v228, v6, v14
    v_cvt_pk_bf16_f32 v229, v7, v15
    v_cvt_pk_bf16_f32 v230, v8, v16
    v_cvt_pk_bf16_f32 v231, v9, v17
    v_fmamk_f32 v2, v26, 0x41400000, v27
    v_fmamk_f32 v3, v26, 0x41500000, v27
    v_fmamk_f32 v4, v26, 0x42300000, v27
    v_fmamk_f32 v5, v26, 0x42340000, v27
    v_fmamk_f32 v6, v26, 0x41600000, v27
    v_fmamk_f32 v7, v26, 0x41700000, v27
    v_fmamk_f32 v8, v26, 0x42380000, v27
    v_fmamk_f32 v9, v26, 0x423c0000, v27
    v_fract_f32 v2, v2
    v_fract_f32 v3, v3
    v_fract_f32 v4, v4
    v_fract_f32 v5, v5
    v_fract_f32 v6, v6
    v_fract_f32 v7, v7
    v_fract_f32 v8, v8
    v_fract_f32 v9, v9
    v_sin_f32 v10, v2
    v_sin_f32 v11, v3
    v_sin_f32 v12, v4
    v_sin_f32 v13, v5
    v_sin_f32 v14, v6
    v_sin_f32 v15, v7
    v_sin_f32 v16, v8
    v_sin_f32 v17, v9
    v_cos_f32 v2, v2
    v_cos_f32 v3, v3
    v_cos_f32 v4, v4
    v_cos_f32 v5, v5
    v_cos_f32 v6, v6
    v_cos_f32 v7, v7
    v_cos_f32 v8, v8
    v_cos_f32 v9, v9
    s_nop 0
    v_cvt_pk_bf16_f32 v232, v2, v10
    v_cvt_pk_bf16_f32 v233, v3, v11
    v_cvt_pk_bf16_f32 v234, v4, v12
    v_cvt_pk_bf16_f32 v235, v5, v13
    v_cvt_pk_bf16_f32 v236, v6, v14
    v_cvt_pk_bf16_f32 v237, v7, v15
    v_cvt_pk_bf16_f32 v238, v8, v16
    v_cvt_pk_bf16_f32 v239, v9, v17
L2C_t23d:
    s_add_u32 s32, s78, 0x580000
    s_addc_u32 s33, s79, 0
    s_mov_b32 s34, 0x211000
    s_mov_b32 s35, 0x20000
    s_add_u32 s24, s78, 0x7a0000
    s_addc_u32 s25, s79, 0
    s_mov_b32 s26, 0x2000
    s_mov_b32 s27, 0x20000
    s_mov_b32 s28, s18
    s_mov_b32 s29, s19
    s_mov_b32 s30, 0x200000
    s_mov_b32 s31, 0x20000
    s_barrier
    s_branch L2C_wz1
L2C_wz:
    s_cmp_lg_u32 s45, 0
    s_cbranch_scc1 L2C_wz1
    s_waitcnt vmcnt(0)
    s_mov_b32 exec_hi, 0xffff
    buffer_load_dword v22, s[36:39], 0 offen sc1 lds
    s_mov_b64 exec, -1
    s_sleep 4
L2C_wz1:
    ds_read_b32 v19, v28
    s_waitcnt lgkmcnt(0)
    v_cmp_ne_u32 vcc, 2, v19
    s_cbranch_vccnz L2C_wz
    buffer_load_dword v10, v25, s[24:27], 0 offen sc1
    buffer_load_dwordx4 v[160:163], v23, s[32:35], s64 offen sc1
    s_add_u32 s64, s64, 4224
    buffer_load_dwordx4 v[164:167], v23, s[32:35], s64 offen sc1
    s_add_u32 s64, s64, 4224
    buffer_load_dwordx4 v[168:171], v23, s[32:35], s64 offen sc1
    s_add_u32 s64, s64, 4224
    buffer_load_dwordx4 v[172:175], v23, s[32:35], s64 offen sc1
    s_add_u32 s64, s64, 4224
    buffer_load_dwordx4 v[176:179], v23, s[32:35], s64 offen sc1
    s_add_u32 s64, s64, 4224
    buffer_load_dwordx4 v[180:183], v23, s[32:35], s64 offen sc1
    s_add_u32 s64, s64, 4224
    buffer_load_dwordx4 v[184:187], v23, s[32:35], s64 offen sc1
    s_add_u32 s64, s64, 4224
    buffer_load_dwordx4 v[188:191], v23, s[32:35], s64 offen sc1
    v_lshlrev_b32 v20, 4, v1
    s_lshl_b32 s42, s45, 14
    v_add_u32 v20, s42, v20
    s_waitcnt vmcnt(7)
    v_mfma_f32_32x32x16_bf16 v[192:207], v[160:163], v[208:211], 0
    s_waitcnt vmcnt(6)
    v_mfma_f32_32x32x16_bf16 v[192:207], v[164:167], v[212:215], v[192:207]
    s_waitcnt vmcnt(5)
    v_mfma_f32_32x32x16_bf16 v[192:207], v[168:171], v[216:219], v[192:207]
    s_waitcnt vmcnt(4)
    v_mfma_f32_32x32x16_bf16 v[192:207], v[172:175], v[220:223], v[192:207]
    s_waitcnt vmcnt(3)
    v_mfma_f32_32x32x16_bf16 v[192:207], v[176:179], v[224:227], v[192:207]
    s_waitcnt vmcnt(2)
    v_mfma_f32_32x32x16_bf16 v[192:207], v[180:183], v[228:231], v[192:207]
    s_waitcnt vmcnt(1)
    v_mfma_f32_32x32x16_bf16 v[192:207], v[184:187], v[232:235], v[192:207]
    s_waitcnt vmcnt(0)
    v_mfma_f32_32x32x16_bf16 v[192:207], v[188:191], v[236:239], v[192:207]
    v_sub_f32 v11, 1.0, v10
    v_cvt_pk_bf16_f32 v11, v11, v11
    v_and_b32 v12, 0xffff0000, v11
    v_and_b32 v13, 0xffff0000, v11
    s_nop 7
    s_nop 1
    v_mul_f32 v192, v10, v192
    v_mul_f32 v193, v10, v193
    v_mul_f32 v194, v10, v194
    v_mul_f32 v195, v10, v195
    v_mul_f32 v196, v10, v196
    v_mul_f32 v197, v10, v197
    v_mul_f32 v198, v10, v198
    v_mul_f32 v199, v10, v199
    v_mul_f32 v200, v10, v200
    v_mul_f32 v201, v10, v201
    v_mul_f32 v202, v10, v202
    v_mul_f32 v203, v10, v203
    v_mul_f32 v204, v10, v204
    v_mul_f32 v205, v10, v205
    v_mul_f32 v206, v10, v206
    v_mul_f32 v207, v10, v207
    s_barrier
    ds_read_b128 v[96:99], v20 offset:0
    ds_read_b128 v[100:103], v20 offset:1024
    ds_read_b128 v[112:115], v20 offset:2048
    ds_read_b128 v[116:119], v20 offset:3072
    ds_read_b128 v[128:131], v20 offset:4096
    ds_read_b128 v[132:135], v20 offset:5120
    ds_read_b128 v[144:147], v20 offset:6144
    ds_read_b128 v[148:151], v20 offset:7168
    ds_read_b128 v[104:107], v20 offset:8192
    ds_read_b128 v[108:111], v20 offset:9216
    ds_read_b128 v[120:123], v20 offset:10240
    ds_read_b128 v[124:127], v20 offset:11264
    ds_read_b128 v[136:139], v20 offset:12288
    ds_read_b128 v[140:143], v20 offset:13312
    ds_read_b128 v[152:155], v20 offset:14336
    s_waitcnt lgkmcnt(7)
    ds_read_b128 v[156:159], v20 offset:15360
    v_pk_add_f32 v[96:97], v[96:97], v[112:113]
    v_pk_add_f32 v[98:99], v[98:99], v[114:115]
    v_pk_add_f32 v[100:101], v[100:101], v[116:117]
    v_pk_add_f32 v[102:103], v[102:103], v[118:119]
    v_pk_add_f32 v[128:129], v[128:129], v[144:145]
    v_pk_add_f32 v[130:131], v[130:131], v[146:147]
    v_pk_add_f32 v[132:133], v[132:133], v[148:149]
    v_pk_add_f32 v[134:135], v[134:135], v[150:151]
    v_pk_add_f32 v[96:97], v[96:97], v[128:129]
    v_pk_add_f32 v[98:99], v[98:99], v[130:131]
    v_pk_add_f32 v[100:101], v[100:101], v[132:133]
    v_pk_add_f32 v[102:103], v[102:103], v[134:135]
    v_pk_fma_f32 v[192:193], v[96:97], v[12:13], v[192:193]
    v_pk_fma_f32 v[194:195], v[98:99], v[12:13], v[194:195]
    v_pk_fma_f32 v[196:197], v[100:101], v[12:13], v[196:197]
    v_pk_fma_f32 v[198:199], v[102:103], v[12:13], v[198:199]
    v_cvt_pk_bf16_f32 v32, v192, v193
    v_cvt_pk_bf16_f32 v33, v194, v195
    v_cvt_pk_bf16_f32 v34, v196, v197
    v_cvt_pk_bf16_f32 v35, v198, v199
    buffer_store_dwordx4 v[32:35], v24, s[28:31], 0 offen offset:0
    s_waitcnt lgkmcnt(0)
    v_pk_add_f32 v[104:105], v[104:105], v[120:121]
    v_pk_add_f32 v[106:107], v[106:107], v[122:123]
    v_pk_add_f32 v[108:109], v[108:109], v[124:125]
    v_pk_add_f32 v[110:111], v[110:111], v[126:127]
    v_pk_add_f32 v[136:137], v[136:137], v[152:153]
    v_pk_add_f32 v[138:139], v[138:139], v[154:155]
    v_pk_add_f32 v[140:141], v[140:141], v[156:157]
    v_pk_add_f32 v[142:143], v[142:143], v[158:159]
    v_pk_add_f32 v[104:105], v[104:105], v[136:137]
    v_pk_add_f32 v[106:107], v[106:107], v[138:139]
    v_pk_add_f32 v[108:109], v[108:109], v[140:141]
    v_pk_add_f32 v[110:111], v[110:111], v[142:143]
    v_pk_fma_f32 v[200:201], v[104:105], v[12:13], v[200:201]
    v_pk_fma_f32 v[202:203], v[106:107], v[12:13], v[202:203]
    v_pk_fma_f32 v[204:205], v[108:109], v[12:13], v[204:205]
    v_pk_fma_f32 v[206:207], v[110:111], v[12:13], v[206:207]
    v_cvt_pk_bf16_f32 v36, v200, v201
    v_cvt_pk_bf16_f32 v37, v202, v203
    v_cvt_pk_bf16_f32 v38, v204, v205
    v_cvt_pk_bf16_f32 v39, v206, v207
    buffer_store_dwordx4 v[36:39], v24, s[28:31], 0 offen offset:16
    s_endpgm
L1C_specs:
    s_mov_b32 s65, 2
    v_and_b32 v20, 15, v1
    v_cvt_f32_u32 v20, v20
    v_mul_f32 v20, 0x3d000000, v20
    v_lshrrev_b32 v21, 4, v1
    v_cvt_f32_u32 v21, v21
    v_mul_f32 v21, 4.0, v21
    v_mul_f32 v22, v20, v21
    v_fmamk_f32 v96, v20, 0x0, v22
    v_fmamk_f32 v97, v20, 0x3f800000, v22
    v_fmamk_f32 v98, v20, 0x40000000, v22
    v_fmamk_f32 v99, v20, 0x40400000, v22
    v_fmamk_f32 v100, v20, 0x41800000, v22
    v_fmamk_f32 v101, v20, 0x41880000, v22
    v_fmamk_f32 v102, v20, 0x41900000, v22
    v_fmamk_f32 v103, v20, 0x41980000, v22
    v_add_f32 v20, 0.5, v20
    v_mul_f32 v22, v20, v21
    v_fmamk_f32 v104, v20, 0x0, v22
    v_fmamk_f32 v105, v20, 0x3f800000, v22
    v_fmamk_f32 v106, v20, 0x40000000, v22
    v_fmamk_f32 v107, v20, 0x40400000, v22
    v_fmamk_f32 v108, v20, 0x41800000, v22
    v_fmamk_f32 v109, v20, 0x41880000, v22
    v_fmamk_f32 v110, v20, 0x41900000, v22
    v_fmamk_f32 v111, v20, 0x41980000, v22
    v_fract_f32 v96, v96
    v_fract_f32 v97, v97
    v_fract_f32 v98, v98
    v_fract_f32 v99, v99
    v_fract_f32 v100, v100
    v_fract_f32 v101, v101
    v_fract_f32 v102, v102
    v_fract_f32 v103, v103
    v_fract_f32 v104, v104
    v_fract_f32 v105, v105
    v_fract_f32 v106, v106
    v_fract_f32 v107, v107
    v_fract_f32 v108, v108
    v_fract_f32 v109, v109
    v_fract_f32 v110, v110
    v_fract_f32 v111, v111
    v_sin_f32 v112, v96
    v_sin_f32 v113, v97
    v_sin_f32 v114, v98
    v_sin_f32 v115, v99
    v_sin_f32 v116, v100
    v_sin_f32 v117, v101
    v_sin_f32 v118, v102
    v_sin_f32 v119, v103
    v_sin_f32 v120, v104
    v_sin_f32 v121, v105
    v_sin_f32 v122, v106
    v_sin_f32 v123, v107
    v_sin_f32 v124, v108
    v_sin_f32 v125, v109
    v_sin_f32 v126, v110
    v_sin_f32 v127, v111
    v_cos_f32 v96, v96
    v_cos_f32 v97, v97
    v_cos_f32 v98, v98
    v_cos_f32 v99, v99
    v_cos_f32 v100, v100
    v_cos_f32 v101, v101
    v_cos_f32 v102, v102
    v_cos_f32 v103, v103
    v_cos_f32 v104, v104
    v_cos_f32 v105, v105
    v_cos_f32 v106, v106
    v_cos_f32 v107, v107
    v_cos_f32 v108, v108
    v_cos_f32 v109, v109
    v_cos_f32 v110, v110
    v_cos_f32 v111, v111
    s_nop 0
    v_cvt_pk_bf16_f32 v212, v96, v97
    v_cvt_pk_bf16_f32 v220, v112, v113
    v_cvt_pk_bf16_f32 v213, v98, v99
    v_cvt_pk_bf16_f32 v221, v114, v115
    v_cvt_pk_bf16_f32 v214, v100, v101
    v_cvt_pk_bf16_f32 v222, v116, v117
    v_cvt_pk_bf16_f32 v215, v102, v103
    v_cvt_pk_bf16_f32 v223, v118, v119
    v_cvt_pk_bf16_f32 v216, v104, v105
    v_cvt_pk_bf16_f32 v224, v120, v121
    v_cvt_pk_bf16_f32 v217, v106, v107
    v_cvt_pk_bf16_f32 v225, v122, v123
    v_cvt_pk_bf16_f32 v218, v108, v109
    v_cvt_pk_bf16_f32 v226, v124, v125
    v_cvt_pk_bf16_f32 v219, v110, v111
    v_cvt_pk_bf16_f32 v227, v126, v127
    s_cmp_eq_u32 s46, 3
    s_cbranch_scc1 L1C_spec4g
L1C_spec6:
    s_mul_i32 s41, s41, 3
    s_add_u32 s42, s41, 0
    s_lshl_b32 s42, s42, 5
    v_xor_b32 v2, s42, v10
    s_add_u32 s42, s41, 1
    s_lshl_b32 s42, s42, 5
    v_xor_b32 v3, s42, v10
    s_add_u32 s42, s41, 2
    s_lshl_b32 s42, s42, 5
    v_xor_b32 v4, s42, v10
    v_lshrrev_b32 v21, 4, v1
    v_mul_u32_u24 v21, 270848, v21
    v_and_b32 v20, 15, v1
    v_lshl_add_u32 v14, v20, 4, v21
    s_add_u32 s32, s78, 0x580000
    s_addc_u32 s33, s79, 0
    s_mov_b32 s34, 0x211000
    s_mov_b32 s35, 0x20000
    s_mul_i32 s42, s22, 96
    s_mul_i32 s43, s21, 264
    s_add_u32 s42, s42, s43
    s_lshr_b32 s43, s45, 1
    s_lshl_b32 s43, s43, 4
    s_add_u32 s42, s42, s43
    s_lshl_b32 s42, s42, 4
    s_and_b32 s43, s45, 1
    s_mul_i32 s43, s43, 1083392
    s_add_u32 s42, s42, s43
    s_barrier
    ds_read_b128 v[52:55], v6 offset:0
    ds_read_b128 v[56:59], v7 offset:0
    ds_read_b128 v[60:63], v6 offset:2048
    ds_read_b128 v[64:67], v7 offset:2048
    ds_read_b128 v[68:71], v8 offset:0
    ds_read_b128 v[72:75], v9 offset:0
    ds_read_b128 v[76:79], v8 offset:2048
    ds_read_b128 v[80:83], v9 offset:2048
    ds_read_b64_tr_b16 v[28:29], v2 offset:0
    ds_read_b64_tr_b16 v[30:31], v2 offset:1024
    ds_read_b64_tr_b16 v[32:33], v2 offset:16384
    ds_read_b64_tr_b16 v[34:35], v2 offset:17408
    v_add_u32 v6, 49152, v6
    v_add_u32 v7, 49152, v7
    v_add_u32 v8, 49152, v8
    v_add_u32 v9, 49152, v9
    ds_read_b64_tr_b16 v[36:37], v3 offset:0
    ds_read_b64_tr_b16 v[38:39], v3 offset:1024
    ds_read_b64_tr_b16 v[40:41], v3 offset:16384
    s_waitcnt lgkmcnt(10)
    ds_read_b64_tr_b16 v[42:43], v3 offset:17408
    s_waitcnt lgkmcnt(4)
    v_mfma_f32_16x16x32_bf16 v[116:119], v[52:55], v[28:31], 0
    ds_read_b64_tr_b16 v[44:45], v4 offset:0
    v_mfma_f32_16x16x32_bf16 v[124:127], v[52:55], v[32:35], 0
    ds_read_b64_tr_b16 v[46:47], v4 offset:1024
    v_mfma_f32_16x16x32_bf16 v[120:123], v[60:63], v[28:31], 0
    ds_read_b64_tr_b16 v[48:49], v4 offset:16384
    v_mfma_f32_16x16x32_bf16 v[128:131], v[60:63], v[32:35], 0
    ds_read_b64_tr_b16 v[50:51], v4 offset:17408
    v_mfma_f32_16x16x32_bf16 v[132:135], v[68:71], v[28:31], 0
    v_mfma_f32_16x16x32_bf16 v[140:143], v[68:71], v[32:35], 0
    v_mfma_f32_16x16x32_bf16 v[136:139], v[76:79], v[28:31], 0
    v_mfma_f32_16x16x32_bf16 v[144:147], v[76:79], v[32:35], 0
    s_waitcnt lgkmcnt(4)
    v_mfma_f32_16x16x32_bf16 v[148:151], v[52:55], v[36:39], 0
    v_mfma_f32_16x16x32_bf16 v[156:159], v[52:55], v[40:43], 0
    v_mfma_f32_16x16x32_bf16 v[152:155], v[60:63], v[36:39], 0
    v_mfma_f32_16x16x32_bf16 v[160:163], v[60:63], v[40:43], 0
    s_waitcnt lgkmcnt(0)
    s_barrier
    ds_read_b64_tr_b16 v[28:29], v2 offset:8192
    ds_read_b64_tr_b16 v[30:31], v2 offset:9216
    v_mfma_f32_16x16x32_bf16 v[164:167], v[68:71], v[36:39], 0
    ds_read_b64_tr_b16 v[32:33], v2 offset:24576
    ds_read_b64_tr_b16 v[34:35], v2 offset:25600
    v_mfma_f32_16x16x32_bf16 v[172:175], v[68:71], v[40:43], 0
    v_add_u32 v2, 49152, v2
    v_mfma_f32_16x16x32_bf16 v[168:171], v[76:79], v[36:39], 0
    v_mfma_f32_16x16x32_bf16 v[176:179], v[76:79], v[40:43], 0
    s_waitcnt lgkmcnt(4)
    v_mfma_f32_16x16x32_bf16 v[180:183], v[52:55], v[44:47], 0
    ds_read_b64_tr_b16 v[36:37], v3 offset:8192
    v_mfma_f32_16x16x32_bf16 v[188:191], v[52:55], v[48:51], 0
    ds_read_b64_tr_b16 v[38:39], v3 offset:9216
    v_mfma_f32_16x16x32_bf16 v[184:187], v[60:63], v[44:47], 0
    ds_read_b64_tr_b16 v[40:41], v3 offset:24576
    v_mfma_f32_16x16x32_bf16 v[192:195], v[60:63], v[48:51], 0
    ds_read_b64_tr_b16 v[42:43], v3 offset:25600
    v_mfma_f32_16x16x32_bf16 v[196:199], v[68:71], v[44:47], 0
    v_add_u32 v3, 49152, v3
    v_mfma_f32_16x16x32_bf16 v[204:207], v[68:71], v[48:51], 0
    v_mfma_f32_16x16x32_bf16 v[200:203], v[76:79], v[44:47], 0
    v_mfma_f32_16x16x32_bf16 v[208:211], v[76:79], v[48:51], 0
    s_waitcnt lgkmcnt(4)
    v_mfma_f32_16x16x32_bf16 v[116:119], v[56:59], v[28:31], v[116:119]
    ds_read_b64_tr_b16 v[44:45], v4 offset:8192
    v_mfma_f32_16x16x32_bf16 v[124:127], v[56:59], v[32:35], v[124:127]
    ds_read_b64_tr_b16 v[46:47], v4 offset:9216
    v_mfma_f32_16x16x32_bf16 v[120:123], v[64:67], v[28:31], v[120:123]
    ds_read_b64_tr_b16 v[48:49], v4 offset:24576
    v_mfma_f32_16x16x32_bf16 v[128:131], v[64:67], v[32:35], v[128:131]
    ds_read_b64_tr_b16 v[50:51], v4 offset:25600
    v_mfma_f32_16x16x32_bf16 v[132:135], v[72:75], v[28:31], v[132:135]
    v_add_u32 v4, 49152, v4
    v_mfma_f32_16x16x32_bf16 v[140:143], v[72:75], v[32:35], v[140:143]
    v_mfma_f32_16x16x32_bf16 v[136:139], v[80:83], v[28:31], v[136:139]
    v_mfma_f32_16x16x32_bf16 v[144:147], v[80:83], v[32:35], v[144:147]
    s_waitcnt lgkmcnt(4)
    v_mfma_f32_16x16x32_bf16 v[148:151], v[56:59], v[36:39], v[148:151]
    v_mfma_f32_16x16x32_bf16 v[156:159], v[56:59], v[40:43], v[156:159]
    v_mfma_f32_16x16x32_bf16 v[152:155], v[64:67], v[36:39], v[152:155]
    v_mfma_f32_16x16x32_bf16 v[160:163], v[64:67], v[40:43], v[160:163]
    s_waitcnt lgkmcnt(0)
    s_barrier
    ds_read_b128 v[84:87], v6 offset:0
    ds_read_b128 v[88:91], v7 offset:0
    v_mfma_f32_16x16x32_bf16 v[164:167], v[72:75], v[36:39], v[164:167]
    ds_read_b128 v[92:95], v6 offset:2048
    ds_read_b128 v[96:99], v7 offset:2048
    v_mfma_f32_16x16x32_bf16 v[172:175], v[72:75], v[40:43], v[172:175]
    ds_read_b128 v[100:103], v8 offset:0
    ds_read_b128 v[104:107], v9 offset:0
    v_mfma_f32_16x16x32_bf16 v[168:171], v[80:83], v[36:39], v[168:171]
    ds_read_b128 v[108:111], v8 offset:2048
    ds_read_b128 v[112:115], v9 offset:2048
    v_mfma_f32_16x16x32_bf16 v[176:179], v[80:83], v[40:43], v[176:179]
    ds_read_b64_tr_b16 v[28:29], v2 offset:0
    ds_read_b64_tr_b16 v[30:31], v2 offset:1024
    s_waitcnt lgkmcnt(10)
    v_mfma_f32_16x16x32_bf16 v[180:183], v[56:59], v[44:47], v[180:183]
    ds_read_b64_tr_b16 v[32:33], v2 offset:8192
    ds_read_b64_tr_b16 v[34:35], v2 offset:9216
    v_mfma_f32_16x16x32_bf16 v[188:191], v[56:59], v[48:51], v[188:191]
    v_add_u32 v6, 49152, v6
    v_add_u32 v7, 49152, v7
    v_mfma_f32_16x16x32_bf16 v[184:187], v[64:67], v[44:47], v[184:187]
    v_add_u32 v8, 49152, v8
    v_add_u32 v9, 49152, v9
    v_mfma_f32_16x16x32_bf16 v[192:195], v[64:67], v[48:51], v[192:195]
    ds_read_b64_tr_b16 v[36:37], v2 offset:16384
    v_mfma_f32_16x16x32_bf16 v[196:199], v[72:75], v[44:47], v[196:199]
    ds_read_b64_tr_b16 v[38:39], v2 offset:17408
    v_mfma_f32_16x16x32_bf16 v[204:207], v[72:75], v[48:51], v[204:207]
    ds_read_b64_tr_b16 v[40:41], v2 offset:24576
    v_mfma_f32_16x16x32_bf16 v[200:203], v[80:83], v[44:47], v[200:203]
    s_waitcnt lgkmcnt(10)
    ds_read_b64_tr_b16 v[42:43], v2 offset:25600
    v_mfma_f32_16x16x32_bf16 v[208:211], v[80:83], v[48:51], v[208:211]
    v_add_u32 v2, 49152, v2
    s_waitcnt lgkmcnt(4)
    v_mfma_f32_16x16x32_bf16 v[116:119], v[84:87], v[28:31], v[116:119]
    ds_read_b64_tr_b16 v[44:45], v3 offset:0
    v_mfma_f32_16x16x32_bf16 v[116:119], v[88:91], v[32:35], v[116:119]
    ds_read_b64_tr_b16 v[46:47], v3 offset:1024
    v_mfma_f32_16x16x32_bf16 v[120:123], v[96:99], v[32:35], v[120:123]
    ds_read_b64_tr_b16 v[48:49], v3 offset:8192
    v_mfma_f32_16x16x32_bf16 v[120:123], v[92:95], v[28:31], v[120:123]
    ds_read_b64_tr_b16 v[50:51], v3 offset:9216
    v_mfma_f32_16x16x32_bf16 v[132:135], v[100:103], v[28:31], v[132:135]
    v_mfma_f32_16x16x32_bf16 v[132:135], v[104:107], v[32:35], v[132:135]
    v_mfma_f32_16x16x32_bf16 v[136:139], v[112:115], v[32:35], v[136:139]
    v_mfma_f32_16x16x32_bf16 v[136:139], v[108:111], v[28:31], v[136:139]
    s_waitcnt lgkmcnt(4)
    v_mfma_f32_16x16x32_bf16 v[124:127], v[84:87], v[36:39], v[124:127]
    ds_read_b64_tr_b16 v[28:29], v3 offset:16384
    v_mfma_f32_16x16x32_bf16 v[124:127], v[88:91], v[40:43], v[124:127]
    ds_read_b64_tr_b16 v[30:31], v3 offset:17408
    v_mfma_f32_16x16x32_bf16 v[128:131], v[96:99], v[40:43], v[128:131]
    ds_read_b64_tr_b16 v[32:33], v3 offset:24576
    v_mfma_f32_16x16x32_bf16 v[128:131], v[92:95], v[36:39], v[128:131]
    ds_read_b64_tr_b16 v[34:35], v3 offset:25600
    v_mfma_f32_16x16x32_bf16 v[140:143], v[100:103], v[36:39], v[140:143]
    v_add_u32 v3, 49152, v3
    v_mfma_f32_16x16x32_bf16 v[140:143], v[104:107], v[40:43], v[140:143]
    v_mfma_f32_16x16x32_bf16 v[144:147], v[112:115], v[40:43], v[144:147]
    v_mfma_f32_16x16x32_bf16 v[144:147], v[108:111], v[36:39], v[144:147]
    s_waitcnt lgkmcnt(4)
    v_mfma_f32_16x16x32_bf16 v[148:151], v[84:87], v[44:47], v[148:151]
    ds_read_b64_tr_b16 v[36:37], v4 offset:0
    v_mfma_f32_16x16x32_bf16 v[148:151], v[88:91], v[48:51], v[148:151]
    ds_read_b64_tr_b16 v[38:39], v4 offset:1024
    v_mfma_f32_16x16x32_bf16 v[152:155], v[96:99], v[48:51], v[152:155]
    ds_read_b64_tr_b16 v[40:41], v4 offset:8192
    v_mfma_f32_16x16x32_bf16 v[152:155], v[92:95], v[44:47], v[152:155]
    ds_read_b64_tr_b16 v[42:43], v4 offset:9216
    v_mfma_f32_16x16x32_bf16 v[164:167], v[100:103], v[44:47], v[164:167]
    v_mfma_f32_16x16x32_bf16 v[164:167], v[104:107], v[48:51], v[164:167]
    v_mfma_f32_16x16x32_bf16 v[168:171], v[112:115], v[48:51], v[168:171]
    v_mfma_f32_16x16x32_bf16 v[168:171], v[108:111], v[44:47], v[168:171]
    s_waitcnt lgkmcnt(4)
    v_mfma_f32_16x16x32_bf16 v[156:159], v[84:87], v[28:31], v[156:159]
    ds_read_b64_tr_b16 v[44:45], v4 offset:16384
    v_mfma_f32_16x16x32_bf16 v[156:159], v[88:91], v[32:35], v[156:159]
    ds_read_b64_tr_b16 v[46:47], v4 offset:17408
    v_mfma_f32_16x16x32_bf16 v[160:163], v[96:99], v[32:35], v[160:163]
    ds_read_b64_tr_b16 v[48:49], v4 offset:24576
    v_mfma_f32_16x16x32_bf16 v[160:163], v[92:95], v[28:31], v[160:163]
    ds_read_b64_tr_b16 v[50:51], v4 offset:25600
    v_mfma_f32_16x16x32_bf16 v[172:175], v[100:103], v[28:31], v[172:175]
    v_add_u32 v4, 49152, v4
    v_mfma_f32_16x16x32_bf16 v[172:175], v[104:107], v[32:35], v[172:175]
    v_mfma_f32_16x16x32_bf16 v[176:179], v[112:115], v[32:35], v[176:179]
    v_mfma_f32_16x16x32_bf16 v[176:179], v[108:111], v[28:31], v[176:179]
    s_waitcnt lgkmcnt(4)
    v_mfma_f32_16x16x32_bf16 v[180:183], v[84:87], v[36:39], v[180:183]
    v_mfma_f32_16x16x32_bf16 v[180:183], v[88:91], v[40:43], v[180:183]
    v_mfma_f32_16x16x32_bf16 v[184:187], v[96:99], v[40:43], v[184:187]
    v_mfma_f32_16x16x32_bf16 v[184:187], v[92:95], v[36:39], v[184:187]
    s_waitcnt lgkmcnt(0)
    s_barrier
    ds_read_b128 v[52:55], v6 offset:0
    ds_read_b128 v[56:59], v7 offset:0
    v_mfma_f32_16x16x32_bf16 v[196:199], v[100:103], v[36:39], v[196:199]
    ds_read_b128 v[60:63], v6 offset:2048
    ds_read_b128 v[64:67], v7 offset:2048
    v_mfma_f32_16x16x32_bf16 v[196:199], v[104:107], v[40:43], v[196:199]
    ds_read_b128 v[68:71], v8 offset:0
    ds_read_b128 v[72:75], v9 offset:0
    v_mfma_f32_16x16x32_bf16 v[200:203], v[112:115], v[40:43], v[200:203]
    ds_read_b128 v[76:79], v8 offset:2048
    ds_read_b128 v[80:83], v9 offset:2048
    v_mfma_f32_16x16x32_bf16 v[200:203], v[108:111], v[36:39], v[200:203]
    ds_read_b64_tr_b16 v[28:29], v2 offset:0
    ds_read_b64_tr_b16 v[30:31], v2 offset:1024
    s_waitcnt lgkmcnt(10)
    v_mfma_f32_16x16x32_bf16 v[188:191], v[84:87], v[44:47], v[188:191]
    ds_read_b64_tr_b16 v[32:33], v2 offset:8192
    ds_read_b64_tr_b16 v[34:35], v2 offset:9216
    v_mfma_f32_16x16x32_bf16 v[188:191], v[88:91], v[48:51], v[188:191]
    v_subrev_u32 v6, 98304, v6
    v_subrev_u32 v7, 98304, v7
    v_mfma_f32_16x16x32_bf16 v[192:195], v[96:99], v[48:51], v[192:195]
    v_subrev_u32 v8, 98304, v8
    v_subrev_u32 v9, 98304, v9
    v_mfma_f32_16x16x32_bf16 v[192:195], v[92:95], v[44:47], v[192:195]
    ds_read_b64_tr_b16 v[36:37], v2 offset:16384
    v_mfma_f32_16x16x32_bf16 v[204:207], v[100:103], v[44:47], v[204:207]
    ds_read_b64_tr_b16 v[38:39], v2 offset:17408
    v_mfma_f32_16x16x32_bf16 v[204:207], v[104:107], v[48:51], v[204:207]
    ds_read_b64_tr_b16 v[40:41], v2 offset:24576
    v_mfma_f32_16x16x32_bf16 v[208:211], v[112:115], v[48:51], v[208:211]
    s_waitcnt lgkmcnt(10)
    ds_read_b64_tr_b16 v[42:43], v2 offset:25600
    v_mfma_f32_16x16x32_bf16 v[208:211], v[108:111], v[44:47], v[208:211]
    v_subrev_u32 v2, 98304, v2
    s_waitcnt lgkmcnt(4)
    v_mfma_f32_16x16x32_bf16 v[116:119], v[52:55], v[28:31], v[116:119]
    ds_read_b64_tr_b16 v[44:45], v3 offset:0
    v_mfma_f32_16x16x32_bf16 v[116:119], v[56:59], v[32:35], v[116:119]
    ds_read_b64_tr_b16 v[46:47], v3 offset:1024
    v_mfma_f32_16x16x32_bf16 v[120:123], v[64:67], v[32:35], v[120:123]
    ds_read_b64_tr_b16 v[48:49], v3 offset:8192
    v_mfma_f32_16x16x32_bf16 v[120:123], v[60:63], v[28:31], v[120:123]
    ds_read_b64_tr_b16 v[50:51], v3 offset:9216
    v_mfma_f32_16x16x32_bf16 v[132:135], v[68:71], v[28:31], v[132:135]
    v_mfma_f32_16x16x32_bf16 v[132:135], v[72:75], v[32:35], v[132:135]
    v_mfma_f32_16x16x32_bf16 v[136:139], v[80:83], v[32:35], v[136:139]
    v_mfma_f32_16x16x32_bf16 v[136:139], v[76:79], v[28:31], v[136:139]
    s_waitcnt lgkmcnt(4)
    v_mfma_f32_16x16x32_bf16 v[124:127], v[52:55], v[36:39], v[124:127]
    ds_read_b64_tr_b16 v[28:29], v3 offset:16384
    v_mfma_f32_16x16x32_bf16 v[124:127], v[56:59], v[40:43], v[124:127]
    ds_read_b64_tr_b16 v[30:31], v3 offset:17408
    v_mfma_f32_16x16x32_bf16 v[128:131], v[64:67], v[40:43], v[128:131]
    ds_read_b64_tr_b16 v[32:33], v3 offset:24576
    v_mfma_f32_16x16x32_bf16 v[128:131], v[60:63], v[36:39], v[128:131]
    ds_read_b64_tr_b16 v[34:35], v3 offset:25600
    v_mfma_f32_16x16x32_bf16 v[140:143], v[68:71], v[36:39], v[140:143]
    v_subrev_u32 v3, 98304, v3
    v_mfma_f32_16x16x32_bf16 v[140:143], v[72:75], v[40:43], v[140:143]
    v_mfma_f32_16x16x32_bf16 v[144:147], v[80:83], v[40:43], v[144:147]
    v_mfma_f32_16x16x32_bf16 v[144:147], v[76:79], v[36:39], v[144:147]
    s_waitcnt lgkmcnt(4)
    v_mfma_f32_16x16x32_bf16 v[148:151], v[52:55], v[44:47], v[148:151]
    ds_read_b64_tr_b16 v[36:37], v4 offset:0
    v_mfma_f32_16x16x32_bf16 v[148:151], v[56:59], v[48:51], v[148:151]
    ds_read_b64_tr_b16 v[38:39], v4 offset:1024
    v_mfma_f32_16x16x32_bf16 v[152:155], v[64:67], v[48:51], v[152:155]
    ds_read_b64_tr_b16 v[40:41], v4 offset:8192
    v_mfma_f32_16x16x32_bf16 v[152:155], v[60:63], v[44:47], v[152:155]
    ds_read_b64_tr_b16 v[42:43], v4 offset:9216
    v_mfma_f32_16x16x32_bf16 v[164:167], v[68:71], v[44:47], v[164:167]
    v_mfma_f32_16x16x32_bf16 v[164:167], v[72:75], v[48:51], v[164:167]
    v_mfma_f32_16x16x32_bf16 v[168:171], v[80:83], v[48:51], v[168:171]
    v_mfma_f32_16x16x32_bf16 v[168:171], v[76:79], v[44:47], v[168:171]
    s_waitcnt lgkmcnt(4)
    v_mfma_f32_16x16x32_bf16 v[156:159], v[52:55], v[28:31], v[156:159]
    ds_read_b64_tr_b16 v[44:45], v4 offset:16384
    v_mfma_f32_16x16x32_bf16 v[156:159], v[56:59], v[32:35], v[156:159]
    ds_read_b64_tr_b16 v[46:47], v4 offset:17408
    v_mfma_f32_16x16x32_bf16 v[160:163], v[64:67], v[32:35], v[160:163]
    ds_read_b64_tr_b16 v[48:49], v4 offset:24576
    v_mfma_f32_16x16x32_bf16 v[160:163], v[60:63], v[28:31], v[160:163]
    ds_read_b64_tr_b16 v[50:51], v4 offset:25600
    v_mfma_f32_16x16x32_bf16 v[172:175], v[68:71], v[28:31], v[172:175]
    v_subrev_u32 v4, 98304, v4
    v_mfma_f32_16x16x32_bf16 v[172:175], v[72:75], v[32:35], v[172:175]
    v_mfma_f32_16x16x32_bf16 v[176:179], v[80:83], v[32:35], v[176:179]
    v_mfma_f32_16x16x32_bf16 v[176:179], v[76:79], v[28:31], v[176:179]
    s_waitcnt lgkmcnt(4)
    v_mfma_f32_16x16x32_bf16 v[180:183], v[52:55], v[36:39], v[180:183]
    v_mfma_f32_16x16x32_bf16 v[180:183], v[56:59], v[40:43], v[180:183]
    v_mfma_f32_16x16x32_bf16 v[184:187], v[64:67], v[40:43], v[184:187]
    v_mfma_f32_16x16x32_bf16 v[184:187], v[60:63], v[36:39], v[184:187]
    s_waitcnt lgkmcnt(0)
    s_barrier
    ds_read_b128 v[84:87], v6 offset:0
    ds_read_b128 v[88:91], v7 offset:0
    v_mfma_f32_16x16x32_bf16 v[196:199], v[68:71], v[36:39], v[196:199]
    ds_read_b128 v[92:95], v6 offset:2048
    ds_read_b128 v[96:99], v7 offset:2048
    v_mfma_f32_16x16x32_bf16 v[196:199], v[72:75], v[40:43], v[196:199]
    ds_read_b128 v[100:103], v8 offset:0
    ds_read_b128 v[104:107], v9 offset:0
    v_mfma_f32_16x16x32_bf16 v[200:203], v[80:83], v[40:43], v[200:203]
    ds_read_b128 v[108:111], v8 offset:2048
    ds_read_b128 v[112:115], v9 offset:2048
    v_mfma_f32_16x16x32_bf16 v[200:203], v[76:79], v[36:39], v[200:203]
    ds_read_b64_tr_b16 v[28:29], v2 offset:0
    ds_read_b64_tr_b16 v[30:31], v2 offset:1024
    s_waitcnt lgkmcnt(10)
    v_mfma_f32_16x16x32_bf16 v[188:191], v[52:55], v[44:47], v[188:191]
    ds_read_b64_tr_b16 v[32:33], v2 offset:8192
    ds_read_b64_tr_b16 v[34:35], v2 offset:9216
    v_mfma_f32_16x16x32_bf16 v[188:191], v[56:59], v[48:51], v[188:191]
    v_add_u32 v6, 49152, v6
    v_add_u32 v7, 49152, v7
    v_mfma_f32_16x16x32_bf16 v[192:195], v[64:67], v[48:51], v[192:195]
    v_add_u32 v8, 49152, v8
    v_add_u32 v9, 49152, v9
    v_mfma_f32_16x16x32_bf16 v[192:195], v[60:63], v[44:47], v[192:195]
    ds_read_b64_tr_b16 v[36:37], v2 offset:16384
    v_mfma_f32_16x16x32_bf16 v[204:207], v[68:71], v[44:47], v[204:207]
    ds_read_b64_tr_b16 v[38:39], v2 offset:17408
    v_mfma_f32_16x16x32_bf16 v[204:207], v[72:75], v[48:51], v[204:207]
    ds_read_b64_tr_b16 v[40:41], v2 offset:24576
    v_mfma_f32_16x16x32_bf16 v[208:211], v[80:83], v[48:51], v[208:211]
    s_waitcnt lgkmcnt(10)
    ds_read_b64_tr_b16 v[42:43], v2 offset:25600
    v_mfma_f32_16x16x32_bf16 v[208:211], v[76:79], v[44:47], v[208:211]
    v_add_u32 v2, 49152, v2
    s_waitcnt lgkmcnt(4)
    v_mfma_f32_16x16x32_bf16 v[116:119], v[84:87], v[28:31], v[116:119]
    ds_read_b64_tr_b16 v[44:45], v3 offset:0
    v_mfma_f32_16x16x32_bf16 v[116:119], v[88:91], v[32:35], v[116:119]
    ds_read_b64_tr_b16 v[46:47], v3 offset:1024
    v_mfma_f32_16x16x32_bf16 v[120:123], v[96:99], v[32:35], v[120:123]
    ds_read_b64_tr_b16 v[48:49], v3 offset:8192
    v_mfma_f32_16x16x32_bf16 v[120:123], v[92:95], v[28:31], v[120:123]
    ds_read_b64_tr_b16 v[50:51], v3 offset:9216
    v_mfma_f32_16x16x32_bf16 v[132:135], v[100:103], v[28:31], v[132:135]
    v_mfma_f32_16x16x32_bf16 v[132:135], v[104:107], v[32:35], v[132:135]
    v_mfma_f32_16x16x32_bf16 v[136:139], v[112:115], v[32:35], v[136:139]
    v_mfma_f32_16x16x32_bf16 v[136:139], v[108:111], v[28:31], v[136:139]
    s_waitcnt lgkmcnt(4)
    v_mfma_f32_16x16x32_bf16 v[124:127], v[84:87], v[36:39], v[124:127]
    ds_read_b64_tr_b16 v[28:29], v3 offset:16384
    v_mfma_f32_16x16x32_bf16 v[124:127], v[88:91], v[40:43], v[124:127]
    ds_read_b64_tr_b16 v[30:31], v3 offset:17408
    v_mfma_f32_16x16x32_bf16 v[128:131], v[96:99], v[40:43], v[128:131]
    ds_read_b64_tr_b16 v[32:33], v3 offset:24576
    v_mfma_f32_16x16x32_bf16 v[128:131], v[92:95], v[36:39], v[128:131]
    ds_read_b64_tr_b16 v[34:35], v3 offset:25600
    v_mfma_f32_16x16x32_bf16 v[140:143], v[100:103], v[36:39], v[140:143]
    v_add_u32 v3, 49152, v3
    v_mfma_f32_16x16x32_bf16 v[140:143], v[104:107], v[40:43], v[140:143]
    v_mfma_f32_16x16x32_bf16 v[144:147], v[112:115], v[40:43], v[144:147]
    v_mfma_f32_16x16x32_bf16 v[144:147], v[108:111], v[36:39], v[144:147]
    s_waitcnt lgkmcnt(4)
    v_mfma_f32_16x16x32_bf16 v[148:151], v[84:87], v[44:47], v[148:151]
    ds_read_b64_tr_b16 v[36:37], v4 offset:0
    v_mfma_f32_16x16x32_bf16 v[148:151], v[88:91], v[48:51], v[148:151]
    ds_read_b64_tr_b16 v[38:39], v4 offset:1024
    v_mfma_f32_16x16x32_bf16 v[152:155], v[96:99], v[48:51], v[152:155]
    ds_read_b64_tr_b16 v[40:41], v4 offset:8192
    v_mfma_f32_16x16x32_bf16 v[152:155], v[92:95], v[44:47], v[152:155]
    ds_read_b64_tr_b16 v[42:43], v4 offset:9216
    v_mfma_f32_16x16x32_bf16 v[164:167], v[100:103], v[44:47], v[164:167]
    v_mfma_f32_16x16x32_bf16 v[164:167], v[104:107], v[48:51], v[164:167]
    v_mfma_f32_16x16x32_bf16 v[168:171], v[112:115], v[48:51], v[168:171]
    v_mfma_f32_16x16x32_bf16 v[168:171], v[108:111], v[44:47], v[168:171]
    s_waitcnt lgkmcnt(4)
    v_mfma_f32_16x16x32_bf16 v[156:159], v[84:87], v[28:31], v[156:159]
    ds_read_b64_tr_b16 v[44:45], v4 offset:16384
    v_mfma_f32_16x16x32_bf16 v[156:159], v[88:91], v[32:35], v[156:159]
    ds_read_b64_tr_b16 v[46:47], v4 offset:17408
    v_mfma_f32_16x16x32_bf16 v[160:163], v[96:99], v[32:35], v[160:163]
    ds_read_b64_tr_b16 v[48:49], v4 offset:24576
    v_mfma_f32_16x16x32_bf16 v[160:163], v[92:95], v[28:31], v[160:163]
    ds_read_b64_tr_b16 v[50:51], v4 offset:25600
    v_mfma_f32_16x16x32_bf16 v[172:175], v[100:103], v[28:31], v[172:175]
    v_add_u32 v4, 49152, v4
    v_mfma_f32_16x16x32_bf16 v[172:175], v[104:107], v[32:35], v[172:175]
    v_mfma_f32_16x16x32_bf16 v[176:179], v[112:115], v[32:35], v[176:179]
    v_mfma_f32_16x16x32_bf16 v[176:179], v[108:111], v[28:31], v[176:179]
    s_waitcnt lgkmcnt(4)
    v_mfma_f32_16x16x32_bf16 v[180:183], v[84:87], v[36:39], v[180:183]
    v_mfma_f32_16x16x32_bf16 v[180:183], v[88:91], v[40:43], v[180:183]
    v_mfma_f32_16x16x32_bf16 v[184:187], v[96:99], v[40:43], v[184:187]
    v_mfma_f32_16x16x32_bf16 v[184:187], v[92:95], v[36:39], v[184:187]
    s_waitcnt lgkmcnt(0)
    s_barrier
    ds_read_b128 v[52:55], v6 offset:0
    ds_read_b128 v[56:59], v7 offset:0
    v_mfma_f32_16x16x32_bf16 v[196:199], v[100:103], v[36:39], v[196:199]
    ds_read_b128 v[60:63], v6 offset:2048
    ds_read_b128 v[64:67], v7 offset:2048
    v_mfma_f32_16x16x32_bf16 v[196:199], v[104:107], v[40:43], v[196:199]
    ds_read_b128 v[68:71], v8 offset:0
    ds_read_b128 v[72:75], v9 offset:0
    v_mfma_f32_16x16x32_bf16 v[200:203], v[112:115], v[40:43], v[200:203]
    ds_read_b128 v[76:79], v8 offset:2048
    ds_read_b128 v[80:83], v9 offset:2048
    v_mfma_f32_16x16x32_bf16 v[200:203], v[108:111], v[36:39], v[200:203]
    ds_read_b64_tr_b16 v[28:29], v2 offset:0
    ds_read_b64_tr_b16 v[30:31], v2 offset:1024
    s_waitcnt lgkmcnt(10)
    v_mfma_f32_16x16x32_bf16 v[188:191], v[84:87], v[44:47], v[188:191]
    ds_read_b64_tr_b16 v[32:33], v2 offset:8192
    ds_read_b64_tr_b16 v[34:35], v2 offset:9216
    v_mfma_f32_16x16x32_bf16 v[188:191], v[88:91], v[48:51], v[188:191]
    v_add_u32 v6, 49152, v6
    v_add_u32 v7, 49152, v7
    v_mfma_f32_16x16x32_bf16 v[192:195], v[96:99], v[48:51], v[192:195]
    v_add_u32 v8, 49152, v8
    v_add_u32 v9, 49152, v9
    v_mfma_f32_16x16x32_bf16 v[192:195], v[92:95], v[44:47], v[192:195]
    ds_read_b64_tr_b16 v[36:37], v2 offset:16384
    v_mfma_f32_16x16x32_bf16 v[204:207], v[100:103], v[44:47], v[204:207]
    ds_read_b64_tr_b16 v[38:39], v2 offset:17408
    v_mfma_f32_16x16x32_bf16 v[204:207], v[104:107], v[48:51], v[204:207]
    ds_read_b64_tr_b16 v[40:41], v2 offset:24576
    v_mfma_f32_16x16x32_bf16 v[208:211], v[112:115], v[48:51], v[208:211]
    s_waitcnt lgkmcnt(10)
    ds_read_b64_tr_b16 v[42:43], v2 offset:25600
    v_mfma_f32_16x16x32_bf16 v[208:211], v[108:111], v[44:47], v[208:211]
    v_add_u32 v2, 49152, v2
    s_waitcnt lgkmcnt(4)
    v_mfma_f32_16x16x32_bf16 v[116:119], v[52:55], v[28:31], v[116:119]
    ds_read_b64_tr_b16 v[44:45], v3 offset:0
    v_mfma_f32_16x16x32_bf16 v[116:119], v[56:59], v[32:35], v[116:119]
    ds_read_b64_tr_b16 v[46:47], v3 offset:1024
    v_mfma_f32_16x16x32_bf16 v[120:123], v[64:67], v[32:35], v[120:123]
    ds_read_b64_tr_b16 v[48:49], v3 offset:8192
    v_mfma_f32_16x16x32_bf16 v[120:123], v[60:63], v[28:31], v[120:123]
    ds_read_b64_tr_b16 v[50:51], v3 offset:9216
    v_mfma_f32_16x16x32_bf16 v[132:135], v[68:71], v[28:31], v[132:135]
    v_mfma_f32_16x16x32_bf16 v[132:135], v[72:75], v[32:35], v[132:135]
    v_mfma_f32_16x16x32_bf16 v[136:139], v[80:83], v[32:35], v[136:139]
    v_mfma_f32_16x16x32_bf16 v[136:139], v[76:79], v[28:31], v[136:139]
    s_waitcnt lgkmcnt(4)
    v_mfma_f32_16x16x32_bf16 v[124:127], v[52:55], v[36:39], v[124:127]
    ds_read_b64_tr_b16 v[28:29], v3 offset:16384
    v_mfma_f32_16x16x32_bf16 v[124:127], v[56:59], v[40:43], v[124:127]
    ds_read_b64_tr_b16 v[30:31], v3 offset:17408
    v_mfma_f32_16x16x32_bf16 v[128:131], v[64:67], v[40:43], v[128:131]
    ds_read_b64_tr_b16 v[32:33], v3 offset:24576
    v_mfma_f32_16x16x32_bf16 v[128:131], v[60:63], v[36:39], v[128:131]
    ds_read_b64_tr_b16 v[34:35], v3 offset:25600
    v_mfma_f32_16x16x32_bf16 v[140:143], v[68:71], v[36:39], v[140:143]
    v_add_u32 v3, 49152, v3
    v_mfma_f32_16x16x32_bf16 v[140:143], v[72:75], v[40:43], v[140:143]
    v_mfma_f32_16x16x32_bf16 v[144:147], v[80:83], v[40:43], v[144:147]
    v_mfma_f32_16x16x32_bf16 v[144:147], v[76:79], v[36:39], v[144:147]
    s_waitcnt lgkmcnt(4)
    v_mfma_f32_16x16x32_bf16 v[148:151], v[52:55], v[44:47], v[148:151]
    ds_read_b64_tr_b16 v[36:37], v4 offset:0
    v_mfma_f32_16x16x32_bf16 v[148:151], v[56:59], v[48:51], v[148:151]
    ds_read_b64_tr_b16 v[38:39], v4 offset:1024
    v_mfma_f32_16x16x32_bf16 v[152:155], v[64:67], v[48:51], v[152:155]
    ds_read_b64_tr_b16 v[40:41], v4 offset:8192
    v_mfma_f32_16x16x32_bf16 v[152:155], v[60:63], v[44:47], v[152:155]
    ds_read_b64_tr_b16 v[42:43], v4 offset:9216
    v_mfma_f32_16x16x32_bf16 v[164:167], v[68:71], v[44:47], v[164:167]
    v_mfma_f32_16x16x32_bf16 v[164:167], v[72:75], v[48:51], v[164:167]
    v_mfma_f32_16x16x32_bf16 v[168:171], v[80:83], v[48:51], v[168:171]
    v_mfma_f32_16x16x32_bf16 v[168:171], v[76:79], v[44:47], v[168:171]
    s_waitcnt lgkmcnt(4)
    v_mfma_f32_16x16x32_bf16 v[156:159], v[52:55], v[28:31], v[156:159]
    ds_read_b64_tr_b16 v[44:45], v4 offset:16384
    v_mfma_f32_16x16x32_bf16 v[156:159], v[56:59], v[32:35], v[156:159]
    ds_read_b64_tr_b16 v[46:47], v4 offset:17408
    v_mfma_f32_16x16x32_bf16 v[160:163], v[64:67], v[32:35], v[160:163]
    ds_read_b64_tr_b16 v[48:49], v4 offset:24576
    v_mfma_f32_16x16x32_bf16 v[160:163], v[60:63], v[28:31], v[160:163]
    ds_read_b64_tr_b16 v[50:51], v4 offset:25600
    v_mfma_f32_16x16x32_bf16 v[172:175], v[68:71], v[28:31], v[172:175]
    v_add_u32 v4, 49152, v4
    v_mfma_f32_16x16x32_bf16 v[172:175], v[72:75], v[32:35], v[172:175]
    v_mfma_f32_16x16x32_bf16 v[176:179], v[80:83], v[32:35], v[176:179]
    v_mfma_f32_16x16x32_bf16 v[176:179], v[76:79], v[28:31], v[176:179]
    s_waitcnt lgkmcnt(4)
    v_mfma_f32_16x16x32_bf16 v[180:183], v[52:55], v[36:39], v[180:183]
    v_mfma_f32_16x16x32_bf16 v[180:183], v[56:59], v[40:43], v[180:183]
    v_mfma_f32_16x16x32_bf16 v[184:187], v[64:67], v[40:43], v[184:187]
    v_mfma_f32_16x16x32_bf16 v[184:187], v[60:63], v[36:39], v[184:187]
    s_waitcnt lgkmcnt(0)
    s_barrier
    ds_read_b128 v[84:87], v6 offset:0
    ds_read_b128 v[88:91], v7 offset:0
    v_mfma_f32_16x16x32_bf16 v[196:199], v[68:71], v[36:39], v[196:199]
    ds_read_b128 v[92:95], v6 offset:2048
    ds_read_b128 v[96:99], v7 offset:2048
    v_mfma_f32_16x16x32_bf16 v[196:199], v[72:75], v[40:43], v[196:199]
    ds_read_b128 v[100:103], v8 offset:0
    ds_read_b128 v[104:107], v9 offset:0
    v_mfma_f32_16x16x32_bf16 v[200:203], v[80:83], v[40:43], v[200:203]
    ds_read_b128 v[108:111], v8 offset:2048
    ds_read_b128 v[112:115], v9 offset:2048
    v_mfma_f32_16x16x32_bf16 v[200:203], v[76:79], v[36:39], v[200:203]
    ds_read_b64_tr_b16 v[28:29], v2 offset:0
    ds_read_b64_tr_b16 v[30:31], v2 offset:1024
    s_waitcnt lgkmcnt(10)
    v_mfma_f32_16x16x32_bf16 v[188:191], v[52:55], v[44:47], v[188:191]
    ds_read_b64_tr_b16 v[32:33], v2 offset:8192
    ds_read_b64_tr_b16 v[34:35], v2 offset:9216
    v_mfma_f32_16x16x32_bf16 v[188:191], v[56:59], v[48:51], v[188:191]
    v_subrev_u32 v6, 98304, v6
    v_subrev_u32 v7, 98304, v7
    v_mfma_f32_16x16x32_bf16 v[192:195], v[64:67], v[48:51], v[192:195]
    v_subrev_u32 v8, 98304, v8
    v_subrev_u32 v9, 98304, v9
    v_mfma_f32_16x16x32_bf16 v[192:195], v[60:63], v[44:47], v[192:195]
    ds_read_b64_tr_b16 v[36:37], v2 offset:16384
    v_mfma_f32_16x16x32_bf16 v[204:207], v[68:71], v[44:47], v[204:207]
    ds_read_b64_tr_b16 v[38:39], v2 offset:17408
    v_mfma_f32_16x16x32_bf16 v[204:207], v[72:75], v[48:51], v[204:207]
    ds_read_b64_tr_b16 v[40:41], v2 offset:24576
    v_mfma_f32_16x16x32_bf16 v[208:211], v[80:83], v[48:51], v[208:211]
    s_waitcnt lgkmcnt(10)
    ds_read_b64_tr_b16 v[42:43], v2 offset:25600
    v_mfma_f32_16x16x32_bf16 v[208:211], v[76:79], v[44:47], v[208:211]
    v_subrev_u32 v2, 98304, v2
    s_waitcnt lgkmcnt(4)
    v_mfma_f32_16x16x32_bf16 v[116:119], v[84:87], v[28:31], v[116:119]
    ds_read_b64_tr_b16 v[44:45], v3 offset:0
    v_mfma_f32_16x16x32_bf16 v[116:119], v[88:91], v[32:35], v[116:119]
    ds_read_b64_tr_b16 v[46:47], v3 offset:1024
    v_mfma_f32_16x16x32_bf16 v[120:123], v[96:99], v[32:35], v[120:123]
    ds_read_b64_tr_b16 v[48:49], v3 offset:8192
    v_mfma_f32_16x16x32_bf16 v[120:123], v[92:95], v[28:31], v[120:123]
    ds_read_b64_tr_b16 v[50:51], v3 offset:9216
    v_mfma_f32_16x16x32_bf16 v[132:135], v[100:103], v[28:31], v[132:135]
    v_mfma_f32_16x16x32_bf16 v[132:135], v[104:107], v[32:35], v[132:135]
    v_mfma_f32_16x16x32_bf16 v[136:139], v[112:115], v[32:35], v[136:139]
    v_mfma_f32_16x16x32_bf16 v[136:139], v[108:111], v[28:31], v[136:139]
    s_waitcnt lgkmcnt(4)
    v_mfma_f32_16x16x32_bf16 v[124:127], v[84:87], v[36:39], v[124:127]
    ds_read_b64_tr_b16 v[28:29], v3 offset:16384
    v_mfma_f32_16x16x32_bf16 v[124:127], v[88:91], v[40:43], v[124:127]
    ds_read_b64_tr_b16 v[30:31], v3 offset:17408
    v_mfma_f32_16x16x32_bf16 v[128:131], v[96:99], v[40:43], v[128:131]
    ds_read_b64_tr_b16 v[32:33], v3 offset:24576
    v_mfma_f32_16x16x32_bf16 v[128:131], v[92:95], v[36:39], v[128:131]
    ds_read_b64_tr_b16 v[34:35], v3 offset:25600
    v_mfma_f32_16x16x32_bf16 v[140:143], v[100:103], v[36:39], v[140:143]
    v_subrev_u32 v3, 98304, v3
    v_mfma_f32_16x16x32_bf16 v[140:143], v[104:107], v[40:43], v[140:143]
    v_mfma_f32_16x16x32_bf16 v[144:147], v[112:115], v[40:43], v[144:147]
    v_mfma_f32_16x16x32_bf16 v[144:147], v[108:111], v[36:39], v[144:147]
    s_waitcnt lgkmcnt(4)
    v_mfma_f32_16x16x32_bf16 v[148:151], v[84:87], v[44:47], v[148:151]
    ds_read_b64_tr_b16 v[36:37], v4 offset:0
    v_mfma_f32_16x16x32_bf16 v[148:151], v[88:91], v[48:51], v[148:151]
    ds_read_b64_tr_b16 v[38:39], v4 offset:1024
    v_mfma_f32_16x16x32_bf16 v[152:155], v[96:99], v[48:51], v[152:155]
    ds_read_b64_tr_b16 v[40:41], v4 offset:8192
    v_mfma_f32_16x16x32_bf16 v[152:155], v[92:95], v[44:47], v[152:155]
    ds_read_b64_tr_b16 v[42:43], v4 offset:9216
    v_mfma_f32_16x16x32_bf16 v[164:167], v[100:103], v[44:47], v[164:167]
    v_mfma_f32_16x16x32_bf16 v[164:167], v[104:107], v[48:51], v[164:167]
    v_mfma_f32_16x16x32_bf16 v[168:171], v[112:115], v[48:51], v[168:171]
    v_mfma_f32_16x16x32_bf16 v[168:171], v[108:111], v[44:47], v[168:171]
    s_waitcnt lgkmcnt(4)
    v_mfma_f32_16x16x32_bf16 v[156:159], v[84:87], v[28:31], v[156:159]
    ds_read_b64_tr_b16 v[44:45], v4 offset:16384
    v_mfma_f32_16x16x32_bf16 v[156:159], v[88:91], v[32:35], v[156:159]
    ds_read_b64_tr_b16 v[46:47], v4 offset:17408
    v_mfma_f32_16x16x32_bf16 v[160:163], v[96:99], v[32:35], v[160:163]
    ds_read_b64_tr_b16 v[48:49], v4 offset:24576
    v_mfma_f32_16x16x32_bf16 v[160:163], v[92:95], v[28:31], v[160:163]
    ds_read_b64_tr_b16 v[50:51], v4 offset:25600
    v_mfma_f32_16x16x32_bf16 v[172:175], v[100:103], v[28:31], v[172:175]
    v_subrev_u32 v4, 98304, v4
    v_mfma_f32_16x16x32_bf16 v[172:175], v[104:107], v[32:35], v[172:175]
    v_mfma_f32_16x16x32_bf16 v[176:179], v[112:115], v[32:35], v[176:179]
    v_mfma_f32_16x16x32_bf16 v[176:179], v[108:111], v[28:31], v[176:179]
    s_waitcnt lgkmcnt(4)
    v_mfma_f32_16x16x32_bf16 v[180:183], v[84:87], v[36:39], v[180:183]
    v_mfma_f32_16x16x32_bf16 v[180:183], v[88:91], v[40:43], v[180:183]
    v_mfma_f32_16x16x32_bf16 v[184:187], v[96:99], v[40:43], v[184:187]
    v_mfma_f32_16x16x32_bf16 v[184:187], v[92:95], v[36:39], v[184:187]
    s_waitcnt lgkmcnt(0)
    s_barrier
    ds_read_b128 v[52:55], v6 offset:0
    ds_read_b128 v[56:59], v7 offset:0
    v_mfma_f32_16x16x32_bf16 v[196:199], v[100:103], v[36:39], v[196:199]
    ds_read_b128 v[60:63], v6 offset:2048
    ds_read_b128 v[64:67], v7 offset:2048
    v_mfma_f32_16x16x32_bf16 v[196:199], v[104:107], v[40:43], v[196:199]
    ds_read_b128 v[68:71], v8 offset:0
    ds_read_b128 v[72:75], v9 offset:0
    v_mfma_f32_16x16x32_bf16 v[200:203], v[112:115], v[40:43], v[200:203]
    ds_read_b128 v[76:79], v8 offset:2048
    ds_read_b128 v[80:83], v9 offset:2048
    v_mfma_f32_16x16x32_bf16 v[200:203], v[108:111], v[36:39], v[200:203]
    ds_read_b64_tr_b16 v[28:29], v2 offset:0
    ds_read_b64_tr_b16 v[30:31], v2 offset:1024
    s_waitcnt lgkmcnt(10)
    v_mfma_f32_16x16x32_bf16 v[188:191], v[84:87], v[44:47], v[188:191]
    ds_read_b64_tr_b16 v[32:33], v2 offset:8192
    ds_read_b64_tr_b16 v[34:35], v2 offset:9216
    v_mfma_f32_16x16x32_bf16 v[188:191], v[88:91], v[48:51], v[188:191]
    v_add_u32 v6, 49152, v6
    v_add_u32 v7, 49152, v7
    v_mfma_f32_16x16x32_bf16 v[192:195], v[96:99], v[48:51], v[192:195]
    v_add_u32 v8, 49152, v8
    v_add_u32 v9, 49152, v9
    v_mfma_f32_16x16x32_bf16 v[192:195], v[92:95], v[44:47], v[192:195]
    ds_read_b64_tr_b16 v[36:37], v2 offset:16384
    v_mfma_f32_16x16x32_bf16 v[204:207], v[100:103], v[44:47], v[204:207]
    ds_read_b64_tr_b16 v[38:39], v2 offset:17408
    v_mfma_f32_16x16x32_bf16 v[204:207], v[104:107], v[48:51], v[204:207]
    ds_read_b64_tr_b16 v[40:41], v2 offset:24576
    v_mfma_f32_16x16x32_bf16 v[208:211], v[112:115], v[48:51], v[208:211]
    s_waitcnt lgkmcnt(10)
    ds_read_b64_tr_b16 v[42:43], v2 offset:25600
    v_mfma_f32_16x16x32_bf16 v[208:211], v[108:111], v[44:47], v[208:211]
    v_add_u32 v2, 49152, v2
    s_waitcnt lgkmcnt(4)
    v_mfma_f32_16x16x32_bf16 v[116:119], v[52:55], v[28:31], v[116:119]
    ds_read_b64_tr_b16 v[44:45], v3 offset:0
    v_mfma_f32_16x16x32_bf16 v[116:119], v[56:59], v[32:35], v[116:119]
    ds_read_b64_tr_b16 v[46:47], v3 offset:1024
    v_mfma_f32_16x16x32_bf16 v[120:123], v[64:67], v[32:35], v[120:123]
    ds_read_b64_tr_b16 v[48:49], v3 offset:8192
    v_mfma_f32_16x16x32_bf16 v[120:123], v[60:63], v[28:31], v[120:123]
    ds_read_b64_tr_b16 v[50:51], v3 offset:9216
    v_mfma_f32_16x16x32_bf16 v[132:135], v[68:71], v[28:31], v[132:135]
    v_mfma_f32_16x16x32_bf16 v[132:135], v[72:75], v[32:35], v[132:135]
    v_mfma_f32_16x16x32_bf16 v[136:139], v[80:83], v[32:35], v[136:139]
    v_mfma_f32_16x16x32_bf16 v[136:139], v[76:79], v[28:31], v[136:139]
    s_waitcnt lgkmcnt(4)
    v_mfma_f32_16x16x32_bf16 v[124:127], v[52:55], v[36:39], v[124:127]
    ds_read_b64_tr_b16 v[28:29], v3 offset:16384
    v_mfma_f32_16x16x32_bf16 v[124:127], v[56:59], v[40:43], v[124:127]
    ds_read_b64_tr_b16 v[30:31], v3 offset:17408
    v_mfma_f32_16x16x32_bf16 v[128:131], v[64:67], v[40:43], v[128:131]
    ds_read_b64_tr_b16 v[32:33], v3 offset:24576
    v_mfma_f32_16x16x32_bf16 v[128:131], v[60:63], v[36:39], v[128:131]
    ds_read_b64_tr_b16 v[34:35], v3 offset:25600
    v_mfma_f32_16x16x32_bf16 v[140:143], v[68:71], v[36:39], v[140:143]
    v_add_u32 v3, 49152, v3
    v_mfma_f32_16x16x32_bf16 v[140:143], v[72:75], v[40:43], v[140:143]
    v_mfma_f32_16x16x32_bf16 v[144:147], v[80:83], v[40:43], v[144:147]
    v_mfma_f32_16x16x32_bf16 v[144:147], v[76:79], v[36:39], v[144:147]
    s_waitcnt lgkmcnt(4)
    v_mfma_f32_16x16x32_bf16 v[148:151], v[52:55], v[44:47], v[148:151]
    ds_read_b64_tr_b16 v[36:37], v4 offset:0
    v_mfma_f32_16x16x32_bf16 v[148:151], v[56:59], v[48:51], v[148:151]
    ds_read_b64_tr_b16 v[38:39], v4 offset:1024
    v_mfma_f32_16x16x32_bf16 v[152:155], v[64:67], v[48:51], v[152:155]
    ds_read_b64_tr_b16 v[40:41], v4 offset:8192
    v_mfma_f32_16x16x32_bf16 v[152:155], v[60:63], v[44:47], v[152:155]
    ds_read_b64_tr_b16 v[42:43], v4 offset:9216
    v_mfma_f32_16x16x32_bf16 v[164:167], v[68:71], v[44:47], v[164:167]
    v_mfma_f32_16x16x32_bf16 v[164:167], v[72:75], v[48:51], v[164:167]
    v_mfma_f32_16x16x32_bf16 v[168:171], v[80:83], v[48:51], v[168:171]
    v_mfma_f32_16x16x32_bf16 v[168:171], v[76:79], v[44:47], v[168:171]
    s_waitcnt lgkmcnt(4)
    v_mfma_f32_16x16x32_bf16 v[156:159], v[52:55], v[28:31], v[156:159]
    ds_read_b64_tr_b16 v[44:45], v4 offset:16384
    v_mfma_f32_16x16x32_bf16 v[156:159], v[56:59], v[32:35], v[156:159]
    ds_read_b64_tr_b16 v[46:47], v4 offset:17408
    v_mfma_f32_16x16x32_bf16 v[160:163], v[64:67], v[32:35], v[160:163]
    ds_read_b64_tr_b16 v[48:49], v4 offset:24576
    v_mfma_f32_16x16x32_bf16 v[160:163], v[60:63], v[28:31], v[160:163]
    ds_read_b64_tr_b16 v[50:51], v4 offset:25600
    v_mfma_f32_16x16x32_bf16 v[172:175], v[68:71], v[28:31], v[172:175]
    v_add_u32 v4, 49152, v4
    v_mfma_f32_16x16x32_bf16 v[172:175], v[72:75], v[32:35], v[172:175]
    v_mfma_f32_16x16x32_bf16 v[176:179], v[80:83], v[32:35], v[176:179]
    v_mfma_f32_16x16x32_bf16 v[176:179], v[76:79], v[28:31], v[176:179]
    s_waitcnt lgkmcnt(4)
    v_mfma_f32_16x16x32_bf16 v[180:183], v[52:55], v[36:39], v[180:183]
    v_mfma_f32_16x16x32_bf16 v[180:183], v[56:59], v[40:43], v[180:183]
    v_mfma_f32_16x16x32_bf16 v[184:187], v[64:67], v[40:43], v[184:187]
    v_mfma_f32_16x16x32_bf16 v[184:187], v[60:63], v[36:39], v[184:187]
    s_waitcnt lgkmcnt(0)
    s_barrier
    ds_read_b128 v[84:87], v6 offset:0
    ds_read_b128 v[88:91], v7 offset:0
    v_mfma_f32_16x16x32_bf16 v[196:199], v[68:71], v[36:39], v[196:199]
    ds_read_b128 v[92:95], v6 offset:2048
    ds_read_b128 v[96:99], v7 offset:2048
    v_mfma_f32_16x16x32_bf16 v[196:199], v[72:75], v[40:43], v[196:199]
    ds_read_b128 v[100:103], v8 offset:0
    ds_read_b128 v[104:107], v9 offset:0
    v_mfma_f32_16x16x32_bf16 v[200:203], v[80:83], v[40:43], v[200:203]
    ds_read_b128 v[108:111], v8 offset:2048
    ds_read_b128 v[112:115], v9 offset:2048
    v_mfma_f32_16x16x32_bf16 v[200:203], v[76:79], v[36:39], v[200:203]
    ds_read_b64_tr_b16 v[28:29], v2 offset:0
    ds_read_b64_tr_b16 v[30:31], v2 offset:1024
    s_waitcnt lgkmcnt(10)
    v_mfma_f32_16x16x32_bf16 v[188:191], v[52:55], v[44:47], v[188:191]
    ds_read_b64_tr_b16 v[32:33], v2 offset:8192
    v_mfma_f32_16x16x32_bf16 v[188:191], v[56:59], v[48:51], v[188:191]
    ds_read_b64_tr_b16 v[34:35], v2 offset:9216
    v_mfma_f32_16x16x32_bf16 v[192:195], v[64:67], v[48:51], v[192:195]
    ds_read_b64_tr_b16 v[36:37], v2 offset:16384
    v_mfma_f32_16x16x32_bf16 v[192:195], v[60:63], v[44:47], v[192:195]
    ds_read_b64_tr_b16 v[38:39], v2 offset:17408
    v_mfma_f32_16x16x32_bf16 v[204:207], v[68:71], v[44:47], v[204:207]
    ds_read_b64_tr_b16 v[40:41], v2 offset:24576
    v_mfma_f32_16x16x32_bf16 v[204:207], v[72:75], v[48:51], v[204:207]
    s_waitcnt lgkmcnt(10)
    ds_read_b64_tr_b16 v[42:43], v2 offset:25600
    v_mfma_f32_16x16x32_bf16 v[208:211], v[80:83], v[48:51], v[208:211]
    v_mfma_f32_16x16x32_bf16 v[208:211], v[76:79], v[44:47], v[208:211]
    s_waitcnt lgkmcnt(4)
    v_mfma_f32_16x16x32_bf16 v[116:119], v[84:87], v[28:31], v[116:119]
    ds_read_b64_tr_b16 v[44:45], v3 offset:0
    v_mfma_f32_16x16x32_bf16 v[116:119], v[88:91], v[32:35], v[116:119]
    ds_read_b64_tr_b16 v[46:47], v3 offset:1024
    v_mfma_f32_16x16x32_bf16 v[120:123], v[96:99], v[32:35], v[120:123]
    ds_read_b64_tr_b16 v[48:49], v3 offset:8192
    v_mfma_f32_16x16x32_bf16 v[120:123], v[92:95], v[28:31], v[120:123]
    ds_read_b64_tr_b16 v[50:51], v3 offset:9216
    v_mfma_f32_16x16x32_bf16 v[132:135], v[100:103], v[28:31], v[132:135]
    v_mfma_f32_16x16x32_bf16 v[132:135], v[104:107], v[32:35], v[132:135]
    v_mfma_f32_16x16x32_bf16 v[136:139], v[112:115], v[32:35], v[136:139]
    v_mfma_f32_16x16x32_bf16 v[136:139], v[108:111], v[28:31], v[136:139]
    s_waitcnt lgkmcnt(4)
    v_mfma_f32_16x16x32_bf16 v[124:127], v[84:87], v[36:39], v[124:127]
    ds_read_b64_tr_b16 v[28:29], v3 offset:16384
    v_mfma_f32_16x16x32_bf16 v[124:127], v[88:91], v[40:43], v[124:127]
    ds_read_b64_tr_b16 v[30:31], v3 offset:17408
    v_mfma_f32_16x16x32_bf16 v[128:131], v[96:99], v[40:43], v[128:131]
    ds_read_b64_tr_b16 v[32:33], v3 offset:24576
    v_mfma_f32_16x16x32_bf16 v[128:131], v[92:95], v[36:39], v[128:131]
    ds_read_b64_tr_b16 v[34:35], v3 offset:25600
    v_mfma_f32_16x16x32_bf16 v[140:143], v[100:103], v[36:39], v[140:143]
    v_mfma_f32_16x16x32_bf16 v[140:143], v[104:107], v[40:43], v[140:143]
    v_mfma_f32_16x16x32_bf16 v[144:147], v[112:115], v[40:43], v[144:147]
    v_mfma_f32_16x16x32_bf16 v[144:147], v[108:111], v[36:39], v[144:147]
    s_waitcnt lgkmcnt(4)
    v_mfma_f32_16x16x32_bf16 v[148:151], v[84:87], v[44:47], v[148:151]
    ds_read_b64_tr_b16 v[36:37], v4 offset:0
    v_mfma_f32_16x16x32_bf16 v[148:151], v[88:91], v[48:51], v[148:151]
    ds_read_b64_tr_b16 v[38:39], v4 offset:1024
    v_mfma_f32_16x16x32_bf16 v[152:155], v[96:99], v[48:51], v[152:155]
    ds_read_b64_tr_b16 v[40:41], v4 offset:8192
    v_mfma_f32_16x16x32_bf16 v[152:155], v[92:95], v[44:47], v[152:155]
    ds_read_b64_tr_b16 v[42:43], v4 offset:9216
    v_mfma_f32_16x16x32_bf16 v[164:167], v[100:103], v[44:47], v[164:167]
    v_mfma_f32_16x16x32_bf16 v[164:167], v[104:107], v[48:51], v[164:167]
    v_mfma_f32_16x16x32_bf16 v[168:171], v[112:115], v[48:51], v[168:171]
    v_mfma_f32_16x16x32_bf16 v[168:171], v[108:111], v[44:47], v[168:171]
    s_waitcnt lgkmcnt(4)
    v_mfma_f32_16x16x32_bf16 v[156:159], v[84:87], v[28:31], v[156:159]
    ds_read_b64_tr_b16 v[44:45], v4 offset:16384
    v_mfma_f32_16x16x32_bf16 v[156:159], v[88:91], v[32:35], v[156:159]
    ds_read_b64_tr_b16 v[46:47], v4 offset:17408
    v_mfma_f32_16x16x32_bf16 v[160:163], v[96:99], v[32:35], v[160:163]
    ds_read_b64_tr_b16 v[48:49], v4 offset:24576
    v_mfma_f32_16x16x32_bf16 v[160:163], v[92:95], v[28:31], v[160:163]
    ds_read_b64_tr_b16 v[50:51], v4 offset:25600
    v_mfma_f32_16x16x32_bf16 v[172:175], v[100:103], v[28:31], v[172:175]
    v_mfma_f32_16x16x32_bf16 v[172:175], v[104:107], v[32:35], v[172:175]
    v_mfma_f32_16x16x32_bf16 v[176:179], v[112:115], v[32:35], v[176:179]
    v_mfma_f32_16x16x32_bf16 v[176:179], v[108:111], v[28:31], v[176:179]
    s_waitcnt lgkmcnt(4)
    v_mfma_f32_16x16x32_bf16 v[180:183], v[84:87], v[36:39], v[180:183]
    v_mfma_f32_16x16x32_bf16 v[180:183], v[88:91], v[40:43], v[180:183]
    v_mfma_f32_16x16x32_bf16 v[184:187], v[96:99], v[40:43], v[184:187]
    v_mfma_f32_16x16x32_bf16 v[184:187], v[92:95], v[36:39], v[184:187]
    s_waitcnt lgkmcnt(0)
    s_barrier
    v_mfma_f32_16x16x32_bf16 v[196:199], v[100:103], v[36:39], v[196:199]
    v_mfma_f32_16x16x32_bf16 v[196:199], v[104:107], v[40:43], v[196:199]
    v_mfma_f32_16x16x32_bf16 v[200:203], v[112:115], v[40:43], v[200:203]
    v_mfma_f32_16x16x32_bf16 v[200:203], v[108:111], v[36:39], v[200:203]
    s_waitcnt lgkmcnt(0)
    v_mfma_f32_16x16x32_bf16 v[188:191], v[84:87], v[44:47], v[188:191]
    v_mfma_f32_16x16x32_bf16 v[188:191], v[88:91], v[48:51], v[188:191]
    v_mfma_f32_16x16x32_bf16 v[192:195], v[96:99], v[48:51], v[192:195]
    v_mfma_f32_16x16x32_bf16 v[192:195], v[92:95], v[44:47], v[192:195]
    v_mfma_f32_16x16x32_bf16 v[204:207], v[100:103], v[44:47], v[204:207]
    v_mfma_f32_16x16x32_bf16 v[204:207], v[104:107], v[48:51], v[204:207]
    v_mfma_f32_16x16x32_bf16 v[208:211], v[112:115], v[48:51], v[208:211]
    v_mfma_f32_16x16x32_bf16 v[208:211], v[108:111], v[44:47], v[208:211]
    s_nop 7
    v_lshlrev_b32 v21, 4, v1
    s_lshl_b32 s43, s45, 10
    s_add_u32 s43, s43, 49152
    v_add_u32 v20, s43, v21
    s_lshl_b32 s43, s41, 13
    v_add_u32 v2, s43, v20
    v_xor_b32 v3, 0x800, v2
    s_lshl_b32 s43, s45, 12
    s_add_u32 s43, s43, 49152
    v_add_u32 v21, s43, v21
    v_cvt_pk_bf16_f32 v100, v116, v117
    v_cvt_pk_bf16_f32 v101, v118, v119
    v_cvt_pk_bf16_f32 v102, v120, v121
    v_cvt_pk_bf16_f32 v103, v122, v123
    v_cvt_pk_bf16_f32 v104, v124, v125
    v_cvt_pk_bf16_f32 v105, v126, v127
    v_cvt_pk_bf16_f32 v106, v128, v129
    v_cvt_pk_bf16_f32 v107, v130, v131
    v_cvt_pk_bf16_f32 v108, -v124, -v125
    v_cvt_pk_bf16_f32 v109, -v126, -v127
    v_cvt_pk_bf16_f32 v110, -v128, -v129
    v_cvt_pk_bf16_f32 v111, -v130, -v131
    v_mfma_f32_16x16x32_bf16 v[116:119], v[212:215], v[100:103], 0
    v_cvt_pk_bf16_f32 v88, v132, v133
    v_cvt_pk_bf16_f32 v89, v134, v135
    v_mfma_f32_16x16x32_bf16 v[116:119], v[220:223], v[104:107], v[116:119]
    v_cvt_pk_bf16_f32 v90, v136, v137
    v_cvt_pk_bf16_f32 v91, v138, v139
    v_mfma_f32_16x16x32_bf16 v[120:123], v[216:219], v[100:103], 0
    v_cvt_pk_bf16_f32 v92, v140, v141
    v_cvt_pk_bf16_f32 v93, v142, v143
    v_mfma_f32_16x16x32_bf16 v[120:123], v[224:227], v[104:107], v[120:123]
    v_cvt_pk_bf16_f32 v94, v144, v145
    v_cvt_pk_bf16_f32 v95, v146, v147
    v_mfma_f32_16x16x32_bf16 v[124:127], v[220:223], v[100:103], 0
    v_cvt_pk_bf16_f32 v96, -v140, -v141
    v_mfma_f32_16x16x32_bf16 v[124:127], v[212:215], v[108:111], v[124:127]
    v_cvt_pk_bf16_f32 v97, -v142, -v143
    v_mfma_f32_16x16x32_bf16 v[128:131], v[224:227], v[100:103], 0
    v_cvt_pk_bf16_f32 v98, -v144, -v145
    v_mfma_f32_16x16x32_bf16 v[128:131], v[216:219], v[108:111], v[128:131]
    v_cvt_pk_bf16_f32 v99, -v146, -v147
    v_mfma_f32_16x16x32_bf16 v[132:135], v[212:215], v[88:91], 0
    v_cvt_pk_bf16_f32 v100, v148, v149
    v_cvt_pk_bf16_f32 v101, v150, v151
    v_cvt_pk_bf16_f32 v102, v152, v153
    v_mfma_f32_16x16x32_bf16 v[132:135], v[220:223], v[92:95], v[132:135]
    v_cvt_pk_bf16_f32 v103, v154, v155
    v_cvt_pk_bf16_f32 v104, v156, v157
    v_cvt_pk_bf16_f32 v105, v158, v159
    v_mfma_f32_16x16x32_bf16 v[136:139], v[216:219], v[88:91], 0
    v_cvt_pk_bf16_f32 v106, v160, v161
    v_cvt_pk_bf16_f32 v107, v162, v163
    v_cvt_pk_bf16_f32 v108, -v156, -v157
    v_mfma_f32_16x16x32_bf16 v[136:139], v[224:227], v[92:95], v[136:139]
    v_cvt_pk_bf16_f32 v109, -v158, -v159
    v_cvt_pk_bf16_f32 v110, -v160, -v161
    v_cvt_pk_bf16_f32 v111, -v162, -v163
    v_mfma_f32_16x16x32_bf16 v[140:143], v[220:223], v[88:91], 0
    v_cvt_pk_bf16_f32 v116, v116, v124
    v_cvt_pk_bf16_f32 v117, v117, v125
    v_cvt_pk_bf16_f32 v118, v118, v126
    v_mfma_f32_16x16x32_bf16 v[140:143], v[212:215], v[96:99], v[140:143]
    v_cvt_pk_bf16_f32 v119, v119, v127
    v_cvt_pk_bf16_f32 v120, v120, v128
    v_cvt_pk_bf16_f32 v121, v121, v129
    v_mfma_f32_16x16x32_bf16 v[144:147], v[224:227], v[88:91], 0
    v_cvt_pk_bf16_f32 v122, v122, v130
    v_cvt_pk_bf16_f32 v123, v123, v131
    v_mfma_f32_16x16x32_bf16 v[144:147], v[216:219], v[96:99], v[144:147]
    ds_write_b128 v2, v[116:119] offset:0
    ds_write_b128 v2, v[120:123] offset:4096
    v_mfma_f32_16x16x32_bf16 v[148:151], v[212:215], v[100:103], 0
    v_cvt_pk_bf16_f32 v88, v164, v165
    v_cvt_pk_bf16_f32 v89, v166, v167
    v_cvt_pk_bf16_f32 v90, v168, v169
    v_mfma_f32_16x16x32_bf16 v[148:151], v[220:223], v[104:107], v[148:151]
    v_cvt_pk_bf16_f32 v91, v170, v171
    v_cvt_pk_bf16_f32 v92, v172, v173
    v_cvt_pk_bf16_f32 v93, v174, v175
    v_mfma_f32_16x16x32_bf16 v[152:155], v[216:219], v[100:103], 0
    v_cvt_pk_bf16_f32 v94, v176, v177
    v_cvt_pk_bf16_f32 v95, v178, v179
    v_cvt_pk_bf16_f32 v96, -v172, -v173
    v_mfma_f32_16x16x32_bf16 v[152:155], v[224:227], v[104:107], v[152:155]
    v_cvt_pk_bf16_f32 v97, -v174, -v175
    v_cvt_pk_bf16_f32 v98, -v176, -v177
    v_cvt_pk_bf16_f32 v99, -v178, -v179
    v_mfma_f32_16x16x32_bf16 v[156:159], v[220:223], v[100:103], 0
    v_cvt_pk_bf16_f32 v132, v132, v140
    v_cvt_pk_bf16_f32 v133, v133, v141
    v_cvt_pk_bf16_f32 v134, v134, v142
    v_mfma_f32_16x16x32_bf16 v[156:159], v[212:215], v[108:111], v[156:159]
    v_cvt_pk_bf16_f32 v135, v135, v143
    v_cvt_pk_bf16_f32 v136, v136, v144
    v_cvt_pk_bf16_f32 v137, v137, v145
    v_mfma_f32_16x16x32_bf16 v[160:163], v[224:227], v[100:103], 0
    v_cvt_pk_bf16_f32 v138, v138, v146
    v_cvt_pk_bf16_f32 v139, v139, v147
    v_mfma_f32_16x16x32_bf16 v[160:163], v[216:219], v[108:111], v[160:163]
    ds_write_b128 v3, v[132:135] offset:0
    ds_write_b128 v3, v[136:139] offset:4096
    v_mfma_f32_16x16x32_bf16 v[164:167], v[212:215], v[88:91], 0
    v_cvt_pk_bf16_f32 v100, v180, v181
    v_cvt_pk_bf16_f32 v101, v182, v183
    v_cvt_pk_bf16_f32 v102, v184, v185
    v_mfma_f32_16x16x32_bf16 v[164:167], v[220:223], v[92:95], v[164:167]
    v_cvt_pk_bf16_f32 v103, v186, v187
    v_cvt_pk_bf16_f32 v104, v188, v189
    v_cvt_pk_bf16_f32 v105, v190, v191
    v_mfma_f32_16x16x32_bf16 v[168:171], v[216:219], v[88:91], 0
    v_cvt_pk_bf16_f32 v106, v192, v193
    v_cvt_pk_bf16_f32 v107, v194, v195
    v_cvt_pk_bf16_f32 v108, -v188, -v189
    v_mfma_f32_16x16x32_bf16 v[168:171], v[224:227], v[92:95], v[168:171]
    v_cvt_pk_bf16_f32 v109, -v190, -v191
    v_cvt_pk_bf16_f32 v110, -v192, -v193
    v_cvt_pk_bf16_f32 v111, -v194, -v195
    v_mfma_f32_16x16x32_bf16 v[172:175], v[220:223], v[88:91], 0
    v_cvt_pk_bf16_f32 v148, v148, v156
    v_cvt_pk_bf16_f32 v149, v149, v157
    v_cvt_pk_bf16_f32 v150, v150, v158
    v_mfma_f32_16x16x32_bf16 v[172:175], v[212:215], v[96:99], v[172:175]
    v_cvt_pk_bf16_f32 v151, v151, v159
    v_cvt_pk_bf16_f32 v152, v152, v160
    v_cvt_pk_bf16_f32 v153, v153, v161
    v_mfma_f32_16x16x32_bf16 v[176:179], v[224:227], v[88:91], 0
    v_cvt_pk_bf16_f32 v154, v154, v162
    v_cvt_pk_bf16_f32 v155, v155, v163
    v_mfma_f32_16x16x32_bf16 v[176:179], v[216:219], v[96:99], v[176:179]
    ds_write_b128 v2, v[148:151] offset:8192
    ds_write_b128 v2, v[152:155] offset:12288
    v_mfma_f32_16x16x32_bf16 v[180:183], v[212:215], v[100:103], 0
    v_cvt_pk_bf16_f32 v88, v196, v197
    v_cvt_pk_bf16_f32 v89, v198, v199
    v_cvt_pk_bf16_f32 v90, v200, v201
    v_mfma_f32_16x16x32_bf16 v[180:183], v[220:223], v[104:107], v[180:183]
    v_cvt_pk_bf16_f32 v91, v202, v203
    v_cvt_pk_bf16_f32 v92, v204, v205
    v_cvt_pk_bf16_f32 v93, v206, v207
    v_mfma_f32_16x16x32_bf16 v[184:187], v[216:219], v[100:103], 0
    v_cvt_pk_bf16_f32 v94, v208, v209
    v_cvt_pk_bf16_f32 v95, v210, v211
    v_cvt_pk_bf16_f32 v96, -v204, -v205
    v_mfma_f32_16x16x32_bf16 v[184:187], v[224:227], v[104:107], v[184:187]
    v_cvt_pk_bf16_f32 v97, -v206, -v207
    v_cvt_pk_bf16_f32 v98, -v208, -v209
    v_cvt_pk_bf16_f32 v99, -v210, -v211
    v_mfma_f32_16x16x32_bf16 v[188:191], v[220:223], v[100:103], 0
    v_cvt_pk_bf16_f32 v164, v164, v172
    v_cvt_pk_bf16_f32 v165, v165, v173
    v_cvt_pk_bf16_f32 v166, v166, v174
    v_mfma_f32_16x16x32_bf16 v[188:191], v[212:215], v[108:111], v[188:191]
    v_cvt_pk_bf16_f32 v167, v167, v175
    v_cvt_pk_bf16_f32 v168, v168, v176
    v_cvt_pk_bf16_f32 v169, v169, v177
    v_mfma_f32_16x16x32_bf16 v[192:195], v[224:227], v[100:103], 0
    v_cvt_pk_bf16_f32 v170, v170, v178
    v_cvt_pk_bf16_f32 v171, v171, v179
    v_mfma_f32_16x16x32_bf16 v[192:195], v[216:219], v[108:111], v[192:195]
    ds_write_b128 v3, v[164:167] offset:8192
    ds_write_b128 v3, v[168:171] offset:12288
    v_mfma_f32_16x16x32_bf16 v[196:199], v[212:215], v[88:91], 0
    s_nop 3
    s_nop 3
    v_mfma_f32_16x16x32_bf16 v[196:199], v[220:223], v[92:95], v[196:199]
    s_nop 3
    v_cvt_pk_bf16_f32 v180, v180, v188
    v_mfma_f32_16x16x32_bf16 v[200:203], v[216:219], v[88:91], 0
    v_cvt_pk_bf16_f32 v181, v181, v189
    v_cvt_pk_bf16_f32 v182, v182, v190
    v_mfma_f32_16x16x32_bf16 v[200:203], v[224:227], v[92:95], v[200:203]
    v_cvt_pk_bf16_f32 v183, v183, v191
    v_cvt_pk_bf16_f32 v184, v184, v192
    v_mfma_f32_16x16x32_bf16 v[204:207], v[220:223], v[88:91], 0
    v_cvt_pk_bf16_f32 v185, v185, v193
    v_cvt_pk_bf16_f32 v186, v186, v194
    v_mfma_f32_16x16x32_bf16 v[204:207], v[212:215], v[96:99], v[204:207]
    v_cvt_pk_bf16_f32 v187, v187, v195
    v_mfma_f32_16x16x32_bf16 v[208:211], v[224:227], v[88:91], 0
    ds_write_b128 v2, v[180:183] offset:16384
    v_mfma_f32_16x16x32_bf16 v[208:211], v[216:219], v[96:99], v[208:211]
    ds_write_b128 v2, v[184:187] offset:20480
    s_nop 7
    v_cvt_pk_bf16_f32 v196, v196, v204
    v_cvt_pk_bf16_f32 v197, v197, v205
    v_cvt_pk_bf16_f32 v198, v198, v206
    v_cvt_pk_bf16_f32 v199, v199, v207
    v_cvt_pk_bf16_f32 v200, v200, v208
    v_cvt_pk_bf16_f32 v201, v201, v209
    v_cvt_pk_bf16_f32 v202, v202, v210
    v_cvt_pk_bf16_f32 v203, v203, v211
    ds_write_b128 v3, v[196:199] offset:16384
    ds_write_b128 v3, v[200:203] offset:20480
    s_waitcnt lgkmcnt(0)
    s_barrier
    ds_read_b128 v[28:31], v21 offset:0
    ds_read_b128 v[32:35], v21 offset:1024
    ds_read_b128 v[36:39], v21 offset:2048
    ds_read_b128 v[40:43], v21 offset:3072
    ds_read_b128 v[44:47], v21 offset:16384
    ds_read_b128 v[48:51], v21 offset:17408
    ds_read_b128 v[52:55], v21 offset:18432
    ds_read_b128 v[56:59], v21 offset:19456
    ds_read_b128 v[60:63], v21 offset:32768
    ds_read_b128 v[64:67], v21 offset:33792
    ds_read_b128 v[68:71], v21 offset:34816
    ds_read_b128 v[72:75], v21 offset:35840
    s_waitcnt lgkmcnt(8)
    v_swap_b32 v29, v32
    v_swap_b32 v30, v36
    v_swap_b32 v31, v40
    v_swap_b32 v34, v37
    v_swap_b32 v35, v41
    v_swap_b32 v39, v42
    s_add_u32 s43, s42, 0
    buffer_store_dwordx4 v[28:31], v14, s[32:35], s43 offen offset:0 sc1
    s_add_u32 s43, s42, 67712
    buffer_store_dwordx4 v[32:35], v14, s[32:35], s43 offen offset:0 sc1
    s_add_u32 s43, s42, 135424
    buffer_store_dwordx4 v[36:39], v14, s[32:35], s43 offen offset:0 sc1
    s_add_u32 s43, s42, 203136
    buffer_store_dwordx4 v[40:43], v14, s[32:35], s43 offen offset:0 sc1
    s_waitcnt lgkmcnt(4)
    v_swap_b32 v45, v48
    v_swap_b32 v46, v52
    v_swap_b32 v47, v56
    v_swap_b32 v50, v53
    v_swap_b32 v51, v57
    v_swap_b32 v55, v58
    s_add_u32 s43, s42, 0
    buffer_store_dwordx4 v[44:47], v14, s[32:35], s43 offen offset:512 sc1
    s_add_u32 s43, s42, 67712
    buffer_store_dwordx4 v[48:51], v14, s[32:35], s43 offen offset:512 sc1
    s_add_u32 s43, s42, 135424
    buffer_store_dwordx4 v[52:55], v14, s[32:35], s43 offen offset:512 sc1
    s_add_u32 s43, s42, 203136
    buffer_store_dwordx4 v[56:59], v14, s[32:35], s43 offen offset:512 sc1
    s_waitcnt lgkmcnt(0)
    v_swap_b32 v61, v64
    v_swap_b32 v62, v68
    v_swap_b32 v63, v72
    v_swap_b32 v66, v69
    v_swap_b32 v67, v73
    v_swap_b32 v71, v74
    s_add_u32 s43, s42, 0
    buffer_store_dwordx4 v[60:63], v14, s[32:35], s43 offen offset:1024 sc1
    s_add_u32 s43, s42, 67712
    buffer_store_dwordx4 v[64:67], v14, s[32:35], s43 offen offset:1024 sc1
    s_add_u32 s43, s42, 135424
    buffer_store_dwordx4 v[68:71], v14, s[32:35], s43 offen offset:1024 sc1
    s_add_u32 s43, s42, 203136
    buffer_store_dwordx4 v[72:75], v14, s[32:35], s43 offen offset:1024 sc1
    s_branch L2C
L1C_spec4g:
    s_mul_i32 s41, s41, 2
    s_add_u32 s42, s41, 0
    s_lshl_b32 s42, s42, 5
    v_xor_b32 v2, s42, v10
    s_add_u32 s42, s41, 1
    s_lshl_b32 s42, s42, 5
    v_xor_b32 v3, s42, v10
    v_lshrrev_b32 v21, 4, v1
    v_mul_u32_u24 v21, 270848, v21
    v_and_b32 v20, 15, v1
    v_lshl_add_u32 v14, v20, 4, v21
    v_lshrrev_b32 v20, 4, v1
    v_lshlrev_b32 v20, 4, v20
    v_and_b32 v21, 1, v1
    v_lshl_add_u32 v20, v21, 10, v20
    v_add_u32 v22, 160256, v20
    s_add_u32 s32, s78, 0x580000
    s_addc_u32 s33, s79, 0
    s_mov_b32 s34, 0x211000
    s_mov_b32 s35, 0x20000
    s_mul_i32 s42, s22, 96
    s_mul_i32 s43, s21, 264
    s_add_u32 s42, s42, s43
    s_lshr_b32 s43, s45, 1
    s_lshl_b32 s43, s43, 4
    s_add_u32 s42, s42, s43
    s_lshl_b32 s42, s42, 4
    s_and_b32 s43, s45, 1
    s_mul_i32 s43, s43, 1083392
    s_add_u32 s42, s42, s43
    s_barrier
    ds_read_b128 v[52:55], v6 offset:0
    ds_read_b128 v[56:59], v7 offset:0
    ds_read_b128 v[60:63], v6 offset:2048
    ds_read_b128 v[64:67], v7 offset:2048
    ds_read_b128 v[68:71], v8 offset:0
    ds_read_b128 v[72:75], v9 offset:0
    ds_read_b128 v[76:79], v8 offset:2048
    ds_read_b128 v[80:83], v9 offset:2048
    ds_read_b64_tr_b16 v[28:29], v2 offset:0
    ds_read_b64_tr_b16 v[30:31], v2 offset:1024
    ds_read_b64_tr_b16 v[32:33], v2 offset:16384
    ds_read_b64_tr_b16 v[34:35], v2 offset:17408
    v_add_u32 v6, 49152, v6
    v_add_u32 v7, 49152, v7
    v_add_u32 v8, 49152, v8
    v_add_u32 v9, 49152, v9
    ds_read_b64_tr_b16 v[36:37], v3 offset:0
    ds_read_b64_tr_b16 v[38:39], v3 offset:1024
    ds_read_b64_tr_b16 v[40:41], v3 offset:16384
    s_waitcnt lgkmcnt(10)
    ds_read_b64_tr_b16 v[42:43], v3 offset:17408
    s_waitcnt lgkmcnt(4)
    v_mfma_f32_16x16x32_bf16 v[116:119], v[52:55], v[28:31], 0
    v_mfma_f32_16x16x32_bf16 v[124:127], v[52:55], v[32:35], 0
    v_mfma_f32_16x16x32_bf16 v[120:123], v[60:63], v[28:31], 0
    v_mfma_f32_16x16x32_bf16 v[128:131], v[60:63], v[32:35], 0
    s_waitcnt lgkmcnt(0)
    s_barrier
    ds_read_b64_tr_b16 v[44:45], v2 offset:8192
    ds_read_b64_tr_b16 v[46:47], v2 offset:9216
    v_mfma_f32_16x16x32_bf16 v[132:135], v[68:71], v[28:31], 0
    ds_read_b64_tr_b16 v[48:49], v2 offset:24576
    ds_read_b64_tr_b16 v[50:51], v2 offset:25600
    v_mfma_f32_16x16x32_bf16 v[140:143], v[68:71], v[32:35], 0
    v_add_u32 v2, 49152, v2
    v_mfma_f32_16x16x32_bf16 v[136:139], v[76:79], v[28:31], 0
    v_mfma_f32_16x16x32_bf16 v[144:147], v[76:79], v[32:35], 0
    s_waitcnt lgkmcnt(4)
    v_mfma_f32_16x16x32_bf16 v[148:151], v[52:55], v[36:39], 0
    ds_read_b64_tr_b16 v[28:29], v3 offset:8192
    v_mfma_f32_16x16x32_bf16 v[156:159], v[52:55], v[40:43], 0
    ds_read_b64_tr_b16 v[30:31], v3 offset:9216
    v_mfma_f32_16x16x32_bf16 v[152:155], v[60:63], v[36:39], 0
    ds_read_b64_tr_b16 v[32:33], v3 offset:24576
    v_mfma_f32_16x16x32_bf16 v[160:163], v[60:63], v[40:43], 0
    ds_read_b64_tr_b16 v[34:35], v3 offset:25600
    v_mfma_f32_16x16x32_bf16 v[164:167], v[68:71], v[36:39], 0
    v_add_u32 v3, 49152, v3
    v_mfma_f32_16x16x32_bf16 v[172:175], v[68:71], v[40:43], 0
    v_mfma_f32_16x16x32_bf16 v[168:171], v[76:79], v[36:39], 0
    v_mfma_f32_16x16x32_bf16 v[176:179], v[76:79], v[40:43], 0
    s_waitcnt lgkmcnt(4)
    v_mfma_f32_16x16x32_bf16 v[116:119], v[56:59], v[44:47], v[116:119]
    s_lshl_b32 s44, s49, 7
    v_mfma_f32_16x16x32_bf16 v[124:127], v[56:59], v[48:51], v[124:127]
    v_add_u32 v15, s44, v22
    v_mfma_f32_16x16x32_bf16 v[120:123], v[64:67], v[44:47], v[120:123]
    ds_read_b128 v[36:39], v15
    v_mfma_f32_16x16x32_bf16 v[128:131], v[64:67], v[48:51], v[128:131]
    ds_read_b128 v[40:43], v15 offset:64
    v_mfma_f32_16x16x32_bf16 v[132:135], v[72:75], v[44:47], v[132:135]
    s_add_u32 s49, s49, 1
    v_mfma_f32_16x16x32_bf16 v[140:143], v[72:75], v[48:51], v[140:143]
    s_and_b32 s49, s49, 7
    v_mfma_f32_16x16x32_bf16 v[136:139], v[80:83], v[44:47], v[136:139]
    v_mfma_f32_16x16x32_bf16 v[144:147], v[80:83], v[48:51], v[144:147]
    s_waitcnt lgkmcnt(2)
    v_mfma_f32_16x16x32_bf16 v[148:151], v[56:59], v[28:31], v[148:151]
    v_mfma_f32_16x16x32_bf16 v[156:159], v[56:59], v[32:35], v[156:159]
    v_mfma_f32_16x16x32_bf16 v[152:155], v[64:67], v[28:31], v[152:155]
    v_mfma_f32_16x16x32_bf16 v[160:163], v[64:67], v[32:35], v[160:163]
    s_waitcnt lgkmcnt(0)
    s_barrier
    ds_read_b128 v[84:87], v6 offset:0
    ds_read_b128 v[88:91], v7 offset:0
    v_mfma_f32_16x16x32_bf16 v[164:167], v[72:75], v[28:31], v[164:167]
    ds_read_b128 v[92:95], v6 offset:2048
    ds_read_b128 v[96:99], v7 offset:2048
    v_mfma_f32_16x16x32_bf16 v[172:175], v[72:75], v[32:35], v[172:175]
    ds_read_b128 v[100:103], v8 offset:0
    ds_read_b128 v[104:107], v9 offset:0
    v_mfma_f32_16x16x32_bf16 v[168:171], v[80:83], v[28:31], v[168:171]
    ds_read_b128 v[108:111], v8 offset:2048
    ds_read_b128 v[112:115], v9 offset:2048
    v_mfma_f32_16x16x32_bf16 v[176:179], v[80:83], v[32:35], v[176:179]
    s_lshl_b32 s44, s49, 7
    v_add_u32 v15, s44, v22
    s_waitcnt lgkmcnt(8)
    v_mfma_f32_16x16x32_bf16 v[180:183], v[52:55], v[36:39], 0
    ds_read_b128 v[44:47], v15
    ds_read_b128 v[48:51], v15 offset:64
    s_add_u32 s49, s49, 1
    v_mfma_f32_16x16x32_bf16 v[180:183], v[56:59], v[40:43], v[180:183]
    s_and_b32 s49, s49, 7
    v_add_u32 v6, 49152, v6
    v_add_u32 v7, 49152, v7
    v_mfma_f32_16x16x32_bf16 v[184:187], v[60:63], v[36:39], 0
    v_add_u32 v8, 49152, v8
    v_add_u32 v9, 49152, v9
    ds_read_b64_tr_b16 v[28:29], v2 offset:0
    v_mfma_f32_16x16x32_bf16 v[184:187], v[64:67], v[40:43], v[184:187]
    ds_read_b64_tr_b16 v[30:31], v2 offset:1024
    ds_read_b64_tr_b16 v[32:33], v2 offset:8192
    ds_read_b64_tr_b16 v[34:35], v2 offset:9216
    s_waitcnt lgkmcnt(4)
    v_mfma_f32_16x16x32_bf16 v[180:183], v[84:87], v[44:47], v[180:183]
    ds_read_b64_tr_b16 v[36:37], v2 offset:16384
    ds_read_b64_tr_b16 v[38:39], v2 offset:17408
    v_mfma_f32_16x16x32_bf16 v[180:183], v[88:91], v[48:51], v[180:183]
    ds_read_b64_tr_b16 v[40:41], v2 offset:24576
    v_mfma_f32_16x16x32_bf16 v[184:187], v[92:95], v[44:47], v[184:187]
    ds_read_b64_tr_b16 v[42:43], v2 offset:25600
    v_mfma_f32_16x16x32_bf16 v[184:187], v[96:99], v[48:51], v[184:187]
    v_add_u32 v2, 49152, v2
    s_waitcnt lgkmcnt(4)
    v_mfma_f32_16x16x32_bf16 v[116:119], v[84:87], v[28:31], v[116:119]
    ds_read_b64_tr_b16 v[44:45], v3 offset:0
    v_mfma_f32_16x16x32_bf16 v[116:119], v[88:91], v[32:35], v[116:119]
    ds_read_b64_tr_b16 v[46:47], v3 offset:1024
    v_mfma_f32_16x16x32_bf16 v[120:123], v[96:99], v[32:35], v[120:123]
    ds_read_b64_tr_b16 v[48:49], v3 offset:8192
    v_mfma_f32_16x16x32_bf16 v[120:123], v[92:95], v[28:31], v[120:123]
    ds_read_b64_tr_b16 v[50:51], v3 offset:9216
    v_mfma_f32_16x16x32_bf16 v[132:135], v[100:103], v[28:31], v[132:135]
    v_mfma_f32_16x16x32_bf16 v[132:135], v[104:107], v[32:35], v[132:135]
    v_mfma_f32_16x16x32_bf16 v[136:139], v[112:115], v[32:35], v[136:139]
    v_mfma_f32_16x16x32_bf16 v[136:139], v[108:111], v[28:31], v[136:139]
    s_waitcnt lgkmcnt(4)
    v_mfma_f32_16x16x32_bf16 v[124:127], v[84:87], v[36:39], v[124:127]
    ds_read_b64_tr_b16 v[28:29], v3 offset:16384
    v_mfma_f32_16x16x32_bf16 v[124:127], v[88:91], v[40:43], v[124:127]
    ds_read_b64_tr_b16 v[30:31], v3 offset:17408
    v_mfma_f32_16x16x32_bf16 v[128:131], v[96:99], v[40:43], v[128:131]
    ds_read_b64_tr_b16 v[32:33], v3 offset:24576
    v_mfma_f32_16x16x32_bf16 v[128:131], v[92:95], v[36:39], v[128:131]
    ds_read_b64_tr_b16 v[34:35], v3 offset:25600
    v_mfma_f32_16x16x32_bf16 v[140:143], v[100:103], v[36:39], v[140:143]
    v_add_u32 v3, 49152, v3
    v_mfma_f32_16x16x32_bf16 v[140:143], v[104:107], v[40:43], v[140:143]
    v_mfma_f32_16x16x32_bf16 v[144:147], v[112:115], v[40:43], v[144:147]
    v_mfma_f32_16x16x32_bf16 v[144:147], v[108:111], v[36:39], v[144:147]
    s_waitcnt lgkmcnt(4)
    v_mfma_f32_16x16x32_bf16 v[148:151], v[84:87], v[44:47], v[148:151]
    v_mfma_f32_16x16x32_bf16 v[148:151], v[88:91], v[48:51], v[148:151]
    v_mfma_f32_16x16x32_bf16 v[152:155], v[96:99], v[48:51], v[152:155]
    v_mfma_f32_16x16x32_bf16 v[152:155], v[92:95], v[44:47], v[152:155]
    s_waitcnt lgkmcnt(0)
    s_barrier
    ds_read_b128 v[52:55], v6 offset:0
    ds_read_b128 v[56:59], v7 offset:0
    v_mfma_f32_16x16x32_bf16 v[164:167], v[100:103], v[44:47], v[164:167]
    ds_read_b128 v[60:63], v6 offset:2048
    ds_read_b128 v[64:67], v7 offset:2048
    v_mfma_f32_16x16x32_bf16 v[164:167], v[104:107], v[48:51], v[164:167]
    ds_read_b128 v[68:71], v8 offset:0
    ds_read_b128 v[72:75], v9 offset:0
    v_mfma_f32_16x16x32_bf16 v[168:171], v[112:115], v[48:51], v[168:171]
    ds_read_b128 v[76:79], v8 offset:2048
    ds_read_b128 v[80:83], v9 offset:2048
    v_mfma_f32_16x16x32_bf16 v[168:171], v[108:111], v[44:47], v[168:171]
    s_lshl_b32 s44, s49, 7
    v_add_u32 v15, s44, v22
    s_waitcnt lgkmcnt(8)
    v_mfma_f32_16x16x32_bf16 v[156:159], v[84:87], v[28:31], v[156:159]
    ds_read_b128 v[36:39], v15
    ds_read_b128 v[40:43], v15 offset:64
    v_mfma_f32_16x16x32_bf16 v[156:159], v[88:91], v[32:35], v[156:159]
    s_add_u32 s49, s49, 1
    s_and_b32 s49, s49, 7
    v_mfma_f32_16x16x32_bf16 v[160:163], v[96:99], v[32:35], v[160:163]
    v_subrev_u32 v6, 98304, v6
    v_subrev_u32 v7, 98304, v7
    v_mfma_f32_16x16x32_bf16 v[160:163], v[92:95], v[28:31], v[160:163]
    v_subrev_u32 v8, 98304, v8
    v_subrev_u32 v9, 98304, v9
    v_mfma_f32_16x16x32_bf16 v[172:175], v[100:103], v[28:31], v[172:175]
    ds_read_b64_tr_b16 v[44:45], v2 offset:0
    v_mfma_f32_16x16x32_bf16 v[172:175], v[104:107], v[32:35], v[172:175]
    ds_read_b64_tr_b16 v[46:47], v2 offset:1024
    v_mfma_f32_16x16x32_bf16 v[176:179], v[112:115], v[32:35], v[176:179]
    ds_read_b64_tr_b16 v[48:49], v2 offset:8192
    v_mfma_f32_16x16x32_bf16 v[176:179], v[108:111], v[28:31], v[176:179]
    ds_read_b64_tr_b16 v[50:51], v2 offset:9216
    s_waitcnt lgkmcnt(4)
    v_mfma_f32_16x16x32_bf16 v[180:183], v[52:55], v[36:39], v[180:183]
    ds_read_b64_tr_b16 v[28:29], v2 offset:16384
    ds_read_b64_tr_b16 v[30:31], v2 offset:17408
    v_mfma_f32_16x16x32_bf16 v[180:183], v[56:59], v[40:43], v[180:183]
    ds_read_b64_tr_b16 v[32:33], v2 offset:24576
    v_mfma_f32_16x16x32_bf16 v[184:187], v[60:63], v[36:39], v[184:187]
    ds_read_b64_tr_b16 v[34:35], v2 offset:25600
    v_mfma_f32_16x16x32_bf16 v[184:187], v[64:67], v[40:43], v[184:187]
    v_subrev_u32 v2, 98304, v2
    s_waitcnt lgkmcnt(4)
    v_mfma_f32_16x16x32_bf16 v[116:119], v[52:55], v[44:47], v[116:119]
    ds_read_b64_tr_b16 v[36:37], v3 offset:0
    v_mfma_f32_16x16x32_bf16 v[116:119], v[56:59], v[48:51], v[116:119]
    ds_read_b64_tr_b16 v[38:39], v3 offset:1024
    v_mfma_f32_16x16x32_bf16 v[120:123], v[64:67], v[48:51], v[120:123]
    ds_read_b64_tr_b16 v[40:41], v3 offset:8192
    v_mfma_f32_16x16x32_bf16 v[120:123], v[60:63], v[44:47], v[120:123]
    ds_read_b64_tr_b16 v[42:43], v3 offset:9216
    v_mfma_f32_16x16x32_bf16 v[132:135], v[68:71], v[44:47], v[132:135]
    v_mfma_f32_16x16x32_bf16 v[132:135], v[72:75], v[48:51], v[132:135]
    v_mfma_f32_16x16x32_bf16 v[136:139], v[80:83], v[48:51], v[136:139]
    v_mfma_f32_16x16x32_bf16 v[136:139], v[76:79], v[44:47], v[136:139]
    s_waitcnt lgkmcnt(4)
    v_mfma_f32_16x16x32_bf16 v[124:127], v[52:55], v[28:31], v[124:127]
    ds_read_b64_tr_b16 v[44:45], v3 offset:16384
    v_mfma_f32_16x16x32_bf16 v[124:127], v[56:59], v[32:35], v[124:127]
    ds_read_b64_tr_b16 v[46:47], v3 offset:17408
    v_mfma_f32_16x16x32_bf16 v[128:131], v[64:67], v[32:35], v[128:131]
    ds_read_b64_tr_b16 v[48:49], v3 offset:24576
    v_mfma_f32_16x16x32_bf16 v[128:131], v[60:63], v[28:31], v[128:131]
    ds_read_b64_tr_b16 v[50:51], v3 offset:25600
    v_mfma_f32_16x16x32_bf16 v[140:143], v[68:71], v[28:31], v[140:143]
    v_subrev_u32 v3, 98304, v3
    v_mfma_f32_16x16x32_bf16 v[140:143], v[72:75], v[32:35], v[140:143]
    v_mfma_f32_16x16x32_bf16 v[144:147], v[80:83], v[32:35], v[144:147]
    v_mfma_f32_16x16x32_bf16 v[144:147], v[76:79], v[28:31], v[144:147]
    s_waitcnt lgkmcnt(4)
    v_mfma_f32_16x16x32_bf16 v[148:151], v[52:55], v[36:39], v[148:151]
    v_mfma_f32_16x16x32_bf16 v[148:151], v[56:59], v[40:43], v[148:151]
    v_mfma_f32_16x16x32_bf16 v[152:155], v[64:67], v[40:43], v[152:155]
    v_mfma_f32_16x16x32_bf16 v[152:155], v[60:63], v[36:39], v[152:155]
    s_waitcnt lgkmcnt(0)
    s_barrier
    ds_read_b128 v[84:87], v6 offset:0
    ds_read_b128 v[88:91], v7 offset:0
    v_mfma_f32_16x16x32_bf16 v[164:167], v[68:71], v[36:39], v[164:167]
    ds_read_b128 v[92:95], v6 offset:2048
    ds_read_b128 v[96:99], v7 offset:2048
    v_mfma_f32_16x16x32_bf16 v[164:167], v[72:75], v[40:43], v[164:167]
    ds_read_b128 v[100:103], v8 offset:0
    ds_read_b128 v[104:107], v9 offset:0
    v_mfma_f32_16x16x32_bf16 v[168:171], v[80:83], v[40:43], v[168:171]
    ds_read_b128 v[108:111], v8 offset:2048
    ds_read_b128 v[112:115], v9 offset:2048
    v_mfma_f32_16x16x32_bf16 v[168:171], v[76:79], v[36:39], v[168:171]
    s_lshl_b32 s44, s49, 7
    v_add_u32 v15, s44, v22
    s_waitcnt lgkmcnt(8)
    v_mfma_f32_16x16x32_bf16 v[156:159], v[52:55], v[44:47], v[156:159]
    ds_read_b128 v[28:31], v15
    ds_read_b128 v[32:35], v15 offset:64
    v_mfma_f32_16x16x32_bf16 v[156:159], v[56:59], v[48:51], v[156:159]
    s_add_u32 s49, s49, 1
    s_and_b32 s49, s49, 7
    v_mfma_f32_16x16x32_bf16 v[160:163], v[64:67], v[48:51], v[160:163]
    v_add_u32 v6, 49152, v6
    v_add_u32 v7, 49152, v7
    v_mfma_f32_16x16x32_bf16 v[160:163], v[60:63], v[44:47], v[160:163]
    v_add_u32 v8, 49152, v8
    v_add_u32 v9, 49152, v9
    v_mfma_f32_16x16x32_bf16 v[172:175], v[68:71], v[44:47], v[172:175]
    ds_read_b64_tr_b16 v[36:37], v2 offset:0
    v_mfma_f32_16x16x32_bf16 v[172:175], v[72:75], v[48:51], v[172:175]
    ds_read_b64_tr_b16 v[38:39], v2 offset:1024
    v_mfma_f32_16x16x32_bf16 v[176:179], v[80:83], v[48:51], v[176:179]
    ds_read_b64_tr_b16 v[40:41], v2 offset:8192
    v_mfma_f32_16x16x32_bf16 v[176:179], v[76:79], v[44:47], v[176:179]
    ds_read_b64_tr_b16 v[42:43], v2 offset:9216
    s_waitcnt lgkmcnt(4)
    v_mfma_f32_16x16x32_bf16 v[180:183], v[84:87], v[28:31], v[180:183]
    ds_read_b64_tr_b16 v[44:45], v2 offset:16384
    ds_read_b64_tr_b16 v[46:47], v2 offset:17408
    v_mfma_f32_16x16x32_bf16 v[180:183], v[88:91], v[32:35], v[180:183]
    ds_read_b64_tr_b16 v[48:49], v2 offset:24576
    v_mfma_f32_16x16x32_bf16 v[184:187], v[92:95], v[28:31], v[184:187]
    ds_read_b64_tr_b16 v[50:51], v2 offset:25600
    v_mfma_f32_16x16x32_bf16 v[184:187], v[96:99], v[32:35], v[184:187]
    v_add_u32 v2, 49152, v2
    s_waitcnt lgkmcnt(4)
    v_mfma_f32_16x16x32_bf16 v[116:119], v[84:87], v[36:39], v[116:119]
    ds_read_b64_tr_b16 v[28:29], v3 offset:0
    v_mfma_f32_16x16x32_bf16 v[116:119], v[88:91], v[40:43], v[116:119]
    ds_read_b64_tr_b16 v[30:31], v3 offset:1024
    v_mfma_f32_16x16x32_bf16 v[120:123], v[96:99], v[40:43], v[120:123]
    ds_read_b64_tr_b16 v[32:33], v3 offset:8192
    v_mfma_f32_16x16x32_bf16 v[120:123], v[92:95], v[36:39], v[120:123]
    ds_read_b64_tr_b16 v[34:35], v3 offset:9216
    v_mfma_f32_16x16x32_bf16 v[132:135], v[100:103], v[36:39], v[132:135]
    v_mfma_f32_16x16x32_bf16 v[132:135], v[104:107], v[40:43], v[132:135]
    v_mfma_f32_16x16x32_bf16 v[136:139], v[112:115], v[40:43], v[136:139]
    v_mfma_f32_16x16x32_bf16 v[136:139], v[108:111], v[36:39], v[136:139]
    s_waitcnt lgkmcnt(4)
    v_mfma_f32_16x16x32_bf16 v[124:127], v[84:87], v[44:47], v[124:127]
    ds_read_b64_tr_b16 v[36:37], v3 offset:16384
    v_mfma_f32_16x16x32_bf16 v[124:127], v[88:91], v[48:51], v[124:127]
    ds_read_b64_tr_b16 v[38:39], v3 offset:17408
    v_mfma_f32_16x16x32_bf16 v[128:131], v[96:99], v[48:51], v[128:131]
    ds_read_b64_tr_b16 v[40:41], v3 offset:24576
    v_mfma_f32_16x16x32_bf16 v[128:131], v[92:95], v[44:47], v[128:131]
    ds_read_b64_tr_b16 v[42:43], v3 offset:25600
    v_mfma_f32_16x16x32_bf16 v[140:143], v[100:103], v[44:47], v[140:143]
    v_add_u32 v3, 49152, v3
    v_mfma_f32_16x16x32_bf16 v[140:143], v[104:107], v[48:51], v[140:143]
    v_mfma_f32_16x16x32_bf16 v[144:147], v[112:115], v[48:51], v[144:147]
    v_mfma_f32_16x16x32_bf16 v[144:147], v[108:111], v[44:47], v[144:147]
    s_waitcnt lgkmcnt(4)
    v_mfma_f32_16x16x32_bf16 v[148:151], v[84:87], v[28:31], v[148:151]
    v_mfma_f32_16x16x32_bf16 v[148:151], v[88:91], v[32:35], v[148:151]
    v_mfma_f32_16x16x32_bf16 v[152:155], v[96:99], v[32:35], v[152:155]
    v_mfma_f32_16x16x32_bf16 v[152:155], v[92:95], v[28:31], v[152:155]
    s_waitcnt lgkmcnt(0)
    s_barrier
    ds_read_b128 v[52:55], v6 offset:0
    ds_read_b128 v[56:59], v7 offset:0
    v_mfma_f32_16x16x32_bf16 v[164:167], v[100:103], v[28:31], v[164:167]
    ds_read_b128 v[60:63], v6 offset:2048
    ds_read_b128 v[64:67], v7 offset:2048
    v_mfma_f32_16x16x32_bf16 v[164:167], v[104:107], v[32:35], v[164:167]
    ds_read_b128 v[68:71], v8 offset:0
    ds_read_b128 v[72:75], v9 offset:0
    v_mfma_f32_16x16x32_bf16 v[168:171], v[112:115], v[32:35], v[168:171]
    ds_read_b128 v[76:79], v8 offset:2048
    ds_read_b128 v[80:83], v9 offset:2048
    v_mfma_f32_16x16x32_bf16 v[168:171], v[108:111], v[28:31], v[168:171]
    s_lshl_b32 s44, s49, 7
    v_add_u32 v15, s44, v22
    s_waitcnt lgkmcnt(8)
    v_mfma_f32_16x16x32_bf16 v[156:159], v[84:87], v[36:39], v[156:159]
    ds_read_b128 v[44:47], v15
    ds_read_b128 v[48:51], v15 offset:64
    v_mfma_f32_16x16x32_bf16 v[156:159], v[88:91], v[40:43], v[156:159]
    s_add_u32 s49, s49, 1
    s_and_b32 s49, s49, 7
    v_mfma_f32_16x16x32_bf16 v[160:163], v[96:99], v[40:43], v[160:163]
    v_add_u32 v6, 49152, v6
    v_add_u32 v7, 49152, v7
    v_mfma_f32_16x16x32_bf16 v[160:163], v[92:95], v[36:39], v[160:163]
    v_add_u32 v8, 49152, v8
    v_add_u32 v9, 49152, v9
    v_mfma_f32_16x16x32_bf16 v[172:175], v[100:103], v[36:39], v[172:175]
    ds_read_b64_tr_b16 v[28:29], v2 offset:0
    v_mfma_f32_16x16x32_bf16 v[172:175], v[104:107], v[40:43], v[172:175]
    ds_read_b64_tr_b16 v[30:31], v2 offset:1024
    v_mfma_f32_16x16x32_bf16 v[176:179], v[112:115], v[40:43], v[176:179]
    ds_read_b64_tr_b16 v[32:33], v2 offset:8192
    v_mfma_f32_16x16x32_bf16 v[176:179], v[108:111], v[36:39], v[176:179]
    ds_read_b64_tr_b16 v[34:35], v2 offset:9216
    s_waitcnt lgkmcnt(4)
    v_mfma_f32_16x16x32_bf16 v[180:183], v[52:55], v[44:47], v[180:183]
    ds_read_b64_tr_b16 v[36:37], v2 offset:16384
    ds_read_b64_tr_b16 v[38:39], v2 offset:17408
    v_mfma_f32_16x16x32_bf16 v[180:183], v[56:59], v[48:51], v[180:183]
    ds_read_b64_tr_b16 v[40:41], v2 offset:24576
    v_mfma_f32_16x16x32_bf16 v[184:187], v[60:63], v[44:47], v[184:187]
    ds_read_b64_tr_b16 v[42:43], v2 offset:25600
    v_mfma_f32_16x16x32_bf16 v[184:187], v[64:67], v[48:51], v[184:187]
    v_add_u32 v2, 49152, v2
    s_waitcnt lgkmcnt(4)
    v_mfma_f32_16x16x32_bf16 v[116:119], v[52:55], v[28:31], v[116:119]
    ds_read_b64_tr_b16 v[44:45], v3 offset:0
    v_mfma_f32_16x16x32_bf16 v[116:119], v[56:59], v[32:35], v[116:119]
    ds_read_b64_tr_b16 v[46:47], v3 offset:1024
    v_mfma_f32_16x16x32_bf16 v[120:123], v[64:67], v[32:35], v[120:123]
    ds_read_b64_tr_b16 v[48:49], v3 offset:8192
    v_mfma_f32_16x16x32_bf16 v[120:123], v[60:63], v[28:31], v[120:123]
    ds_read_b64_tr_b16 v[50:51], v3 offset:9216
    v_mfma_f32_16x16x32_bf16 v[132:135], v[68:71], v[28:31], v[132:135]
    v_mfma_f32_16x16x32_bf16 v[132:135], v[72:75], v[32:35], v[132:135]
    v_mfma_f32_16x16x32_bf16 v[136:139], v[80:83], v[32:35], v[136:139]
    v_mfma_f32_16x16x32_bf16 v[136:139], v[76:79], v[28:31], v[136:139]
    s_waitcnt lgkmcnt(4)
    v_mfma_f32_16x16x32_bf16 v[124:127], v[52:55], v[36:39], v[124:127]
    ds_read_b64_tr_b16 v[28:29], v3 offset:16384
    v_mfma_f32_16x16x32_bf16 v[124:127], v[56:59], v[40:43], v[124:127]
    ds_read_b64_tr_b16 v[30:31], v3 offset:17408
    v_mfma_f32_16x16x32_bf16 v[128:131], v[64:67], v[40:43], v[128:131]
    ds_read_b64_tr_b16 v[32:33], v3 offset:24576
    v_mfma_f32_16x16x32_bf16 v[128:131], v[60:63], v[36:39], v[128:131]
    ds_read_b64_tr_b16 v[34:35], v3 offset:25600
    v_mfma_f32_16x16x32_bf16 v[140:143], v[68:71], v[36:39], v[140:143]
    v_add_u32 v3, 49152, v3
    v_mfma_f32_16x16x32_bf16 v[140:143], v[72:75], v[40:43], v[140:143]
    v_mfma_f32_16x16x32_bf16 v[144:147], v[80:83], v[40:43], v[144:147]
    v_mfma_f32_16x16x32_bf16 v[144:147], v[76:79], v[36:39], v[144:147]
    s_waitcnt lgkmcnt(4)
    v_mfma_f32_16x16x32_bf16 v[148:151], v[52:55], v[44:47], v[148:151]
    v_mfma_f32_16x16x32_bf16 v[148:151], v[56:59], v[48:51], v[148:151]
    v_mfma_f32_16x16x32_bf16 v[152:155], v[64:67], v[48:51], v[152:155]
    v_mfma_f32_16x16x32_bf16 v[152:155], v[60:63], v[44:47], v[152:155]
    s_waitcnt lgkmcnt(0)
    s_barrier
    ds_read_b128 v[84:87], v6 offset:0
    ds_read_b128 v[88:91], v7 offset:0
    v_mfma_f32_16x16x32_bf16 v[164:167], v[68:71], v[44:47], v[164:167]
    ds_read_b128 v[92:95], v6 offset:2048
    ds_read_b128 v[96:99], v7 offset:2048
    v_mfma_f32_16x16x32_bf16 v[164:167], v[72:75], v[48:51], v[164:167]
    ds_read_b128 v[100:103], v8 offset:0
    ds_read_b128 v[104:107], v9 offset:0
    v_mfma_f32_16x16x32_bf16 v[168:171], v[80:83], v[48:51], v[168:171]
    ds_read_b128 v[108:111], v8 offset:2048
    ds_read_b128 v[112:115], v9 offset:2048
    v_mfma_f32_16x16x32_bf16 v[168:171], v[76:79], v[44:47], v[168:171]
    s_lshl_b32 s44, s49, 7
    v_add_u32 v15, s44, v22
    s_waitcnt lgkmcnt(8)
    v_mfma_f32_16x16x32_bf16 v[156:159], v[52:55], v[28:31], v[156:159]
    ds_read_b128 v[36:39], v15
    ds_read_b128 v[40:43], v15 offset:64
    v_mfma_f32_16x16x32_bf16 v[156:159], v[56:59], v[32:35], v[156:159]
    s_add_u32 s49, s49, 1
    s_and_b32 s49, s49, 7
    v_mfma_f32_16x16x32_bf16 v[160:163], v[64:67], v[32:35], v[160:163]
    v_subrev_u32 v6, 98304, v6
    v_subrev_u32 v7, 98304, v7
    v_mfma_f32_16x16x32_bf16 v[160:163], v[60:63], v[28:31], v[160:163]
    v_subrev_u32 v8, 98304, v8
    v_subrev_u32 v9, 98304, v9
    v_mfma_f32_16x16x32_bf16 v[172:175], v[68:71], v[28:31], v[172:175]
    ds_read_b64_tr_b16 v[44:45], v2 offset:0
    v_mfma_f32_16x16x32_bf16 v[172:175], v[72:75], v[32:35], v[172:175]
    ds_read_b64_tr_b16 v[46:47], v2 offset:1024
    v_mfma_f32_16x16x32_bf16 v[176:179], v[80:83], v[32:35], v[176:179]
    ds_read_b64_tr_b16 v[48:49], v2 offset:8192
    v_mfma_f32_16x16x32_bf16 v[176:179], v[76:79], v[28:31], v[176:179]
    ds_read_b64_tr_b16 v[50:51], v2 offset:9216
    s_waitcnt lgkmcnt(4)
    v_mfma_f32_16x16x32_bf16 v[180:183], v[84:87], v[36:39], v[180:183]
    ds_read_b64_tr_b16 v[28:29], v2 offset:16384
    ds_read_b64_tr_b16 v[30:31], v2 offset:17408
    v_mfma_f32_16x16x32_bf16 v[180:183], v[88:91], v[40:43], v[180:183]
    ds_read_b64_tr_b16 v[32:33], v2 offset:24576
    v_mfma_f32_16x16x32_bf16 v[184:187], v[92:95], v[36:39], v[184:187]
    ds_read_b64_tr_b16 v[34:35], v2 offset:25600
    v_mfma_f32_16x16x32_bf16 v[184:187], v[96:99], v[40:43], v[184:187]
    v_subrev_u32 v2, 98304, v2
    s_waitcnt lgkmcnt(4)
    v_mfma_f32_16x16x32_bf16 v[116:119], v[84:87], v[44:47], v[116:119]
    ds_read_b64_tr_b16 v[36:37], v3 offset:0
    v_mfma_f32_16x16x32_bf16 v[116:119], v[88:91], v[48:51], v[116:119]
    ds_read_b64_tr_b16 v[38:39], v3 offset:1024
    v_mfma_f32_16x16x32_bf16 v[120:123], v[96:99], v[48:51], v[120:123]
    ds_read_b64_tr_b16 v[40:41], v3 offset:8192
    v_mfma_f32_16x16x32_bf16 v[120:123], v[92:95], v[44:47], v[120:123]
    ds_read_b64_tr_b16 v[42:43], v3 offset:9216
    v_mfma_f32_16x16x32_bf16 v[132:135], v[100:103], v[44:47], v[132:135]
    v_mfma_f32_16x16x32_bf16 v[132:135], v[104:107], v[48:51], v[132:135]
    v_mfma_f32_16x16x32_bf16 v[136:139], v[112:115], v[48:51], v[136:139]
    v_mfma_f32_16x16x32_bf16 v[136:139], v[108:111], v[44:47], v[136:139]
    s_waitcnt lgkmcnt(4)
    v_mfma_f32_16x16x32_bf16 v[124:127], v[84:87], v[28:31], v[124:127]
    ds_read_b64_tr_b16 v[44:45], v3 offset:16384
    v_mfma_f32_16x16x32_bf16 v[124:127], v[88:91], v[32:35], v[124:127]
    ds_read_b64_tr_b16 v[46:47], v3 offset:17408
    v_mfma_f32_16x16x32_bf16 v[128:131], v[96:99], v[32:35], v[128:131]
    ds_read_b64_tr_b16 v[48:49], v3 offset:24576
    v_mfma_f32_16x16x32_bf16 v[128:131], v[92:95], v[28:31], v[128:131]
    ds_read_b64_tr_b16 v[50:51], v3 offset:25600
    v_mfma_f32_16x16x32_bf16 v[140:143], v[100:103], v[28:31], v[140:143]
    v_subrev_u32 v3, 98304, v3
    v_mfma_f32_16x16x32_bf16 v[140:143], v[104:107], v[32:35], v[140:143]
    v_mfma_f32_16x16x32_bf16 v[144:147], v[112:115], v[32:35], v[144:147]
    v_mfma_f32_16x16x32_bf16 v[144:147], v[108:111], v[28:31], v[144:147]
    s_waitcnt lgkmcnt(4)
    v_mfma_f32_16x16x32_bf16 v[148:151], v[84:87], v[36:39], v[148:151]
    v_mfma_f32_16x16x32_bf16 v[148:151], v[88:91], v[40:43], v[148:151]
    v_mfma_f32_16x16x32_bf16 v[152:155], v[96:99], v[40:43], v[152:155]
    v_mfma_f32_16x16x32_bf16 v[152:155], v[92:95], v[36:39], v[152:155]
    s_waitcnt lgkmcnt(0)
    s_barrier
    ds_read_b128 v[52:55], v6 offset:0
    ds_read_b128 v[56:59], v7 offset:0
    v_mfma_f32_16x16x32_bf16 v[164:167], v[100:103], v[36:39], v[164:167]
    ds_read_b128 v[60:63], v6 offset:2048
    ds_read_b128 v[64:67], v7 offset:2048
    v_mfma_f32_16x16x32_bf16 v[164:167], v[104:107], v[40:43], v[164:167]
    ds_read_b128 v[68:71], v8 offset:0
    ds_read_b128 v[72:75], v9 offset:0
    v_mfma_f32_16x16x32_bf16 v[168:171], v[112:115], v[40:43], v[168:171]
    ds_read_b128 v[76:79], v8 offset:2048
    ds_read_b128 v[80:83], v9 offset:2048
    v_mfma_f32_16x16x32_bf16 v[168:171], v[108:111], v[36:39], v[168:171]
    s_lshl_b32 s44, s49, 7
    v_add_u32 v15, s44, v22
    s_waitcnt lgkmcnt(8)
    v_mfma_f32_16x16x32_bf16 v[156:159], v[84:87], v[44:47], v[156:159]
    ds_read_b128 v[28:31], v15
    ds_read_b128 v[32:35], v15 offset:64
    v_mfma_f32_16x16x32_bf16 v[156:159], v[88:91], v[48:51], v[156:159]
    s_add_u32 s49, s49, 1
    s_and_b32 s49, s49, 7
    v_mfma_f32_16x16x32_bf16 v[160:163], v[96:99], v[48:51], v[160:163]
    v_add_u32 v6, 49152, v6
    v_add_u32 v7, 49152, v7
    v_mfma_f32_16x16x32_bf16 v[160:163], v[92:95], v[44:47], v[160:163]
    v_add_u32 v8, 49152, v8
    v_add_u32 v9, 49152, v9
    v_mfma_f32_16x16x32_bf16 v[172:175], v[100:103], v[44:47], v[172:175]
    ds_read_b64_tr_b16 v[36:37], v2 offset:0
    v_mfma_f32_16x16x32_bf16 v[172:175], v[104:107], v[48:51], v[172:175]
    ds_read_b64_tr_b16 v[38:39], v2 offset:1024
    v_mfma_f32_16x16x32_bf16 v[176:179], v[112:115], v[48:51], v[176:179]
    ds_read_b64_tr_b16 v[40:41], v2 offset:8192
    v_mfma_f32_16x16x32_bf16 v[176:179], v[108:111], v[44:47], v[176:179]
    ds_read_b64_tr_b16 v[42:43], v2 offset:9216
    s_waitcnt lgkmcnt(4)
    v_mfma_f32_16x16x32_bf16 v[180:183], v[52:55], v[28:31], v[180:183]
    ds_read_b64_tr_b16 v[44:45], v2 offset:16384
    ds_read_b64_tr_b16 v[46:47], v2 offset:17408
    v_mfma_f32_16x16x32_bf16 v[180:183], v[56:59], v[32:35], v[180:183]
    ds_read_b64_tr_b16 v[48:49], v2 offset:24576
    v_mfma_f32_16x16x32_bf16 v[184:187], v[60:63], v[28:31], v[184:187]
    ds_read_b64_tr_b16 v[50:51], v2 offset:25600
    v_mfma_f32_16x16x32_bf16 v[184:187], v[64:67], v[32:35], v[184:187]
    v_add_u32 v2, 49152, v2
    s_waitcnt lgkmcnt(4)
    v_mfma_f32_16x16x32_bf16 v[116:119], v[52:55], v[36:39], v[116:119]
    ds_read_b64_tr_b16 v[28:29], v3 offset:0
    v_mfma_f32_16x16x32_bf16 v[116:119], v[56:59], v[40:43], v[116:119]
    ds_read_b64_tr_b16 v[30:31], v3 offset:1024
    v_mfma_f32_16x16x32_bf16 v[120:123], v[64:67], v[40:43], v[120:123]
    ds_read_b64_tr_b16 v[32:33], v3 offset:8192
    v_mfma_f32_16x16x32_bf16 v[120:123], v[60:63], v[36:39], v[120:123]
    ds_read_b64_tr_b16 v[34:35], v3 offset:9216
    v_mfma_f32_16x16x32_bf16 v[132:135], v[68:71], v[36:39], v[132:135]
    v_mfma_f32_16x16x32_bf16 v[132:135], v[72:75], v[40:43], v[132:135]
    v_mfma_f32_16x16x32_bf16 v[136:139], v[80:83], v[40:43], v[136:139]
    v_mfma_f32_16x16x32_bf16 v[136:139], v[76:79], v[36:39], v[136:139]
    s_waitcnt lgkmcnt(4)
    v_mfma_f32_16x16x32_bf16 v[124:127], v[52:55], v[44:47], v[124:127]
    ds_read_b64_tr_b16 v[36:37], v3 offset:16384
    v_mfma_f32_16x16x32_bf16 v[124:127], v[56:59], v[48:51], v[124:127]
    ds_read_b64_tr_b16 v[38:39], v3 offset:17408
    v_mfma_f32_16x16x32_bf16 v[128:131], v[64:67], v[48:51], v[128:131]
    ds_read_b64_tr_b16 v[40:41], v3 offset:24576
    v_mfma_f32_16x16x32_bf16 v[128:131], v[60:63], v[44:47], v[128:131]
    ds_read_b64_tr_b16 v[42:43], v3 offset:25600
    v_mfma_f32_16x16x32_bf16 v[140:143], v[68:71], v[44:47], v[140:143]
    v_add_u32 v3, 49152, v3
    v_mfma_f32_16x16x32_bf16 v[140:143], v[72:75], v[48:51], v[140:143]
    v_mfma_f32_16x16x32_bf16 v[144:147], v[80:83], v[48:51], v[144:147]
    v_mfma_f32_16x16x32_bf16 v[144:147], v[76:79], v[44:47], v[144:147]
    s_waitcnt lgkmcnt(4)
    v_mfma_f32_16x16x32_bf16 v[148:151], v[52:55], v[28:31], v[148:151]
    v_mfma_f32_16x16x32_bf16 v[148:151], v[56:59], v[32:35], v[148:151]
    v_mfma_f32_16x16x32_bf16 v[152:155], v[64:67], v[32:35], v[152:155]
    v_mfma_f32_16x16x32_bf16 v[152:155], v[60:63], v[28:31], v[152:155]
    s_waitcnt lgkmcnt(0)
    s_barrier
    ds_read_b128 v[84:87], v6 offset:0
    ds_read_b128 v[88:91], v7 offset:0
    v_mfma_f32_16x16x32_bf16 v[164:167], v[68:71], v[28:31], v[164:167]
    ds_read_b128 v[92:95], v6 offset:2048
    ds_read_b128 v[96:99], v7 offset:2048
    v_mfma_f32_16x16x32_bf16 v[164:167], v[72:75], v[32:35], v[164:167]
    ds_read_b128 v[100:103], v8 offset:0
    ds_read_b128 v[104:107], v9 offset:0
    v_mfma_f32_16x16x32_bf16 v[168:171], v[80:83], v[32:35], v[168:171]
    ds_read_b128 v[108:111], v8 offset:2048
    ds_read_b128 v[112:115], v9 offset:2048
    v_mfma_f32_16x16x32_bf16 v[168:171], v[76:79], v[28:31], v[168:171]
    s_lshl_b32 s44, s49, 7
    v_add_u32 v15, s44, v22
    s_waitcnt lgkmcnt(8)
    v_mfma_f32_16x16x32_bf16 v[156:159], v[52:55], v[36:39], v[156:159]
    ds_read_b128 v[44:47], v15
    v_mfma_f32_16x16x32_bf16 v[156:159], v[56:59], v[40:43], v[156:159]
    ds_read_b128 v[48:51], v15 offset:64
    v_mfma_f32_16x16x32_bf16 v[160:163], v[64:67], v[40:43], v[160:163]
    s_add_u32 s49, s49, 1
    v_mfma_f32_16x16x32_bf16 v[160:163], v[60:63], v[36:39], v[160:163]
    s_and_b32 s49, s49, 7
    v_mfma_f32_16x16x32_bf16 v[172:175], v[68:71], v[36:39], v[172:175]
    ds_read_b64_tr_b16 v[28:29], v2 offset:0
    v_mfma_f32_16x16x32_bf16 v[172:175], v[72:75], v[40:43], v[172:175]
    ds_read_b64_tr_b16 v[30:31], v2 offset:1024
    v_mfma_f32_16x16x32_bf16 v[176:179], v[80:83], v[40:43], v[176:179]
    ds_read_b64_tr_b16 v[32:33], v2 offset:8192
    v_mfma_f32_16x16x32_bf16 v[176:179], v[76:79], v[36:39], v[176:179]
    ds_read_b64_tr_b16 v[34:35], v2 offset:9216
    s_waitcnt lgkmcnt(4)
    v_mfma_f32_16x16x32_bf16 v[180:183], v[84:87], v[44:47], v[180:183]
    ds_read_b64_tr_b16 v[36:37], v2 offset:16384
    v_mfma_f32_16x16x32_bf16 v[180:183], v[88:91], v[48:51], v[180:183]
    ds_read_b64_tr_b16 v[38:39], v2 offset:17408
    v_mfma_f32_16x16x32_bf16 v[184:187], v[92:95], v[44:47], v[184:187]
    ds_read_b64_tr_b16 v[40:41], v2 offset:24576
    v_mfma_f32_16x16x32_bf16 v[184:187], v[96:99], v[48:51], v[184:187]
    ds_read_b64_tr_b16 v[42:43], v2 offset:25600
    s_waitcnt lgkmcnt(4)
    v_mfma_f32_16x16x32_bf16 v[116:119], v[84:87], v[28:31], v[116:119]
    ds_read_b64_tr_b16 v[44:45], v3 offset:0
    v_mfma_f32_16x16x32_bf16 v[116:119], v[88:91], v[32:35], v[116:119]
    ds_read_b64_tr_b16 v[46:47], v3 offset:1024
    v_mfma_f32_16x16x32_bf16 v[120:123], v[96:99], v[32:35], v[120:123]
    ds_read_b64_tr_b16 v[48:49], v3 offset:8192
    v_mfma_f32_16x16x32_bf16 v[120:123], v[92:95], v[28:31], v[120:123]
    ds_read_b64_tr_b16 v[50:51], v3 offset:9216
    v_mfma_f32_16x16x32_bf16 v[132:135], v[100:103], v[28:31], v[132:135]
    v_mfma_f32_16x16x32_bf16 v[132:135], v[104:107], v[32:35], v[132:135]
    v_mfma_f32_16x16x32_bf16 v[136:139], v[112:115], v[32:35], v[136:139]
    v_mfma_f32_16x16x32_bf16 v[136:139], v[108:111], v[28:31], v[136:139]
    s_waitcnt lgkmcnt(4)
    v_mfma_f32_16x16x32_bf16 v[124:127], v[84:87], v[36:39], v[124:127]
    ds_read_b64_tr_b16 v[28:29], v3 offset:16384
    v_mfma_f32_16x16x32_bf16 v[124:127], v[88:91], v[40:43], v[124:127]
    ds_read_b64_tr_b16 v[30:31], v3 offset:17408
    v_mfma_f32_16x16x32_bf16 v[128:131], v[96:99], v[40:43], v[128:131]
    ds_read_b64_tr_b16 v[32:33], v3 offset:24576
    v_mfma_f32_16x16x32_bf16 v[128:131], v[92:95], v[36:39], v[128:131]
    ds_read_b64_tr_b16 v[34:35], v3 offset:25600
    v_mfma_f32_16x16x32_bf16 v[140:143], v[100:103], v[36:39], v[140:143]
    v_mfma_f32_16x16x32_bf16 v[140:143], v[104:107], v[40:43], v[140:143]
    v_mfma_f32_16x16x32_bf16 v[144:147], v[112:115], v[40:43], v[144:147]
    v_mfma_f32_16x16x32_bf16 v[144:147], v[108:111], v[36:39], v[144:147]
    s_waitcnt lgkmcnt(4)
    v_mfma_f32_16x16x32_bf16 v[148:151], v[84:87], v[44:47], v[148:151]
    v_mfma_f32_16x16x32_bf16 v[148:151], v[88:91], v[48:51], v[148:151]
    v_mfma_f32_16x16x32_bf16 v[152:155], v[96:99], v[48:51], v[152:155]
    v_mfma_f32_16x16x32_bf16 v[152:155], v[92:95], v[44:47], v[152:155]
    s_waitcnt lgkmcnt(0)
    s_barrier
    v_mfma_f32_16x16x32_bf16 v[164:167], v[100:103], v[44:47], v[164:167]
    v_mfma_f32_16x16x32_bf16 v[164:167], v[104:107], v[48:51], v[164:167]
    v_mfma_f32_16x16x32_bf16 v[168:171], v[112:115], v[48:51], v[168:171]
    v_mfma_f32_16x16x32_bf16 v[168:171], v[108:111], v[44:47], v[168:171]
    s_waitcnt lgkmcnt(0)
    v_mfma_f32_16x16x32_bf16 v[156:159], v[84:87], v[28:31], v[156:159]
    v_mfma_f32_16x16x32_bf16 v[156:159], v[88:91], v[32:35], v[156:159]
    v_mfma_f32_16x16x32_bf16 v[160:163], v[96:99], v[32:35], v[160:163]
    v_mfma_f32_16x16x32_bf16 v[160:163], v[92:95], v[28:31], v[160:163]
    v_mfma_f32_16x16x32_bf16 v[172:175], v[100:103], v[28:31], v[172:175]
    v_mfma_f32_16x16x32_bf16 v[172:175], v[104:107], v[32:35], v[172:175]
    v_mfma_f32_16x16x32_bf16 v[176:179], v[112:115], v[32:35], v[176:179]
    v_mfma_f32_16x16x32_bf16 v[176:179], v[108:111], v[28:31], v[176:179]
    s_nop 7
    v_lshlrev_b32 v21, 4, v1
    s_lshl_b32 s43, s45, 10
    s_add_u32 s43, s43, 49152
    v_add_u32 v20, s43, v21
    s_lshl_b32 s43, s41, 13
    v_add_u32 v2, s43, v20
    v_xor_b32 v3, 0x800, v2
    s_lshl_b32 s43, s45, 12
    s_add_u32 s43, s43, 49152
    v_add_u32 v21, s43, v21
    v_cvt_pk_bf16_f32 v88, v180, v181
    v_cvt_pk_bf16_f32 v89, v182, v183
    v_cvt_pk_bf16_f32 v90, v184, v185
    v_cvt_pk_bf16_f32 v91, v186, v187
    s_add_u32 s36, s78, 0x7a0000
    s_addc_u32 s37, s79, 0
    s_mov_b32 s38, 0x2000
    s_mov_b32 s39, 0x20000
    v_mfma_f32_16x16x32_bf16 v[188:191], v[212:215], v[88:91], 0
    v_mfma_f32_16x16x32_bf16 v[196:199], v[220:223], v[88:91], 0
    v_mfma_f32_16x16x32_bf16 v[192:195], v[216:219], v[88:91], 0
    v_mfma_f32_16x16x32_bf16 v[200:203], v[224:227], v[88:91], 0
    v_lshlrev_b32 v180, 16, v88
    v_and_b32 v181, 0xffff0000, v88
    v_lshlrev_b32 v182, 16, v89
    v_and_b32 v183, 0xffff0000, v89
    v_lshlrev_b32 v184, 16, v90
    v_and_b32 v185, 0xffff0000, v90
    v_lshlrev_b32 v186, 16, v91
    v_and_b32 v187, 0xffff0000, v91
    v_mul_f32 v180, 0xbfb8aa3b, v180
    v_mul_f32 v181, 0xbfb8aa3b, v181
    v_mul_f32 v182, 0xbfb8aa3b, v182
    v_mul_f32 v183, 0xbfb8aa3b, v183
    v_mul_f32 v184, 0xbfb8aa3b, v184
    v_mul_f32 v185, 0xbfb8aa3b, v185
    v_mul_f32 v186, 0xbfb8aa3b, v186
    v_mul_f32 v187, 0xbfb8aa3b, v187
    v_exp_f32 v180, v180
    v_exp_f32 v181, v181
    v_exp_f32 v182, v182
    v_exp_f32 v183, v183
    v_exp_f32 v184, v184
    v_exp_f32 v185, v185
    v_exp_f32 v186, v186
    v_exp_f32 v187, v187
    v_add_f32 v180, 1.0, v180
    v_add_f32 v181, 1.0, v181
    v_add_f32 v182, 1.0, v182
    v_add_f32 v183, 1.0, v183
    v_add_f32 v184, 1.0, v184
    v_add_f32 v185, 1.0, v185
    v_add_f32 v186, 1.0, v186
    v_add_f32 v187, 1.0, v187
    v_rcp_f32 v180, v180
    v_rcp_f32 v181, v181
    v_rcp_f32 v182, v182
    v_rcp_f32 v183, v183
    v_rcp_f32 v184, v184
    v_rcp_f32 v185, v185
    v_rcp_f32 v186, v186
    v_rcp_f32 v187, v187
    v_cvt_pk_bf16_f32 v188, v188, v196
    v_cvt_pk_bf16_f32 v189, v189, v197
    v_cvt_pk_bf16_f32 v190, v190, v198
    v_cvt_pk_bf16_f32 v191, v191, v199
    v_cvt_pk_bf16_f32 v192, v192, v200
    v_cvt_pk_bf16_f32 v193, v193, v201
    v_cvt_pk_bf16_f32 v194, v194, v202
    v_cvt_pk_bf16_f32 v195, v195, v203
    ds_write_b128 v20, v[188:191] offset:32768
    ds_write_b128 v20, v[192:195] offset:36864
    v_cvt_pk_bf16_f32 v88, v180, v181
    v_cvt_pk_bf16_f32 v89, v182, v183
    v_cvt_pk_bf16_f32 v90, v184, v185
    v_cvt_pk_bf16_f32 v91, v186, v187
    v_lshlrev_b32 v180, 16, v88
    v_and_b32 v181, 0xffff0000, v88
    v_lshlrev_b32 v182, 16, v89
    v_and_b32 v183, 0xffff0000, v89
    v_lshlrev_b32 v184, 16, v90
    v_and_b32 v185, 0xffff0000, v90
    v_lshlrev_b32 v186, 16, v91
    v_and_b32 v187, 0xffff0000, v91
    s_lshl_b32 s43, s23, 7
    s_mov_b32 exec_lo, 0x00010001
    s_mov_b32 exec_hi, 0x00010001
    buffer_store_dwordx4 v[180:183], v1, s[36:39], s43 offen sc1
    buffer_store_dwordx4 v[184:187], v1, s[36:39], s43 offen offset:64 sc1
    s_mov_b64 exec, -1
    v_cvt_pk_bf16_f32 v100, v116, v117
    v_cvt_pk_bf16_f32 v101, v118, v119
    v_cvt_pk_bf16_f32 v102, v120, v121
    v_cvt_pk_bf16_f32 v103, v122, v123
    v_cvt_pk_bf16_f32 v104, v124, v125
    v_cvt_pk_bf16_f32 v105, v126, v127
    v_cvt_pk_bf16_f32 v106, v128, v129
    v_cvt_pk_bf16_f32 v107, v130, v131
    v_cvt_pk_bf16_f32 v108, -v124, -v125
    v_cvt_pk_bf16_f32 v109, -v126, -v127
    v_cvt_pk_bf16_f32 v110, -v128, -v129
    v_cvt_pk_bf16_f32 v111, -v130, -v131
    v_mfma_f32_16x16x32_bf16 v[116:119], v[212:215], v[100:103], 0
    v_cvt_pk_bf16_f32 v88, v132, v133
    v_cvt_pk_bf16_f32 v89, v134, v135
    v_mfma_f32_16x16x32_bf16 v[116:119], v[220:223], v[104:107], v[116:119]
    v_cvt_pk_bf16_f32 v90, v136, v137
    v_cvt_pk_bf16_f32 v91, v138, v139
    v_mfma_f32_16x16x32_bf16 v[120:123], v[216:219], v[100:103], 0
    v_cvt_pk_bf16_f32 v92, v140, v141
    v_cvt_pk_bf16_f32 v93, v142, v143
    v_mfma_f32_16x16x32_bf16 v[120:123], v[224:227], v[104:107], v[120:123]
    v_cvt_pk_bf16_f32 v94, v144, v145
    v_cvt_pk_bf16_f32 v95, v146, v147
    v_mfma_f32_16x16x32_bf16 v[124:127], v[220:223], v[100:103], 0
    v_cvt_pk_bf16_f32 v96, -v140, -v141
    v_mfma_f32_16x16x32_bf16 v[124:127], v[212:215], v[108:111], v[124:127]
    v_cvt_pk_bf16_f32 v97, -v142, -v143
    v_mfma_f32_16x16x32_bf16 v[128:131], v[224:227], v[100:103], 0
    v_cvt_pk_bf16_f32 v98, -v144, -v145
    v_mfma_f32_16x16x32_bf16 v[128:131], v[216:219], v[108:111], v[128:131]
    v_cvt_pk_bf16_f32 v99, -v146, -v147
    v_mfma_f32_16x16x32_bf16 v[132:135], v[212:215], v[88:91], 0
    v_cvt_pk_bf16_f32 v100, v148, v149
    v_cvt_pk_bf16_f32 v101, v150, v151
    v_cvt_pk_bf16_f32 v102, v152, v153
    v_mfma_f32_16x16x32_bf16 v[132:135], v[220:223], v[92:95], v[132:135]
    v_cvt_pk_bf16_f32 v103, v154, v155
    v_cvt_pk_bf16_f32 v104, v156, v157
    v_cvt_pk_bf16_f32 v105, v158, v159
    v_mfma_f32_16x16x32_bf16 v[136:139], v[216:219], v[88:91], 0
    v_cvt_pk_bf16_f32 v106, v160, v161
    v_cvt_pk_bf16_f32 v107, v162, v163
    v_cvt_pk_bf16_f32 v108, -v156, -v157
    v_mfma_f32_16x16x32_bf16 v[136:139], v[224:227], v[92:95], v[136:139]
    v_cvt_pk_bf16_f32 v109, -v158, -v159
    v_cvt_pk_bf16_f32 v110, -v160, -v161
    v_cvt_pk_bf16_f32 v111, -v162, -v163
    v_mfma_f32_16x16x32_bf16 v[140:143], v[220:223], v[88:91], 0
    v_cvt_pk_bf16_f32 v116, v116, v124
    v_cvt_pk_bf16_f32 v117, v117, v125
    v_cvt_pk_bf16_f32 v118, v118, v126
    v_mfma_f32_16x16x32_bf16 v[140:143], v[212:215], v[96:99], v[140:143]
    v_cvt_pk_bf16_f32 v119, v119, v127
    v_cvt_pk_bf16_f32 v120, v120, v128
    v_cvt_pk_bf16_f32 v121, v121, v129
    v_mfma_f32_16x16x32_bf16 v[144:147], v[224:227], v[88:91], 0
    v_cvt_pk_bf16_f32 v122, v122, v130
    v_cvt_pk_bf16_f32 v123, v123, v131
    v_mfma_f32_16x16x32_bf16 v[144:147], v[216:219], v[96:99], v[144:147]
    ds_write_b128 v2, v[116:119] offset:0
    ds_write_b128 v2, v[120:123] offset:4096
    v_mfma_f32_16x16x32_bf16 v[148:151], v[212:215], v[100:103], 0
    v_cvt_pk_bf16_f32 v88, v164, v165
    v_cvt_pk_bf16_f32 v89, v166, v167
    v_cvt_pk_bf16_f32 v90, v168, v169
    v_mfma_f32_16x16x32_bf16 v[148:151], v[220:223], v[104:107], v[148:151]
    v_cvt_pk_bf16_f32 v91, v170, v171
    v_cvt_pk_bf16_f32 v92, v172, v173
    v_cvt_pk_bf16_f32 v93, v174, v175
    v_mfma_f32_16x16x32_bf16 v[152:155], v[216:219], v[100:103], 0
    v_cvt_pk_bf16_f32 v94, v176, v177
    v_cvt_pk_bf16_f32 v95, v178, v179
    v_cvt_pk_bf16_f32 v96, -v172, -v173
    v_mfma_f32_16x16x32_bf16 v[152:155], v[224:227], v[104:107], v[152:155]
    v_cvt_pk_bf16_f32 v97, -v174, -v175
    v_cvt_pk_bf16_f32 v98, -v176, -v177
    v_cvt_pk_bf16_f32 v99, -v178, -v179
    v_mfma_f32_16x16x32_bf16 v[156:159], v[220:223], v[100:103], 0
    v_cvt_pk_bf16_f32 v132, v132, v140
    v_cvt_pk_bf16_f32 v133, v133, v141
    v_cvt_pk_bf16_f32 v134, v134, v142
    v_mfma_f32_16x16x32_bf16 v[156:159], v[212:215], v[108:111], v[156:159]
    v_cvt_pk_bf16_f32 v135, v135, v143
    v_cvt_pk_bf16_f32 v136, v136, v144
    v_cvt_pk_bf16_f32 v137, v137, v145
    v_mfma_f32_16x16x32_bf16 v[160:163], v[224:227], v[100:103], 0
    v_cvt_pk_bf16_f32 v138, v138, v146
    v_cvt_pk_bf16_f32 v139, v139, v147
    v_mfma_f32_16x16x32_bf16 v[160:163], v[216:219], v[108:111], v[160:163]
    ds_write_b128 v3, v[132:135] offset:0
    ds_write_b128 v3, v[136:139] offset:4096
    v_mfma_f32_16x16x32_bf16 v[164:167], v[212:215], v[88:91], 0
    s_nop 3
    s_nop 3
    v_mfma_f32_16x16x32_bf16 v[164:167], v[220:223], v[92:95], v[164:167]
    s_nop 3
    v_cvt_pk_bf16_f32 v148, v148, v156
    v_mfma_f32_16x16x32_bf16 v[168:171], v[216:219], v[88:91], 0
    v_cvt_pk_bf16_f32 v149, v149, v157
    v_cvt_pk_bf16_f32 v150, v150, v158
    v_mfma_f32_16x16x32_bf16 v[168:171], v[224:227], v[92:95], v[168:171]
    v_cvt_pk_bf16_f32 v151, v151, v159
    v_cvt_pk_bf16_f32 v152, v152, v160
    v_mfma_f32_16x16x32_bf16 v[172:175], v[220:223], v[88:91], 0
    v_cvt_pk_bf16_f32 v153, v153, v161
    v_cvt_pk_bf16_f32 v154, v154, v162
    v_mfma_f32_16x16x32_bf16 v[172:175], v[212:215], v[96:99], v[172:175]
    v_cvt_pk_bf16_f32 v155, v155, v163
    v_mfma_f32_16x16x32_bf16 v[176:179], v[224:227], v[88:91], 0
    ds_write_b128 v2, v[148:151] offset:8192
    v_mfma_f32_16x16x32_bf16 v[176:179], v[216:219], v[96:99], v[176:179]
    ds_write_b128 v2, v[152:155] offset:12288
    s_nop 7
    v_cvt_pk_bf16_f32 v164, v164, v172
    v_cvt_pk_bf16_f32 v165, v165, v173
    v_cvt_pk_bf16_f32 v166, v166, v174
    v_cvt_pk_bf16_f32 v167, v167, v175
    v_cvt_pk_bf16_f32 v168, v168, v176
    v_cvt_pk_bf16_f32 v169, v169, v177
    v_cvt_pk_bf16_f32 v170, v170, v178
    v_cvt_pk_bf16_f32 v171, v171, v179
    ds_write_b128 v3, v[164:167] offset:8192
    ds_write_b128 v3, v[168:171] offset:12288
    s_waitcnt lgkmcnt(0)
    s_barrier
    ds_read_b128 v[28:31], v21 offset:0
    ds_read_b128 v[32:35], v21 offset:1024
    ds_read_b128 v[36:39], v21 offset:2048
    ds_read_b128 v[40:43], v21 offset:3072
    ds_read_b128 v[44:47], v21 offset:16384
    ds_read_b128 v[48:51], v21 offset:17408
    ds_read_b128 v[52:55], v21 offset:18432
    ds_read_b128 v[56:59], v21 offset:19456
    ds_read_b128 v[60:63], v21 offset:32768
    ds_read_b128 v[64:67], v21 offset:33792
    ds_read_b128 v[68:71], v21 offset:34816
    ds_read_b128 v[72:75], v21 offset:35840
    s_waitcnt lgkmcnt(8)
    v_swap_b32 v29, v32
    v_swap_b32 v30, v36
    v_swap_b32 v31, v40
    v_swap_b32 v34, v37
    v_swap_b32 v35, v41
    v_swap_b32 v39, v42
    s_add_u32 s43, s42, 0
    buffer_store_dwordx4 v[28:31], v14, s[32:35], s43 offen offset:0 sc1
    s_add_u32 s43, s42, 67712
    buffer_store_dwordx4 v[32:35], v14, s[32:35], s43 offen offset:0 sc1
    s_add_u32 s43, s42, 135424
    buffer_store_dwordx4 v[36:39], v14, s[32:35], s43 offen offset:0 sc1
    s_add_u32 s43, s42, 203136
    buffer_store_dwordx4 v[40:43], v14, s[32:35], s43 offen offset:0 sc1
    s_waitcnt lgkmcnt(4)
    v_swap_b32 v45, v48
    v_swap_b32 v46, v52
    v_swap_b32 v47, v56
    v_swap_b32 v50, v53
    v_swap_b32 v51, v57
    v_swap_b32 v55, v58
    s_add_u32 s43, s42, 0
    buffer_store_dwordx4 v[44:47], v14, s[32:35], s43 offen offset:512 sc1
    s_add_u32 s43, s42, 67712
    buffer_store_dwordx4 v[48:51], v14, s[32:35], s43 offen offset:512 sc1
    s_add_u32 s43, s42, 135424
    buffer_store_dwordx4 v[52:55], v14, s[32:35], s43 offen offset:512 sc1
    s_add_u32 s43, s42, 203136
    buffer_store_dwordx4 v[56:59], v14, s[32:35], s43 offen offset:512 sc1
    s_waitcnt lgkmcnt(0)
    v_swap_b32 v61, v64
    v_swap_b32 v62, v68
    v_swap_b32 v63, v72
    v_swap_b32 v66, v69
    v_swap_b32 v67, v73
    v_swap_b32 v71, v74
    s_cmp_ge_u32 s45, 2
    s_cbranch_scc1 L1C_no256
    s_mov_b32 exec_lo, 0x00020002
    s_mov_b32 exec_hi, 0x00020002
    s_add_u32 s43, s42, 0
    buffer_store_dwordx4 v[60:63], v14, s[32:35], s43 offen offset:1008 sc1
    s_add_u32 s43, s42, 67712
    buffer_store_dwordx4 v[64:67], v14, s[32:35], s43 offen offset:1008 sc1
    s_add_u32 s43, s42, 135424
    buffer_store_dwordx4 v[68:71], v14, s[32:35], s43 offen offset:1008 sc1
    s_add_u32 s43, s42, 203136
    buffer_store_dwordx4 v[72:75], v14, s[32:35], s43 offen offset:1008 sc1
    s_mov_b64 exec, -1
L1C_no256:
    s_branch L2C
L1C_ffn6:
    s_mul_i32 s41, s41, 3
    s_add_u32 s42, s41, 0
    s_lshl_b32 s42, s42, 5
    v_xor_b32 v2, s42, v10
    s_add_u32 s42, s41, 1
    s_lshl_b32 s42, s42, 5
    v_xor_b32 v3, s42, v10
    s_add_u32 s42, s41, 2
    s_lshl_b32 s42, s42, 5
    v_xor_b32 v4, s42, v10
    v_mov_b32 v24, 0xc0135761
    v_mov_b32 v26, 0xbdd2d3e8
    v_mov_b32 v25, 0xc0135761
    v_mov_b32 v27, 0xbdd2d3e8
    v_lshlrev_b32 v14, 4, v1
    s_mov_b32 s32, s78
    s_mov_b32 s33, s79
    s_mov_b32 s34, 0x570000
    s_mov_b32 s35, 0x20000
    s_lshl3_add_u32 s44, s22, s41
    s_mul_i32 s42, s23, 87
    s_add_u32 s42, s42, s44
    s_lshl_b32 s42, s42, 10
    s_xor_b32 s43, s23, 32
    s_mul_i32 s43, s43, 87
    s_add_u32 s43, s43, s44
    s_lshl_b32 s43, s43, 10
    s_barrier
    ds_read_b128 v[52:55], v6 offset:0
    ds_read_b128 v[56:59], v7 offset:0
    ds_read_b128 v[60:63], v6 offset:2048
    ds_read_b128 v[64:67], v7 offset:2048
    ds_read_b128 v[68:71], v8 offset:0
    ds_read_b128 v[72:75], v9 offset:0
    ds_read_b128 v[76:79], v8 offset:2048
    ds_read_b128 v[80:83], v9 offset:2048
    ds_read_b64_tr_b16 v[28:29], v2 offset:0
    ds_read_b64_tr_b16 v[30:31], v2 offset:1024
    ds_read_b64_tr_b16 v[32:33], v2 offset:16384
    ds_read_b64_tr_b16 v[34:35], v2 offset:17408
    v_add_u32 v6, 49152, v6
    v_add_u32 v7, 49152, v7
    v_add_u32 v8, 49152, v8
    v_add_u32 v9, 49152, v9
    ds_read_b64_tr_b16 v[36:37], v3 offset:0
    ds_read_b64_tr_b16 v[38:39], v3 offset:1024
    ds_read_b64_tr_b16 v[40:41], v3 offset:16384
    s_waitcnt lgkmcnt(10)
    ds_read_b64_tr_b16 v[42:43], v3 offset:17408
    s_waitcnt lgkmcnt(4)
    v_mfma_f32_16x16x32_bf16 v[116:119], v[28:31], v[52:55], 0
    ds_read_b64_tr_b16 v[44:45], v4 offset:0
    v_mfma_f32_16x16x32_bf16 v[124:127], v[32:35], v[52:55], 0
    ds_read_b64_tr_b16 v[46:47], v4 offset:1024
    v_mfma_f32_16x16x32_bf16 v[120:123], v[28:31], v[60:63], 0
    ds_read_b64_tr_b16 v[48:49], v4 offset:16384
    v_mfma_f32_16x16x32_bf16 v[128:131], v[32:35], v[60:63], 0
    ds_read_b64_tr_b16 v[50:51], v4 offset:17408
    v_mfma_f32_16x16x32_bf16 v[132:135], v[28:31], v[68:71], 0
    v_mfma_f32_16x16x32_bf16 v[140:143], v[32:35], v[68:71], 0
    v_mfma_f32_16x16x32_bf16 v[136:139], v[28:31], v[76:79], 0
    v_mfma_f32_16x16x32_bf16 v[144:147], v[32:35], v[76:79], 0
    s_waitcnt lgkmcnt(4)
    v_mfma_f32_16x16x32_bf16 v[148:151], v[36:39], v[52:55], 0
    v_mfma_f32_16x16x32_bf16 v[156:159], v[40:43], v[52:55], 0
    v_mfma_f32_16x16x32_bf16 v[152:155], v[36:39], v[60:63], 0
    v_mfma_f32_16x16x32_bf16 v[160:163], v[40:43], v[60:63], 0
    s_waitcnt lgkmcnt(0)
    s_barrier
    ds_read_b64_tr_b16 v[28:29], v2 offset:8192
    ds_read_b64_tr_b16 v[30:31], v2 offset:9216
    v_mfma_f32_16x16x32_bf16 v[164:167], v[36:39], v[68:71], 0
    ds_read_b64_tr_b16 v[32:33], v2 offset:24576
    ds_read_b64_tr_b16 v[34:35], v2 offset:25600
    v_mfma_f32_16x16x32_bf16 v[172:175], v[40:43], v[68:71], 0
    v_add_u32 v2, 49152, v2
    v_mfma_f32_16x16x32_bf16 v[168:171], v[36:39], v[76:79], 0
    v_mfma_f32_16x16x32_bf16 v[176:179], v[40:43], v[76:79], 0
    s_waitcnt lgkmcnt(4)
    v_mfma_f32_16x16x32_bf16 v[180:183], v[44:47], v[52:55], 0
    ds_read_b64_tr_b16 v[36:37], v3 offset:8192
    v_mfma_f32_16x16x32_bf16 v[188:191], v[48:51], v[52:55], 0
    ds_read_b64_tr_b16 v[38:39], v3 offset:9216
    v_mfma_f32_16x16x32_bf16 v[184:187], v[44:47], v[60:63], 0
    ds_read_b64_tr_b16 v[40:41], v3 offset:24576
    v_mfma_f32_16x16x32_bf16 v[192:195], v[48:51], v[60:63], 0
    ds_read_b64_tr_b16 v[42:43], v3 offset:25600
    v_mfma_f32_16x16x32_bf16 v[196:199], v[44:47], v[68:71], 0
    v_add_u32 v3, 49152, v3
    v_mfma_f32_16x16x32_bf16 v[204:207], v[48:51], v[68:71], 0
    v_mfma_f32_16x16x32_bf16 v[200:203], v[44:47], v[76:79], 0
    v_mfma_f32_16x16x32_bf16 v[208:211], v[48:51], v[76:79], 0
    s_waitcnt lgkmcnt(4)
    v_mfma_f32_16x16x32_bf16 v[116:119], v[28:31], v[56:59], v[116:119]
    ds_read_b64_tr_b16 v[44:45], v4 offset:8192
    v_mfma_f32_16x16x32_bf16 v[124:127], v[32:35], v[56:59], v[124:127]
    ds_read_b64_tr_b16 v[46:47], v4 offset:9216
    v_mfma_f32_16x16x32_bf16 v[120:123], v[28:31], v[64:67], v[120:123]
    ds_read_b64_tr_b16 v[48:49], v4 offset:24576
    v_mfma_f32_16x16x32_bf16 v[128:131], v[32:35], v[64:67], v[128:131]
    ds_read_b64_tr_b16 v[50:51], v4 offset:25600
    v_mfma_f32_16x16x32_bf16 v[132:135], v[28:31], v[72:75], v[132:135]
    v_add_u32 v4, 49152, v4
    v_mfma_f32_16x16x32_bf16 v[140:143], v[32:35], v[72:75], v[140:143]
    v_mfma_f32_16x16x32_bf16 v[136:139], v[28:31], v[80:83], v[136:139]
    v_mfma_f32_16x16x32_bf16 v[144:147], v[32:35], v[80:83], v[144:147]
    s_waitcnt lgkmcnt(4)
    v_mfma_f32_16x16x32_bf16 v[148:151], v[36:39], v[56:59], v[148:151]
    v_mfma_f32_16x16x32_bf16 v[156:159], v[40:43], v[56:59], v[156:159]
    v_mfma_f32_16x16x32_bf16 v[152:155], v[36:39], v[64:67], v[152:155]
    v_mfma_f32_16x16x32_bf16 v[160:163], v[40:43], v[64:67], v[160:163]
    s_waitcnt lgkmcnt(0)
    s_barrier
    ds_read_b128 v[84:87], v6 offset:0
    ds_read_b128 v[88:91], v7 offset:0
    v_mfma_f32_16x16x32_bf16 v[164:167], v[36:39], v[72:75], v[164:167]
    ds_read_b128 v[92:95], v6 offset:2048
    ds_read_b128 v[96:99], v7 offset:2048
    v_mfma_f32_16x16x32_bf16 v[172:175], v[40:43], v[72:75], v[172:175]
    ds_read_b128 v[100:103], v8 offset:0
    ds_read_b128 v[104:107], v9 offset:0
    v_mfma_f32_16x16x32_bf16 v[168:171], v[36:39], v[80:83], v[168:171]
    ds_read_b128 v[108:111], v8 offset:2048
    ds_read_b128 v[112:115], v9 offset:2048
    v_mfma_f32_16x16x32_bf16 v[176:179], v[40:43], v[80:83], v[176:179]
    ds_read_b64_tr_b16 v[28:29], v2 offset:0
    ds_read_b64_tr_b16 v[30:31], v2 offset:1024
    s_waitcnt lgkmcnt(10)
    v_mfma_f32_16x16x32_bf16 v[180:183], v[44:47], v[56:59], v[180:183]
    ds_read_b64_tr_b16 v[32:33], v2 offset:8192
    ds_read_b64_tr_b16 v[34:35], v2 offset:9216
    v_mfma_f32_16x16x32_bf16 v[188:191], v[48:51], v[56:59], v[188:191]
    v_add_u32 v6, 49152, v6
    v_add_u32 v7, 49152, v7
    v_mfma_f32_16x16x32_bf16 v[184:187], v[44:47], v[64:67], v[184:187]
    v_add_u32 v8, 49152, v8
    v_add_u32 v9, 49152, v9
    v_mfma_f32_16x16x32_bf16 v[192:195], v[48:51], v[64:67], v[192:195]
    ds_read_b64_tr_b16 v[36:37], v2 offset:16384
    v_mfma_f32_16x16x32_bf16 v[196:199], v[44:47], v[72:75], v[196:199]
    ds_read_b64_tr_b16 v[38:39], v2 offset:17408
    v_mfma_f32_16x16x32_bf16 v[204:207], v[48:51], v[72:75], v[204:207]
    ds_read_b64_tr_b16 v[40:41], v2 offset:24576
    v_mfma_f32_16x16x32_bf16 v[200:203], v[44:47], v[80:83], v[200:203]
    s_waitcnt lgkmcnt(10)
    ds_read_b64_tr_b16 v[42:43], v2 offset:25600
    v_mfma_f32_16x16x32_bf16 v[208:211], v[48:51], v[80:83], v[208:211]
    v_add_u32 v2, 49152, v2
    s_waitcnt lgkmcnt(4)
    v_mfma_f32_16x16x32_bf16 v[116:119], v[28:31], v[84:87], v[116:119]
    ds_read_b64_tr_b16 v[44:45], v3 offset:0
    v_mfma_f32_16x16x32_bf16 v[116:119], v[32:35], v[88:91], v[116:119]
    ds_read_b64_tr_b16 v[46:47], v3 offset:1024
    v_mfma_f32_16x16x32_bf16 v[120:123], v[32:35], v[96:99], v[120:123]
    ds_read_b64_tr_b16 v[48:49], v3 offset:8192
    v_mfma_f32_16x16x32_bf16 v[120:123], v[28:31], v[92:95], v[120:123]
    ds_read_b64_tr_b16 v[50:51], v3 offset:9216
    v_mfma_f32_16x16x32_bf16 v[132:135], v[28:31], v[100:103], v[132:135]
    v_mfma_f32_16x16x32_bf16 v[132:135], v[32:35], v[104:107], v[132:135]
    v_mfma_f32_16x16x32_bf16 v[136:139], v[32:35], v[112:115], v[136:139]
    v_mfma_f32_16x16x32_bf16 v[136:139], v[28:31], v[108:111], v[136:139]
    s_waitcnt lgkmcnt(4)
    v_mfma_f32_16x16x32_bf16 v[124:127], v[36:39], v[84:87], v[124:127]
    ds_read_b64_tr_b16 v[28:29], v3 offset:16384
    v_mfma_f32_16x16x32_bf16 v[124:127], v[40:43], v[88:91], v[124:127]
    ds_read_b64_tr_b16 v[30:31], v3 offset:17408
    v_mfma_f32_16x16x32_bf16 v[128:131], v[40:43], v[96:99], v[128:131]
    ds_read_b64_tr_b16 v[32:33], v3 offset:24576
    v_mfma_f32_16x16x32_bf16 v[128:131], v[36:39], v[92:95], v[128:131]
    ds_read_b64_tr_b16 v[34:35], v3 offset:25600
    v_mfma_f32_16x16x32_bf16 v[140:143], v[36:39], v[100:103], v[140:143]
    v_add_u32 v3, 49152, v3
    v_mfma_f32_16x16x32_bf16 v[140:143], v[40:43], v[104:107], v[140:143]
    v_mfma_f32_16x16x32_bf16 v[144:147], v[40:43], v[112:115], v[144:147]
    v_mfma_f32_16x16x32_bf16 v[144:147], v[36:39], v[108:111], v[144:147]
    s_waitcnt lgkmcnt(4)
    v_mfma_f32_16x16x32_bf16 v[148:151], v[44:47], v[84:87], v[148:151]
    ds_read_b64_tr_b16 v[36:37], v4 offset:0
    v_mfma_f32_16x16x32_bf16 v[148:151], v[48:51], v[88:91], v[148:151]
    ds_read_b64_tr_b16 v[38:39], v4 offset:1024
    v_mfma_f32_16x16x32_bf16 v[152:155], v[48:51], v[96:99], v[152:155]
    ds_read_b64_tr_b16 v[40:41], v4 offset:8192
    v_mfma_f32_16x16x32_bf16 v[152:155], v[44:47], v[92:95], v[152:155]
    ds_read_b64_tr_b16 v[42:43], v4 offset:9216
    v_mfma_f32_16x16x32_bf16 v[164:167], v[44:47], v[100:103], v[164:167]
    v_mfma_f32_16x16x32_bf16 v[164:167], v[48:51], v[104:107], v[164:167]
    v_mfma_f32_16x16x32_bf16 v[168:171], v[48:51], v[112:115], v[168:171]
    v_mfma_f32_16x16x32_bf16 v[168:171], v[44:47], v[108:111], v[168:171]
    s_waitcnt lgkmcnt(4)
    v_mfma_f32_16x16x32_bf16 v[156:159], v[28:31], v[84:87], v[156:159]
    ds_read_b64_tr_b16 v[44:45], v4 offset:16384
    v_mfma_f32_16x16x32_bf16 v[156:159], v[32:35], v[88:91], v[156:159]
    ds_read_b64_tr_b16 v[46:47], v4 offset:17408
    v_mfma_f32_16x16x32_bf16 v[160:163], v[32:35], v[96:99], v[160:163]
    ds_read_b64_tr_b16 v[48:49], v4 offset:24576
    v_mfma_f32_16x16x32_bf16 v[160:163], v[28:31], v[92:95], v[160:163]
    ds_read_b64_tr_b16 v[50:51], v4 offset:25600
    v_mfma_f32_16x16x32_bf16 v[172:175], v[28:31], v[100:103], v[172:175]
    v_add_u32 v4, 49152, v4
    v_mfma_f32_16x16x32_bf16 v[172:175], v[32:35], v[104:107], v[172:175]
    v_mfma_f32_16x16x32_bf16 v[176:179], v[32:35], v[112:115], v[176:179]
    v_mfma_f32_16x16x32_bf16 v[176:179], v[28:31], v[108:111], v[176:179]
    s_waitcnt lgkmcnt(4)
    v_mfma_f32_16x16x32_bf16 v[180:183], v[36:39], v[84:87], v[180:183]
    v_mfma_f32_16x16x32_bf16 v[180:183], v[40:43], v[88:91], v[180:183]
    v_mfma_f32_16x16x32_bf16 v[184:187], v[40:43], v[96:99], v[184:187]
    v_mfma_f32_16x16x32_bf16 v[184:187], v[36:39], v[92:95], v[184:187]
    s_waitcnt lgkmcnt(0)
    s_barrier
    ds_read_b128 v[52:55], v6 offset:0
    ds_read_b128 v[56:59], v7 offset:0
    v_mfma_f32_16x16x32_bf16 v[196:199], v[36:39], v[100:103], v[196:199]
    ds_read_b128 v[60:63], v6 offset:2048
    ds_read_b128 v[64:67], v7 offset:2048
    v_mfma_f32_16x16x32_bf16 v[196:199], v[40:43], v[104:107], v[196:199]
    ds_read_b128 v[68:71], v8 offset:0
    ds_read_b128 v[72:75], v9 offset:0
    v_mfma_f32_16x16x32_bf16 v[200:203], v[40:43], v[112:115], v[200:203]
    ds_read_b128 v[76:79], v8 offset:2048
    ds_read_b128 v[80:83], v9 offset:2048
    v_mfma_f32_16x16x32_bf16 v[200:203], v[36:39], v[108:111], v[200:203]
    ds_read_b64_tr_b16 v[28:29], v2 offset:0
    ds_read_b64_tr_b16 v[30:31], v2 offset:1024
    s_waitcnt lgkmcnt(10)
    v_mfma_f32_16x16x32_bf16 v[188:191], v[44:47], v[84:87], v[188:191]
    ds_read_b64_tr_b16 v[32:33], v2 offset:8192
    ds_read_b64_tr_b16 v[34:35], v2 offset:9216
    v_mfma_f32_16x16x32_bf16 v[188:191], v[48:51], v[88:91], v[188:191]
    v_subrev_u32 v6, 98304, v6
    v_subrev_u32 v7, 98304, v7
    v_mfma_f32_16x16x32_bf16 v[192:195], v[48:51], v[96:99], v[192:195]
    v_subrev_u32 v8, 98304, v8
    v_subrev_u32 v9, 98304, v9
    v_mfma_f32_16x16x32_bf16 v[192:195], v[44:47], v[92:95], v[192:195]
    ds_read_b64_tr_b16 v[36:37], v2 offset:16384
    v_mfma_f32_16x16x32_bf16 v[204:207], v[44:47], v[100:103], v[204:207]
    ds_read_b64_tr_b16 v[38:39], v2 offset:17408
    v_mfma_f32_16x16x32_bf16 v[204:207], v[48:51], v[104:107], v[204:207]
    ds_read_b64_tr_b16 v[40:41], v2 offset:24576
    v_mfma_f32_16x16x32_bf16 v[208:211], v[48:51], v[112:115], v[208:211]
    s_waitcnt lgkmcnt(10)
    ds_read_b64_tr_b16 v[42:43], v2 offset:25600
    v_mfma_f32_16x16x32_bf16 v[208:211], v[44:47], v[108:111], v[208:211]
    v_subrev_u32 v2, 98304, v2
    s_waitcnt lgkmcnt(4)
    v_mfma_f32_16x16x32_bf16 v[116:119], v[28:31], v[52:55], v[116:119]
    ds_read_b64_tr_b16 v[44:45], v3 offset:0
    v_mfma_f32_16x16x32_bf16 v[116:119], v[32:35], v[56:59], v[116:119]
    ds_read_b64_tr_b16 v[46:47], v3 offset:1024
    v_mfma_f32_16x16x32_bf16 v[120:123], v[32:35], v[64:67], v[120:123]
    ds_read_b64_tr_b16 v[48:49], v3 offset:8192
    v_mfma_f32_16x16x32_bf16 v[120:123], v[28:31], v[60:63], v[120:123]
    ds_read_b64_tr_b16 v[50:51], v3 offset:9216
    v_mfma_f32_16x16x32_bf16 v[132:135], v[28:31], v[68:71], v[132:135]
    v_mfma_f32_16x16x32_bf16 v[132:135], v[32:35], v[72:75], v[132:135]
    v_mfma_f32_16x16x32_bf16 v[136:139], v[32:35], v[80:83], v[136:139]
    v_mfma_f32_16x16x32_bf16 v[136:139], v[28:31], v[76:79], v[136:139]
    s_waitcnt lgkmcnt(4)
    v_mfma_f32_16x16x32_bf16 v[124:127], v[36:39], v[52:55], v[124:127]
    ds_read_b64_tr_b16 v[28:29], v3 offset:16384
    v_mfma_f32_16x16x32_bf16 v[124:127], v[40:43], v[56:59], v[124:127]
    ds_read_b64_tr_b16 v[30:31], v3 offset:17408
    v_mfma_f32_16x16x32_bf16 v[128:131], v[40:43], v[64:67], v[128:131]
    ds_read_b64_tr_b16 v[32:33], v3 offset:24576
    v_mfma_f32_16x16x32_bf16 v[128:131], v[36:39], v[60:63], v[128:131]
    ds_read_b64_tr_b16 v[34:35], v3 offset:25600
    v_mfma_f32_16x16x32_bf16 v[140:143], v[36:39], v[68:71], v[140:143]
    v_subrev_u32 v3, 98304, v3
    v_mfma_f32_16x16x32_bf16 v[140:143], v[40:43], v[72:75], v[140:143]
    v_mfma_f32_16x16x32_bf16 v[144:147], v[40:43], v[80:83], v[144:147]
    v_mfma_f32_16x16x32_bf16 v[144:147], v[36:39], v[76:79], v[144:147]
    s_waitcnt lgkmcnt(4)
    v_mfma_f32_16x16x32_bf16 v[148:151], v[44:47], v[52:55], v[148:151]
    ds_read_b64_tr_b16 v[36:37], v4 offset:0
    v_mfma_f32_16x16x32_bf16 v[148:151], v[48:51], v[56:59], v[148:151]
    ds_read_b64_tr_b16 v[38:39], v4 offset:1024
    v_mfma_f32_16x16x32_bf16 v[152:155], v[48:51], v[64:67], v[152:155]
    ds_read_b64_tr_b16 v[40:41], v4 offset:8192
    v_mfma_f32_16x16x32_bf16 v[152:155], v[44:47], v[60:63], v[152:155]
    ds_read_b64_tr_b16 v[42:43], v4 offset:9216
    v_mfma_f32_16x16x32_bf16 v[164:167], v[44:47], v[68:71], v[164:167]
    v_mfma_f32_16x16x32_bf16 v[164:167], v[48:51], v[72:75], v[164:167]
    v_mfma_f32_16x16x32_bf16 v[168:171], v[48:51], v[80:83], v[168:171]
    v_mfma_f32_16x16x32_bf16 v[168:171], v[44:47], v[76:79], v[168:171]
    s_waitcnt lgkmcnt(4)
    v_mfma_f32_16x16x32_bf16 v[156:159], v[28:31], v[52:55], v[156:159]
    ds_read_b64_tr_b16 v[44:45], v4 offset:16384
    v_mfma_f32_16x16x32_bf16 v[156:159], v[32:35], v[56:59], v[156:159]
    ds_read_b64_tr_b16 v[46:47], v4 offset:17408
    v_mfma_f32_16x16x32_bf16 v[160:163], v[32:35], v[64:67], v[160:163]
    ds_read_b64_tr_b16 v[48:49], v4 offset:24576
    v_mfma_f32_16x16x32_bf16 v[160:163], v[28:31], v[60:63], v[160:163]
    ds_read_b64_tr_b16 v[50:51], v4 offset:25600
    v_mfma_f32_16x16x32_bf16 v[172:175], v[28:31], v[68:71], v[172:175]
    v_subrev_u32 v4, 98304, v4
    v_mfma_f32_16x16x32_bf16 v[172:175], v[32:35], v[72:75], v[172:175]
    v_mfma_f32_16x16x32_bf16 v[176:179], v[32:35], v[80:83], v[176:179]
    v_mfma_f32_16x16x32_bf16 v[176:179], v[28:31], v[76:79], v[176:179]
    s_waitcnt lgkmcnt(4)
    v_mfma_f32_16x16x32_bf16 v[180:183], v[36:39], v[52:55], v[180:183]
    v_mfma_f32_16x16x32_bf16 v[180:183], v[40:43], v[56:59], v[180:183]
    v_mfma_f32_16x16x32_bf16 v[184:187], v[40:43], v[64:67], v[184:187]
    v_mfma_f32_16x16x32_bf16 v[184:187], v[36:39], v[60:63], v[184:187]
    s_waitcnt lgkmcnt(0)
    s_barrier
    ds_read_b128 v[84:87], v6 offset:0
    ds_read_b128 v[88:91], v7 offset:0
    v_mfma_f32_16x16x32_bf16 v[196:199], v[36:39], v[68:71], v[196:199]
    ds_read_b128 v[92:95], v6 offset:2048
    ds_read_b128 v[96:99], v7 offset:2048
    v_mfma_f32_16x16x32_bf16 v[196:199], v[40:43], v[72:75], v[196:199]
    ds_read_b128 v[100:103], v8 offset:0
    ds_read_b128 v[104:107], v9 offset:0
    v_mfma_f32_16x16x32_bf16 v[200:203], v[40:43], v[80:83], v[200:203]
    ds_read_b128 v[108:111], v8 offset:2048
    ds_read_b128 v[112:115], v9 offset:2048
    v_mfma_f32_16x16x32_bf16 v[200:203], v[36:39], v[76:79], v[200:203]
    ds_read_b64_tr_b16 v[28:29], v2 offset:0
    ds_read_b64_tr_b16 v[30:31], v2 offset:1024
    s_waitcnt lgkmcnt(10)
    v_mfma_f32_16x16x32_bf16 v[188:191], v[44:47], v[52:55], v[188:191]
    ds_read_b64_tr_b16 v[32:33], v2 offset:8192
    ds_read_b64_tr_b16 v[34:35], v2 offset:9216
    v_mfma_f32_16x16x32_bf16 v[188:191], v[48:51], v[56:59], v[188:191]
    v_add_u32 v6, 49152, v6
    v_add_u32 v7, 49152, v7
    v_mfma_f32_16x16x32_bf16 v[192:195], v[48:51], v[64:67], v[192:195]
    v_add_u32 v8, 49152, v8
    v_add_u32 v9, 49152, v9
    v_mfma_f32_16x16x32_bf16 v[192:195], v[44:47], v[60:63], v[192:195]
    ds_read_b64_tr_b16 v[36:37], v2 offset:16384
    v_mfma_f32_16x16x32_bf16 v[204:207], v[44:47], v[68:71], v[204:207]
    ds_read_b64_tr_b16 v[38:39], v2 offset:17408
    v_mfma_f32_16x16x32_bf16 v[204:207], v[48:51], v[72:75], v[204:207]
    ds_read_b64_tr_b16 v[40:41], v2 offset:24576
    v_mfma_f32_16x16x32_bf16 v[208:211], v[48:51], v[80:83], v[208:211]
    s_waitcnt lgkmcnt(10)
    ds_read_b64_tr_b16 v[42:43], v2 offset:25600
    v_mfma_f32_16x16x32_bf16 v[208:211], v[44:47], v[76:79], v[208:211]
    v_add_u32 v2, 49152, v2
    s_waitcnt lgkmcnt(4)
    v_mfma_f32_16x16x32_bf16 v[116:119], v[28:31], v[84:87], v[116:119]
    ds_read_b64_tr_b16 v[44:45], v3 offset:0
    v_mfma_f32_16x16x32_bf16 v[116:119], v[32:35], v[88:91], v[116:119]
    ds_read_b64_tr_b16 v[46:47], v3 offset:1024
    v_mfma_f32_16x16x32_bf16 v[120:123], v[32:35], v[96:99], v[120:123]
    ds_read_b64_tr_b16 v[48:49], v3 offset:8192
    v_mfma_f32_16x16x32_bf16 v[120:123], v[28:31], v[92:95], v[120:123]
    ds_read_b64_tr_b16 v[50:51], v3 offset:9216
    v_mfma_f32_16x16x32_bf16 v[132:135], v[28:31], v[100:103], v[132:135]
    v_mfma_f32_16x16x32_bf16 v[132:135], v[32:35], v[104:107], v[132:135]
    v_mfma_f32_16x16x32_bf16 v[136:139], v[32:35], v[112:115], v[136:139]
    v_mfma_f32_16x16x32_bf16 v[136:139], v[28:31], v[108:111], v[136:139]
    s_waitcnt lgkmcnt(4)
    v_mfma_f32_16x16x32_bf16 v[124:127], v[36:39], v[84:87], v[124:127]
    ds_read_b64_tr_b16 v[28:29], v3 offset:16384
    v_mfma_f32_16x16x32_bf16 v[124:127], v[40:43], v[88:91], v[124:127]
    ds_read_b64_tr_b16 v[30:31], v3 offset:17408
    v_mfma_f32_16x16x32_bf16 v[128:131], v[40:43], v[96:99], v[128:131]
    ds_read_b64_tr_b16 v[32:33], v3 offset:24576
    v_mfma_f32_16x16x32_bf16 v[128:131], v[36:39], v[92:95], v[128:131]
    ds_read_b64_tr_b16 v[34:35], v3 offset:25600
    v_mfma_f32_16x16x32_bf16 v[140:143], v[36:39], v[100:103], v[140:143]
    v_add_u32 v3, 49152, v3
    v_mfma_f32_16x16x32_bf16 v[140:143], v[40:43], v[104:107], v[140:143]
    v_mfma_f32_16x16x32_bf16 v[144:147], v[40:43], v[112:115], v[144:147]
    v_mfma_f32_16x16x32_bf16 v[144:147], v[36:39], v[108:111], v[144:147]
    s_waitcnt lgkmcnt(4)
    v_mfma_f32_16x16x32_bf16 v[148:151], v[44:47], v[84:87], v[148:151]
    ds_read_b64_tr_b16 v[36:37], v4 offset:0
    v_mfma_f32_16x16x32_bf16 v[148:151], v[48:51], v[88:91], v[148:151]
    ds_read_b64_tr_b16 v[38:39], v4 offset:1024
    v_mfma_f32_16x16x32_bf16 v[152:155], v[48:51], v[96:99], v[152:155]
    ds_read_b64_tr_b16 v[40:41], v4 offset:8192
    v_mfma_f32_16x16x32_bf16 v[152:155], v[44:47], v[92:95], v[152:155]
    ds_read_b64_tr_b16 v[42:43], v4 offset:9216
    v_mfma_f32_16x16x32_bf16 v[164:167], v[44:47], v[100:103], v[164:167]
    v_mfma_f32_16x16x32_bf16 v[164:167], v[48:51], v[104:107], v[164:167]
    v_mfma_f32_16x16x32_bf16 v[168:171], v[48:51], v[112:115], v[168:171]
    v_mfma_f32_16x16x32_bf16 v[168:171], v[44:47], v[108:111], v[168:171]
    s_waitcnt lgkmcnt(4)
    v_mfma_f32_16x16x32_bf16 v[156:159], v[28:31], v[84:87], v[156:159]
    ds_read_b64_tr_b16 v[44:45], v4 offset:16384
    v_mfma_f32_16x16x32_bf16 v[156:159], v[32:35], v[88:91], v[156:159]
    ds_read_b64_tr_b16 v[46:47], v4 offset:17408
    v_mfma_f32_16x16x32_bf16 v[160:163], v[32:35], v[96:99], v[160:163]
    ds_read_b64_tr_b16 v[48:49], v4 offset:24576
    v_mfma_f32_16x16x32_bf16 v[160:163], v[28:31], v[92:95], v[160:163]
    ds_read_b64_tr_b16 v[50:51], v4 offset:25600
    v_mfma_f32_16x16x32_bf16 v[172:175], v[28:31], v[100:103], v[172:175]
    v_add_u32 v4, 49152, v4
    v_mfma_f32_16x16x32_bf16 v[172:175], v[32:35], v[104:107], v[172:175]
    v_mfma_f32_16x16x32_bf16 v[176:179], v[32:35], v[112:115], v[176:179]
    v_mfma_f32_16x16x32_bf16 v[176:179], v[28:31], v[108:111], v[176:179]
    s_waitcnt lgkmcnt(4)
    v_mfma_f32_16x16x32_bf16 v[180:183], v[36:39], v[84:87], v[180:183]
    v_mfma_f32_16x16x32_bf16 v[180:183], v[40:43], v[88:91], v[180:183]
    v_mfma_f32_16x16x32_bf16 v[184:187], v[40:43], v[96:99], v[184:187]
    v_mfma_f32_16x16x32_bf16 v[184:187], v[36:39], v[92:95], v[184:187]
    s_waitcnt lgkmcnt(0)
    s_barrier
    ds_read_b128 v[52:55], v6 offset:0
    ds_read_b128 v[56:59], v7 offset:0
    v_mfma_f32_16x16x32_bf16 v[196:199], v[36:39], v[100:103], v[196:199]
    ds_read_b128 v[60:63], v6 offset:2048
    ds_read_b128 v[64:67], v7 offset:2048
    v_mfma_f32_16x16x32_bf16 v[196:199], v[40:43], v[104:107], v[196:199]
    ds_read_b128 v[68:71], v8 offset:0
    ds_read_b128 v[72:75], v9 offset:0
    v_mfma_f32_16x16x32_bf16 v[200:203], v[40:43], v[112:115], v[200:203]
    ds_read_b128 v[76:79], v8 offset:2048
    ds_read_b128 v[80:83], v9 offset:2048
    v_mfma_f32_16x16x32_bf16 v[200:203], v[36:39], v[108:111], v[200:203]
    ds_read_b64_tr_b16 v[28:29], v2 offset:0
    ds_read_b64_tr_b16 v[30:31], v2 offset:1024
    s_waitcnt lgkmcnt(10)
    v_mfma_f32_16x16x32_bf16 v[188:191], v[44:47], v[84:87], v[188:191]
    ds_read_b64_tr_b16 v[32:33], v2 offset:8192
    ds_read_b64_tr_b16 v[34:35], v2 offset:9216
    v_mfma_f32_16x16x32_bf16 v[188:191], v[48:51], v[88:91], v[188:191]
    v_add_u32 v6, 49152, v6
    v_add_u32 v7, 49152, v7
    v_mfma_f32_16x16x32_bf16 v[192:195], v[48:51], v[96:99], v[192:195]
    v_add_u32 v8, 49152, v8
    v_add_u32 v9, 49152, v9
    v_mfma_f32_16x16x32_bf16 v[192:195], v[44:47], v[92:95], v[192:195]
    ds_read_b64_tr_b16 v[36:37], v2 offset:16384
    v_mfma_f32_16x16x32_bf16 v[204:207], v[44:47], v[100:103], v[204:207]
    ds_read_b64_tr_b16 v[38:39], v2 offset:17408
    v_mfma_f32_16x16x32_bf16 v[204:207], v[48:51], v[104:107], v[204:207]
    ds_read_b64_tr_b16 v[40:41], v2 offset:24576
    v_mfma_f32_16x16x32_bf16 v[208:211], v[48:51], v[112:115], v[208:211]
    s_waitcnt lgkmcnt(10)
    ds_read_b64_tr_b16 v[42:43], v2 offset:25600
    v_mfma_f32_16x16x32_bf16 v[208:211], v[44:47], v[108:111], v[208:211]
    v_add_u32 v2, 49152, v2
    s_waitcnt lgkmcnt(4)
    v_mfma_f32_16x16x32_bf16 v[116:119], v[28:31], v[52:55], v[116:119]
    ds_read_b64_tr_b16 v[44:45], v3 offset:0
    v_mfma_f32_16x16x32_bf16 v[116:119], v[32:35], v[56:59], v[116:119]
    ds_read_b64_tr_b16 v[46:47], v3 offset:1024
    v_mfma_f32_16x16x32_bf16 v[120:123], v[32:35], v[64:67], v[120:123]
    ds_read_b64_tr_b16 v[48:49], v3 offset:8192
    v_mfma_f32_16x16x32_bf16 v[120:123], v[28:31], v[60:63], v[120:123]
    ds_read_b64_tr_b16 v[50:51], v3 offset:9216
    v_mfma_f32_16x16x32_bf16 v[132:135], v[28:31], v[68:71], v[132:135]
    v_mfma_f32_16x16x32_bf16 v[132:135], v[32:35], v[72:75], v[132:135]
    v_mfma_f32_16x16x32_bf16 v[136:139], v[32:35], v[80:83], v[136:139]
    v_mfma_f32_16x16x32_bf16 v[136:139], v[28:31], v[76:79], v[136:139]
    s_waitcnt lgkmcnt(4)
    v_mfma_f32_16x16x32_bf16 v[124:127], v[36:39], v[52:55], v[124:127]
    ds_read_b64_tr_b16 v[28:29], v3 offset:16384
    v_mfma_f32_16x16x32_bf16 v[124:127], v[40:43], v[56:59], v[124:127]
    ds_read_b64_tr_b16 v[30:31], v3 offset:17408
    v_mfma_f32_16x16x32_bf16 v[128:131], v[40:43], v[64:67], v[128:131]
    ds_read_b64_tr_b16 v[32:33], v3 offset:24576
    v_mfma_f32_16x16x32_bf16 v[128:131], v[36:39], v[60:63], v[128:131]
    ds_read_b64_tr_b16 v[34:35], v3 offset:25600
    v_mfma_f32_16x16x32_bf16 v[140:143], v[36:39], v[68:71], v[140:143]
    v_add_u32 v3, 49152, v3
    v_mfma_f32_16x16x32_bf16 v[140:143], v[40:43], v[72:75], v[140:143]
    v_mfma_f32_16x16x32_bf16 v[144:147], v[40:43], v[80:83], v[144:147]
    v_mfma_f32_16x16x32_bf16 v[144:147], v[36:39], v[76:79], v[144:147]
    s_waitcnt lgkmcnt(4)
    v_mfma_f32_16x16x32_bf16 v[148:151], v[44:47], v[52:55], v[148:151]
    ds_read_b64_tr_b16 v[36:37], v4 offset:0
    v_mfma_f32_16x16x32_bf16 v[148:151], v[48:51], v[56:59], v[148:151]
    ds_read_b64_tr_b16 v[38:39], v4 offset:1024
    v_mfma_f32_16x16x32_bf16 v[152:155], v[48:51], v[64:67], v[152:155]
    ds_read_b64_tr_b16 v[40:41], v4 offset:8192
    v_mfma_f32_16x16x32_bf16 v[152:155], v[44:47], v[60:63], v[152:155]
    ds_read_b64_tr_b16 v[42:43], v4 offset:9216
    v_mfma_f32_16x16x32_bf16 v[164:167], v[44:47], v[68:71], v[164:167]
    v_mfma_f32_16x16x32_bf16 v[164:167], v[48:51], v[72:75], v[164:167]
    v_mfma_f32_16x16x32_bf16 v[168:171], v[48:51], v[80:83], v[168:171]
    v_mfma_f32_16x16x32_bf16 v[168:171], v[44:47], v[76:79], v[168:171]
    s_waitcnt lgkmcnt(4)
    v_mfma_f32_16x16x32_bf16 v[156:159], v[28:31], v[52:55], v[156:159]
    ds_read_b64_tr_b16 v[44:45], v4 offset:16384
    v_mfma_f32_16x16x32_bf16 v[156:159], v[32:35], v[56:59], v[156:159]
    ds_read_b64_tr_b16 v[46:47], v4 offset:17408
    v_mfma_f32_16x16x32_bf16 v[160:163], v[32:35], v[64:67], v[160:163]
    ds_read_b64_tr_b16 v[48:49], v4 offset:24576
    v_mfma_f32_16x16x32_bf16 v[160:163], v[28:31], v[60:63], v[160:163]
    ds_read_b64_tr_b16 v[50:51], v4 offset:25600
    v_mfma_f32_16x16x32_bf16 v[172:175], v[28:31], v[68:71], v[172:175]
    v_add_u32 v4, 49152, v4
    v_mfma_f32_16x16x32_bf16 v[172:175], v[32:35], v[72:75], v[172:175]
    v_mfma_f32_16x16x32_bf16 v[176:179], v[32:35], v[80:83], v[176:179]
    v_mfma_f32_16x16x32_bf16 v[176:179], v[28:31], v[76:79], v[176:179]
    s_waitcnt lgkmcnt(4)
    v_mfma_f32_16x16x32_bf16 v[180:183], v[36:39], v[52:55], v[180:183]
    v_mfma_f32_16x16x32_bf16 v[180:183], v[40:43], v[56:59], v[180:183]
    v_mfma_f32_16x16x32_bf16 v[184:187], v[40:43], v[64:67], v[184:187]
    v_mfma_f32_16x16x32_bf16 v[184:187], v[36:39], v[60:63], v[184:187]
    s_waitcnt lgkmcnt(0)
    s_barrier
    ds_read_b128 v[84:87], v6 offset:0
    ds_read_b128 v[88:91], v7 offset:0
    v_mfma_f32_16x16x32_bf16 v[196:199], v[36:39], v[68:71], v[196:199]
    ds_read_b128 v[92:95], v6 offset:2048
    ds_read_b128 v[96:99], v7 offset:2048
    v_mfma_f32_16x16x32_bf16 v[196:199], v[40:43], v[72:75], v[196:199]
    ds_read_b128 v[100:103], v8 offset:0
    ds_read_b128 v[104:107], v9 offset:0
    v_mfma_f32_16x16x32_bf16 v[200:203], v[40:43], v[80:83], v[200:203]
    ds_read_b128 v[108:111], v8 offset:2048
    ds_read_b128 v[112:115], v9 offset:2048
    v_mfma_f32_16x16x32_bf16 v[200:203], v[36:39], v[76:79], v[200:203]
    ds_read_b64_tr_b16 v[28:29], v2 offset:0
    ds_read_b64_tr_b16 v[30:31], v2 offset:1024
    s_waitcnt lgkmcnt(10)
    v_mfma_f32_16x16x32_bf16 v[188:191], v[44:47], v[52:55], v[188:191]
    ds_read_b64_tr_b16 v[32:33], v2 offset:8192
    ds_read_b64_tr_b16 v[34:35], v2 offset:9216
    v_mfma_f32_16x16x32_bf16 v[188:191], v[48:51], v[56:59], v[188:191]
    v_subrev_u32 v6, 98304, v6
    v_subrev_u32 v7, 98304, v7
    v_mfma_f32_16x16x32_bf16 v[192:195], v[48:51], v[64:67], v[192:195]
    v_subrev_u32 v8, 98304, v8
    v_subrev_u32 v9, 98304, v9
    v_mfma_f32_16x16x32_bf16 v[192:195], v[44:47], v[60:63], v[192:195]
    ds_read_b64_tr_b16 v[36:37], v2 offset:16384
    v_mfma_f32_16x16x32_bf16 v[204:207], v[44:47], v[68:71], v[204:207]
    ds_read_b64_tr_b16 v[38:39], v2 offset:17408
    v_mfma_f32_16x16x32_bf16 v[204:207], v[48:51], v[72:75], v[204:207]
    ds_read_b64_tr_b16 v[40:41], v2 offset:24576
    v_mfma_f32_16x16x32_bf16 v[208:211], v[48:51], v[80:83], v[208:211]
    s_waitcnt lgkmcnt(10)
    ds_read_b64_tr_b16 v[42:43], v2 offset:25600
    v_mfma_f32_16x16x32_bf16 v[208:211], v[44:47], v[76:79], v[208:211]
    v_subrev_u32 v2, 98304, v2
    s_waitcnt lgkmcnt(4)
    v_mfma_f32_16x16x32_bf16 v[116:119], v[28:31], v[84:87], v[116:119]
    ds_read_b64_tr_b16 v[44:45], v3 offset:0
    v_mfma_f32_16x16x32_bf16 v[116:119], v[32:35], v[88:91], v[116:119]
    ds_read_b64_tr_b16 v[46:47], v3 offset:1024
    v_mfma_f32_16x16x32_bf16 v[120:123], v[32:35], v[96:99], v[120:123]
    ds_read_b64_tr_b16 v[48:49], v3 offset:8192
    v_mfma_f32_16x16x32_bf16 v[120:123], v[28:31], v[92:95], v[120:123]
    ds_read_b64_tr_b16 v[50:51], v3 offset:9216
    v_mfma_f32_16x16x32_bf16 v[132:135], v[28:31], v[100:103], v[132:135]
    v_mfma_f32_16x16x32_bf16 v[132:135], v[32:35], v[104:107], v[132:135]
    v_mfma_f32_16x16x32_bf16 v[136:139], v[32:35], v[112:115], v[136:139]
    v_mfma_f32_16x16x32_bf16 v[136:139], v[28:31], v[108:111], v[136:139]
    s_waitcnt lgkmcnt(4)
    v_mfma_f32_16x16x32_bf16 v[124:127], v[36:39], v[84:87], v[124:127]
    ds_read_b64_tr_b16 v[28:29], v3 offset:16384
    v_mfma_f32_16x16x32_bf16 v[124:127], v[40:43], v[88:91], v[124:127]
    ds_read_b64_tr_b16 v[30:31], v3 offset:17408
    v_mfma_f32_16x16x32_bf16 v[128:131], v[40:43], v[96:99], v[128:131]
    ds_read_b64_tr_b16 v[32:33], v3 offset:24576
    v_mfma_f32_16x16x32_bf16 v[128:131], v[36:39], v[92:95], v[128:131]
    ds_read_b64_tr_b16 v[34:35], v3 offset:25600
    v_mfma_f32_16x16x32_bf16 v[140:143], v[36:39], v[100:103], v[140:143]
    v_subrev_u32 v3, 98304, v3
    v_mfma_f32_16x16x32_bf16 v[140:143], v[40:43], v[104:107], v[140:143]
    v_mfma_f32_16x16x32_bf16 v[144:147], v[40:43], v[112:115], v[144:147]
    v_mfma_f32_16x16x32_bf16 v[144:147], v[36:39], v[108:111], v[144:147]
    s_waitcnt lgkmcnt(4)
    v_mfma_f32_16x16x32_bf16 v[148:151], v[44:47], v[84:87], v[148:151]
    ds_read_b64_tr_b16 v[36:37], v4 offset:0
    v_mfma_f32_16x16x32_bf16 v[148:151], v[48:51], v[88:91], v[148:151]
    ds_read_b64_tr_b16 v[38:39], v4 offset:1024
    v_mfma_f32_16x16x32_bf16 v[152:155], v[48:51], v[96:99], v[152:155]
    ds_read_b64_tr_b16 v[40:41], v4 offset:8192
    v_mfma_f32_16x16x32_bf16 v[152:155], v[44:47], v[92:95], v[152:155]
    ds_read_b64_tr_b16 v[42:43], v4 offset:9216
    v_mfma_f32_16x16x32_bf16 v[164:167], v[44:47], v[100:103], v[164:167]
    v_mfma_f32_16x16x32_bf16 v[164:167], v[48:51], v[104:107], v[164:167]
    v_mfma_f32_16x16x32_bf16 v[168:171], v[48:51], v[112:115], v[168:171]
    v_mfma_f32_16x16x32_bf16 v[168:171], v[44:47], v[108:111], v[168:171]
    s_waitcnt lgkmcnt(4)
    v_mfma_f32_16x16x32_bf16 v[156:159], v[28:31], v[84:87], v[156:159]
    ds_read_b64_tr_b16 v[44:45], v4 offset:16384
    v_mfma_f32_16x16x32_bf16 v[156:159], v[32:35], v[88:91], v[156:159]
    ds_read_b64_tr_b16 v[46:47], v4 offset:17408
    v_mfma_f32_16x16x32_bf16 v[160:163], v[32:35], v[96:99], v[160:163]
    ds_read_b64_tr_b16 v[48:49], v4 offset:24576
    v_mfma_f32_16x16x32_bf16 v[160:163], v[28:31], v[92:95], v[160:163]
    ds_read_b64_tr_b16 v[50:51], v4 offset:25600
    v_mfma_f32_16x16x32_bf16 v[172:175], v[28:31], v[100:103], v[172:175]
    v_subrev_u32 v4, 98304, v4
    v_mfma_f32_16x16x32_bf16 v[172:175], v[32:35], v[104:107], v[172:175]
    v_mfma_f32_16x16x32_bf16 v[176:179], v[32:35], v[112:115], v[176:179]
    v_mfma_f32_16x16x32_bf16 v[176:179], v[28:31], v[108:111], v[176:179]
    s_waitcnt lgkmcnt(4)
    v_mfma_f32_16x16x32_bf16 v[180:183], v[36:39], v[84:87], v[180:183]
    v_mfma_f32_16x16x32_bf16 v[180:183], v[40:43], v[88:91], v[180:183]
    v_mfma_f32_16x16x32_bf16 v[184:187], v[40:43], v[96:99], v[184:187]
    v_mfma_f32_16x16x32_bf16 v[184:187], v[36:39], v[92:95], v[184:187]
    s_waitcnt lgkmcnt(0)
    s_barrier
    ds_read_b128 v[52:55], v6 offset:0
    ds_read_b128 v[56:59], v7 offset:0
    v_mfma_f32_16x16x32_bf16 v[196:199], v[36:39], v[100:103], v[196:199]
    ds_read_b128 v[60:63], v6 offset:2048
    ds_read_b128 v[64:67], v7 offset:2048
    v_mfma_f32_16x16x32_bf16 v[196:199], v[40:43], v[104:107], v[196:199]
    ds_read_b128 v[68:71], v8 offset:0
    ds_read_b128 v[72:75], v9 offset:0
    v_mfma_f32_16x16x32_bf16 v[200:203], v[40:43], v[112:115], v[200:203]
    ds_read_b128 v[76:79], v8 offset:2048
    ds_read_b128 v[80:83], v9 offset:2048
    v_mfma_f32_16x16x32_bf16 v[200:203], v[36:39], v[108:111], v[200:203]
    ds_read_b64_tr_b16 v[28:29], v2 offset:0
    ds_read_b64_tr_b16 v[30:31], v2 offset:1024
    s_waitcnt lgkmcnt(10)
    v_mfma_f32_16x16x32_bf16 v[188:191], v[44:47], v[84:87], v[188:191]
    ds_read_b64_tr_b16 v[32:33], v2 offset:8192
    ds_read_b64_tr_b16 v[34:35], v2 offset:9216
    v_mfma_f32_16x16x32_bf16 v[188:191], v[48:51], v[88:91], v[188:191]
    v_add_u32 v6, 49152, v6
    v_add_u32 v7, 49152, v7
    v_mfma_f32_16x16x32_bf16 v[192:195], v[48:51], v[96:99], v[192:195]
    v_add_u32 v8, 49152, v8
    v_add_u32 v9, 49152, v9
    v_mfma_f32_16x16x32_bf16 v[192:195], v[44:47], v[92:95], v[192:195]
    ds_read_b64_tr_b16 v[36:37], v2 offset:16384
    v_mfma_f32_16x16x32_bf16 v[204:207], v[44:47], v[100:103], v[204:207]
    ds_read_b64_tr_b16 v[38:39], v2 offset:17408
    v_mfma_f32_16x16x32_bf16 v[204:207], v[48:51], v[104:107], v[204:207]
    ds_read_b64_tr_b16 v[40:41], v2 offset:24576
    v_mfma_f32_16x16x32_bf16 v[208:211], v[48:51], v[112:115], v[208:211]
    s_waitcnt lgkmcnt(10)
    ds_read_b64_tr_b16 v[42:43], v2 offset:25600
    v_mfma_f32_16x16x32_bf16 v[208:211], v[44:47], v[108:111], v[208:211]
    v_add_u32 v2, 49152, v2
    s_waitcnt lgkmcnt(4)
    v_mfma_f32_16x16x32_bf16 v[116:119], v[28:31], v[52:55], v[116:119]
    ds_read_b64_tr_b16 v[44:45], v3 offset:0
    v_mfma_f32_16x16x32_bf16 v[116:119], v[32:35], v[56:59], v[116:119]
    ds_read_b64_tr_b16 v[46:47], v3 offset:1024
    v_mfma_f32_16x16x32_bf16 v[120:123], v[32:35], v[64:67], v[120:123]
    ds_read_b64_tr_b16 v[48:49], v3 offset:8192
    v_mfma_f32_16x16x32_bf16 v[120:123], v[28:31], v[60:63], v[120:123]
    ds_read_b64_tr_b16 v[50:51], v3 offset:9216
    v_mfma_f32_16x16x32_bf16 v[132:135], v[28:31], v[68:71], v[132:135]
    v_mfma_f32_16x16x32_bf16 v[132:135], v[32:35], v[72:75], v[132:135]
    v_mfma_f32_16x16x32_bf16 v[136:139], v[32:35], v[80:83], v[136:139]
    v_mfma_f32_16x16x32_bf16 v[136:139], v[28:31], v[76:79], v[136:139]
    s_waitcnt lgkmcnt(4)
    v_mfma_f32_16x16x32_bf16 v[124:127], v[36:39], v[52:55], v[124:127]
    ds_read_b64_tr_b16 v[28:29], v3 offset:16384
    v_mfma_f32_16x16x32_bf16 v[124:127], v[40:43], v[56:59], v[124:127]
    ds_read_b64_tr_b16 v[30:31], v3 offset:17408
    v_mfma_f32_16x16x32_bf16 v[128:131], v[40:43], v[64:67], v[128:131]
    ds_read_b64_tr_b16 v[32:33], v3 offset:24576
    v_mfma_f32_16x16x32_bf16 v[128:131], v[36:39], v[60:63], v[128:131]
    ds_read_b64_tr_b16 v[34:35], v3 offset:25600
    v_mfma_f32_16x16x32_bf16 v[140:143], v[36:39], v[68:71], v[140:143]
    v_add_u32 v3, 49152, v3
    v_mfma_f32_16x16x32_bf16 v[140:143], v[40:43], v[72:75], v[140:143]
    v_mfma_f32_16x16x32_bf16 v[144:147], v[40:43], v[80:83], v[144:147]
    v_mfma_f32_16x16x32_bf16 v[144:147], v[36:39], v[76:79], v[144:147]
    s_waitcnt lgkmcnt(4)
    v_mfma_f32_16x16x32_bf16 v[148:151], v[44:47], v[52:55], v[148:151]
    ds_read_b64_tr_b16 v[36:37], v4 offset:0
    v_mfma_f32_16x16x32_bf16 v[148:151], v[48:51], v[56:59], v[148:151]
    ds_read_b64_tr_b16 v[38:39], v4 offset:1024
    v_mfma_f32_16x16x32_bf16 v[152:155], v[48:51], v[64:67], v[152:155]
    ds_read_b64_tr_b16 v[40:41], v4 offset:8192
    v_mfma_f32_16x16x32_bf16 v[152:155], v[44:47], v[60:63], v[152:155]
    ds_read_b64_tr_b16 v[42:43], v4 offset:9216
    v_mfma_f32_16x16x32_bf16 v[164:167], v[44:47], v[68:71], v[164:167]
    v_mfma_f32_16x16x32_bf16 v[164:167], v[48:51], v[72:75], v[164:167]
    v_mfma_f32_16x16x32_bf16 v[168:171], v[48:51], v[80:83], v[168:171]
    v_mfma_f32_16x16x32_bf16 v[168:171], v[44:47], v[76:79], v[168:171]
    s_waitcnt lgkmcnt(4)
    v_mfma_f32_16x16x32_bf16 v[156:159], v[28:31], v[52:55], v[156:159]
    ds_read_b64_tr_b16 v[44:45], v4 offset:16384
    v_mfma_f32_16x16x32_bf16 v[156:159], v[32:35], v[56:59], v[156:159]
    ds_read_b64_tr_b16 v[46:47], v4 offset:17408
    v_mfma_f32_16x16x32_bf16 v[160:163], v[32:35], v[64:67], v[160:163]
    ds_read_b64_tr_b16 v[48:49], v4 offset:24576
    v_mfma_f32_16x16x32_bf16 v[160:163], v[28:31], v[60:63], v[160:163]
    ds_read_b64_tr_b16 v[50:51], v4 offset:25600
    v_mfma_f32_16x16x32_bf16 v[172:175], v[28:31], v[68:71], v[172:175]
    v_add_u32 v4, 49152, v4
    v_mfma_f32_16x16x32_bf16 v[172:175], v[32:35], v[72:75], v[172:175]
    v_mfma_f32_16x16x32_bf16 v[176:179], v[32:35], v[80:83], v[176:179]
    v_mfma_f32_16x16x32_bf16 v[176:179], v[28:31], v[76:79], v[176:179]
    s_waitcnt lgkmcnt(4)
    v_mfma_f32_16x16x32_bf16 v[180:183], v[36:39], v[52:55], v[180:183]
    v_mfma_f32_16x16x32_bf16 v[180:183], v[40:43], v[56:59], v[180:183]
    v_mfma_f32_16x16x32_bf16 v[184:187], v[40:43], v[64:67], v[184:187]
    v_mfma_f32_16x16x32_bf16 v[184:187], v[36:39], v[60:63], v[184:187]
    s_waitcnt lgkmcnt(0)
    s_barrier
    ds_read_b128 v[84:87], v6 offset:0
    ds_read_b128 v[88:91], v7 offset:0
    v_mfma_f32_16x16x32_bf16 v[196:199], v[36:39], v[68:71], v[196:199]
    ds_read_b128 v[92:95], v6 offset:2048
    ds_read_b128 v[96:99], v7 offset:2048
    v_mfma_f32_16x16x32_bf16 v[196:199], v[40:43], v[72:75], v[196:199]
    ds_read_b128 v[100:103], v8 offset:0
    ds_read_b128 v[104:107], v9 offset:0
    v_mfma_f32_16x16x32_bf16 v[200:203], v[40:43], v[80:83], v[200:203]
    ds_read_b128 v[108:111], v8 offset:2048
    ds_read_b128 v[112:115], v9 offset:2048
    v_mfma_f32_16x16x32_bf16 v[200:203], v[36:39], v[76:79], v[200:203]
    ds_read_b64_tr_b16 v[28:29], v2 offset:0
    ds_read_b64_tr_b16 v[30:31], v2 offset:1024
    s_waitcnt lgkmcnt(10)
    v_mfma_f32_16x16x32_bf16 v[188:191], v[44:47], v[52:55], v[188:191]
    ds_read_b64_tr_b16 v[32:33], v2 offset:8192
    v_mfma_f32_16x16x32_bf16 v[188:191], v[48:51], v[56:59], v[188:191]
    ds_read_b64_tr_b16 v[34:35], v2 offset:9216
    v_mfma_f32_16x16x32_bf16 v[192:195], v[48:51], v[64:67], v[192:195]
    ds_read_b64_tr_b16 v[36:37], v2 offset:16384
    v_mfma_f32_16x16x32_bf16 v[192:195], v[44:47], v[60:63], v[192:195]
    ds_read_b64_tr_b16 v[38:39], v2 offset:17408
    v_mfma_f32_16x16x32_bf16 v[204:207], v[44:47], v[68:71], v[204:207]
    ds_read_b64_tr_b16 v[40:41], v2 offset:24576
    v_mfma_f32_16x16x32_bf16 v[204:207], v[48:51], v[72:75], v[204:207]
    s_waitcnt lgkmcnt(10)
    ds_read_b64_tr_b16 v[42:43], v2 offset:25600
    v_mfma_f32_16x16x32_bf16 v[208:211], v[48:51], v[80:83], v[208:211]
    v_mfma_f32_16x16x32_bf16 v[208:211], v[44:47], v[76:79], v[208:211]
    s_waitcnt lgkmcnt(4)
    v_mfma_f32_16x16x32_bf16 v[116:119], v[28:31], v[84:87], v[116:119]
    ds_read_b64_tr_b16 v[44:45], v3 offset:0
    v_mfma_f32_16x16x32_bf16 v[116:119], v[32:35], v[88:91], v[116:119]
    ds_read_b64_tr_b16 v[46:47], v3 offset:1024
    v_mfma_f32_16x16x32_bf16 v[120:123], v[32:35], v[96:99], v[120:123]
    ds_read_b64_tr_b16 v[48:49], v3 offset:8192
    v_mfma_f32_16x16x32_bf16 v[120:123], v[28:31], v[92:95], v[120:123]
    ds_read_b64_tr_b16 v[50:51], v3 offset:9216
    v_mfma_f32_16x16x32_bf16 v[132:135], v[28:31], v[100:103], v[132:135]
    v_mfma_f32_16x16x32_bf16 v[132:135], v[32:35], v[104:107], v[132:135]
    v_mfma_f32_16x16x32_bf16 v[136:139], v[32:35], v[112:115], v[136:139]
    v_mfma_f32_16x16x32_bf16 v[136:139], v[28:31], v[108:111], v[136:139]
    s_waitcnt lgkmcnt(4)
    v_mfma_f32_16x16x32_bf16 v[124:127], v[36:39], v[84:87], v[124:127]
    ds_read_b64_tr_b16 v[28:29], v3 offset:16384
    v_mfma_f32_16x16x32_bf16 v[124:127], v[40:43], v[88:91], v[124:127]
    ds_read_b64_tr_b16 v[30:31], v3 offset:17408
    v_mfma_f32_16x16x32_bf16 v[128:131], v[40:43], v[96:99], v[128:131]
    ds_read_b64_tr_b16 v[32:33], v3 offset:24576
    v_mfma_f32_16x16x32_bf16 v[128:131], v[36:39], v[92:95], v[128:131]
    ds_read_b64_tr_b16 v[34:35], v3 offset:25600
    v_mfma_f32_16x16x32_bf16 v[140:143], v[36:39], v[100:103], v[140:143]
    v_mfma_f32_16x16x32_bf16 v[140:143], v[40:43], v[104:107], v[140:143]
    v_mfma_f32_16x16x32_bf16 v[144:147], v[40:43], v[112:115], v[144:147]
    v_mfma_f32_16x16x32_bf16 v[144:147], v[36:39], v[108:111], v[144:147]
    s_waitcnt lgkmcnt(4)
    v_mfma_f32_16x16x32_bf16 v[148:151], v[44:47], v[84:87], v[148:151]
    ds_read_b64_tr_b16 v[36:37], v4 offset:0
    v_mfma_f32_16x16x32_bf16 v[148:151], v[48:51], v[88:91], v[148:151]
    ds_read_b64_tr_b16 v[38:39], v4 offset:1024
    v_mfma_f32_16x16x32_bf16 v[152:155], v[48:51], v[96:99], v[152:155]
    ds_read_b64_tr_b16 v[40:41], v4 offset:8192
    v_mfma_f32_16x16x32_bf16 v[152:155], v[44:47], v[92:95], v[152:155]
    ds_read_b64_tr_b16 v[42:43], v4 offset:9216
    v_mfma_f32_16x16x32_bf16 v[164:167], v[44:47], v[100:103], v[164:167]
    v_mfma_f32_16x16x32_bf16 v[164:167], v[48:51], v[104:107], v[164:167]
    v_mfma_f32_16x16x32_bf16 v[168:171], v[48:51], v[112:115], v[168:171]
    v_mfma_f32_16x16x32_bf16 v[168:171], v[44:47], v[108:111], v[168:171]
    s_waitcnt lgkmcnt(4)
    v_mfma_f32_16x16x32_bf16 v[156:159], v[28:31], v[84:87], v[156:159]
    ds_read_b64_tr_b16 v[44:45], v4 offset:16384
    v_mfma_f32_16x16x32_bf16 v[156:159], v[32:35], v[88:91], v[156:159]
    ds_read_b64_tr_b16 v[46:47], v4 offset:17408
    v_mfma_f32_16x16x32_bf16 v[160:163], v[32:35], v[96:99], v[160:163]
    ds_read_b64_tr_b16 v[48:49], v4 offset:24576
    v_mfma_f32_16x16x32_bf16 v[160:163], v[28:31], v[92:95], v[160:163]
    ds_read_b64_tr_b16 v[50:51], v4 offset:25600
    v_mfma_f32_16x16x32_bf16 v[172:175], v[28:31], v[100:103], v[172:175]
    v_mfma_f32_16x16x32_bf16 v[172:175], v[32:35], v[104:107], v[172:175]
    v_mfma_f32_16x16x32_bf16 v[176:179], v[32:35], v[112:115], v[176:179]
    v_mfma_f32_16x16x32_bf16 v[176:179], v[28:31], v[108:111], v[176:179]
    s_waitcnt lgkmcnt(4)
    v_mfma_f32_16x16x32_bf16 v[180:183], v[36:39], v[84:87], v[180:183]
    v_mfma_f32_16x16x32_bf16 v[180:183], v[40:43], v[88:91], v[180:183]
    v_mfma_f32_16x16x32_bf16 v[184:187], v[40:43], v[96:99], v[184:187]
    v_mfma_f32_16x16x32_bf16 v[184:187], v[36:39], v[92:95], v[184:187]
    s_waitcnt lgkmcnt(0)
    s_barrier
    v_mfma_f32_16x16x32_bf16 v[196:199], v[36:39], v[100:103], v[196:199]
    v_mfma_f32_16x16x32_bf16 v[196:199], v[40:43], v[104:107], v[196:199]
    v_mfma_f32_16x16x32_bf16 v[200:203], v[40:43], v[112:115], v[200:203]
    v_mfma_f32_16x16x32_bf16 v[200:203], v[36:39], v[108:111], v[200:203]
    s_waitcnt lgkmcnt(0)
    v_mfma_f32_16x16x32_bf16 v[188:191], v[44:47], v[84:87], v[188:191]
    v_mfma_f32_16x16x32_bf16 v[188:191], v[48:51], v[88:91], v[188:191]
    v_mfma_f32_16x16x32_bf16 v[192:195], v[48:51], v[96:99], v[192:195]
    v_mfma_f32_16x16x32_bf16 v[192:195], v[44:47], v[92:95], v[192:195]
    v_mfma_f32_16x16x32_bf16 v[204:207], v[44:47], v[100:103], v[204:207]
    v_mfma_f32_16x16x32_bf16 v[204:207], v[48:51], v[104:107], v[204:207]
    v_mfma_f32_16x16x32_bf16 v[208:211], v[48:51], v[112:115], v[208:211]
    v_mfma_f32_16x16x32_bf16 v[208:211], v[44:47], v[108:111], v[208:211]
    s_nop 7
    v_pk_mul_f32 v[244:245], v[116:117], v[116:117]
    v_pk_mul_f32 v[246:247], v[118:119], v[118:119]
    v_pk_mul_f32 v[248:249], v[120:121], v[120:121]
    v_pk_mul_f32 v[250:251], v[122:123], v[122:123]
    v_pk_fma_f32 v[244:245], v[244:245], v[26:27], v[24:25]
    v_pk_fma_f32 v[246:247], v[246:247], v[26:27], v[24:25]
    v_pk_fma_f32 v[248:249], v[248:249], v[26:27], v[24:25]
    v_pk_fma_f32 v[250:251], v[250:251], v[26:27], v[24:25]
    v_pk_mul_f32 v[244:245], v[244:245], v[116:117]
    v_pk_mul_f32 v[246:247], v[246:247], v[118:119]
    v_pk_mul_f32 v[248:249], v[248:249], v[120:121]
    v_pk_mul_f32 v[250:251], v[250:251], v[122:123]
    v_exp_f32 v244, v244
    v_exp_f32 v245, v245
    v_exp_f32 v246, v246
    v_exp_f32 v247, v247
    v_exp_f32 v248, v248
    v_exp_f32 v249, v249
    v_exp_f32 v250, v250
    v_exp_f32 v251, v251
    v_pk_mul_f32 v[124:125], v[116:117], v[124:125]
    v_pk_mul_f32 v[126:127], v[118:119], v[126:127]
    v_pk_mul_f32 v[128:129], v[120:121], v[128:129]
    v_pk_mul_f32 v[130:131], v[122:123], v[130:131]
    v_pk_add_f32 v[244:245], v[244:245], 1.0 op_sel_hi:[1,0]
    v_pk_add_f32 v[246:247], v[246:247], 1.0 op_sel_hi:[1,0]
    v_pk_add_f32 v[248:249], v[248:249], 1.0 op_sel_hi:[1,0]
    v_pk_add_f32 v[250:251], v[250:251], 1.0 op_sel_hi:[1,0]
    v_rcp_f32 v244, v244
    v_rcp_f32 v245, v245
    v_rcp_f32 v246, v246
    v_rcp_f32 v247, v247
    v_rcp_f32 v248, v248
    v_rcp_f32 v249, v249
    v_rcp_f32 v250, v250
    v_rcp_f32 v251, v251
    v_pk_mul_f32 v[124:125], v[124:125], v[244:245]
    v_pk_mul_f32 v[126:127], v[126:127], v[246:247]
    v_pk_mul_f32 v[128:129], v[128:129], v[248:249]
    v_pk_mul_f32 v[130:131], v[130:131], v[250:251]
    v_cvt_pk_bf16_f32 v116, v124, v125
    v_cvt_pk_bf16_f32 v118, v128, v129
    v_cvt_pk_bf16_f32 v117, v126, v127
    v_cvt_pk_bf16_f32 v119, v130, v131
    v_permlane16_swap_b32 v116, v118
    s_nop 0
    v_permlane16_swap_b32 v117, v119
    buffer_store_dwordx4 v[116:119], v14, s[32:35], s42 offen offset:0 sc1
    v_pk_mul_f32 v[244:245], v[132:133], v[132:133]
    v_pk_mul_f32 v[246:247], v[134:135], v[134:135]
    v_pk_mul_f32 v[248:249], v[136:137], v[136:137]
    v_pk_mul_f32 v[250:251], v[138:139], v[138:139]
    v_pk_fma_f32 v[244:245], v[244:245], v[26:27], v[24:25]
    v_pk_fma_f32 v[246:247], v[246:247], v[26:27], v[24:25]
    v_pk_fma_f32 v[248:249], v[248:249], v[26:27], v[24:25]
    v_pk_fma_f32 v[250:251], v[250:251], v[26:27], v[24:25]
    v_pk_mul_f32 v[244:245], v[244:245], v[132:133]
    v_pk_mul_f32 v[246:247], v[246:247], v[134:135]
    v_pk_mul_f32 v[248:249], v[248:249], v[136:137]
    v_pk_mul_f32 v[250:251], v[250:251], v[138:139]
    v_exp_f32 v244, v244
    v_exp_f32 v245, v245
    v_exp_f32 v246, v246
    v_exp_f32 v247, v247
    v_exp_f32 v248, v248
    v_exp_f32 v249, v249
    v_exp_f32 v250, v250
    v_exp_f32 v251, v251
    v_pk_mul_f32 v[140:141], v[132:133], v[140:141]
    v_pk_mul_f32 v[142:143], v[134:135], v[142:143]
    v_pk_mul_f32 v[144:145], v[136:137], v[144:145]
    v_pk_mul_f32 v[146:147], v[138:139], v[146:147]
    v_pk_add_f32 v[244:245], v[244:245], 1.0 op_sel_hi:[1,0]
    v_pk_add_f32 v[246:247], v[246:247], 1.0 op_sel_hi:[1,0]
    v_pk_add_f32 v[248:249], v[248:249], 1.0 op_sel_hi:[1,0]
    v_pk_add_f32 v[250:251], v[250:251], 1.0 op_sel_hi:[1,0]
    v_rcp_f32 v244, v244
    v_rcp_f32 v245, v245
    v_rcp_f32 v246, v246
    v_rcp_f32 v247, v247
    v_rcp_f32 v248, v248
    v_rcp_f32 v249, v249
    v_rcp_f32 v250, v250
    v_rcp_f32 v251, v251
    v_pk_mul_f32 v[140:141], v[140:141], v[244:245]
    v_pk_mul_f32 v[142:143], v[142:143], v[246:247]
    v_pk_mul_f32 v[144:145], v[144:145], v[248:249]
    v_pk_mul_f32 v[146:147], v[146:147], v[250:251]
    v_cvt_pk_bf16_f32 v132, v140, v141
    v_cvt_pk_bf16_f32 v134, v144, v145
    v_cvt_pk_bf16_f32 v133, v142, v143
    v_cvt_pk_bf16_f32 v135, v146, v147
    v_permlane16_swap_b32 v132, v134
    s_nop 0
    v_permlane16_swap_b32 v133, v135
    buffer_store_dwordx4 v[132:135], v14, s[32:35], s43 offen offset:0 sc1
    v_pk_mul_f32 v[244:245], v[148:149], v[148:149]
    v_pk_mul_f32 v[246:247], v[150:151], v[150:151]
    v_pk_mul_f32 v[248:249], v[152:153], v[152:153]
    v_pk_mul_f32 v[250:251], v[154:155], v[154:155]
    v_pk_fma_f32 v[244:245], v[244:245], v[26:27], v[24:25]
    v_pk_fma_f32 v[246:247], v[246:247], v[26:27], v[24:25]
    v_pk_fma_f32 v[248:249], v[248:249], v[26:27], v[24:25]
    v_pk_fma_f32 v[250:251], v[250:251], v[26:27], v[24:25]
    v_pk_mul_f32 v[244:245], v[244:245], v[148:149]
    v_pk_mul_f32 v[246:247], v[246:247], v[150:151]
    v_pk_mul_f32 v[248:249], v[248:249], v[152:153]
    v_pk_mul_f32 v[250:251], v[250:251], v[154:155]
    v_exp_f32 v244, v244
    v_exp_f32 v245, v245
    v_exp_f32 v246, v246
    v_exp_f32 v247, v247
    v_exp_f32 v248, v248
    v_exp_f32 v249, v249
    v_exp_f32 v250, v250
    v_exp_f32 v251, v251
    v_pk_mul_f32 v[156:157], v[148:149], v[156:157]
    v_pk_mul_f32 v[158:159], v[150:151], v[158:159]
    v_pk_mul_f32 v[160:161], v[152:153], v[160:161]
    v_pk_mul_f32 v[162:163], v[154:155], v[162:163]
    v_pk_add_f32 v[244:245], v[244:245], 1.0 op_sel_hi:[1,0]
    v_pk_add_f32 v[246:247], v[246:247], 1.0 op_sel_hi:[1,0]
    v_pk_add_f32 v[248:249], v[248:249], 1.0 op_sel_hi:[1,0]
    v_pk_add_f32 v[250:251], v[250:251], 1.0 op_sel_hi:[1,0]
    v_rcp_f32 v244, v244
    v_rcp_f32 v245, v245
    v_rcp_f32 v246, v246
    v_rcp_f32 v247, v247
    v_rcp_f32 v248, v248
    v_rcp_f32 v249, v249
    v_rcp_f32 v250, v250
    v_rcp_f32 v251, v251
    v_pk_mul_f32 v[156:157], v[156:157], v[244:245]
    v_pk_mul_f32 v[158:159], v[158:159], v[246:247]
    v_pk_mul_f32 v[160:161], v[160:161], v[248:249]
    v_pk_mul_f32 v[162:163], v[162:163], v[250:251]
    v_cvt_pk_bf16_f32 v148, v156, v157
    v_cvt_pk_bf16_f32 v150, v160, v161
    v_cvt_pk_bf16_f32 v149, v158, v159
    v_cvt_pk_bf16_f32 v151, v162, v163
    v_permlane16_swap_b32 v148, v150
    s_nop 0
    v_permlane16_swap_b32 v149, v151
    buffer_store_dwordx4 v[148:151], v14, s[32:35], s42 offen offset:1024 sc1
    v_pk_mul_f32 v[244:245], v[164:165], v[164:165]
    v_pk_mul_f32 v[246:247], v[166:167], v[166:167]
    v_pk_mul_f32 v[248:249], v[168:169], v[168:169]
    v_pk_mul_f32 v[250:251], v[170:171], v[170:171]
    v_pk_fma_f32 v[244:245], v[244:245], v[26:27], v[24:25]
    v_pk_fma_f32 v[246:247], v[246:247], v[26:27], v[24:25]
    v_pk_fma_f32 v[248:249], v[248:249], v[26:27], v[24:25]
    v_pk_fma_f32 v[250:251], v[250:251], v[26:27], v[24:25]
    v_pk_mul_f32 v[244:245], v[244:245], v[164:165]
    v_pk_mul_f32 v[246:247], v[246:247], v[166:167]
    v_pk_mul_f32 v[248:249], v[248:249], v[168:169]
    v_pk_mul_f32 v[250:251], v[250:251], v[170:171]
    v_exp_f32 v244, v244
    v_exp_f32 v245, v245
    v_exp_f32 v246, v246
    v_exp_f32 v247, v247
    v_exp_f32 v248, v248
    v_exp_f32 v249, v249
    v_exp_f32 v250, v250
    v_exp_f32 v251, v251
    v_pk_mul_f32 v[172:173], v[164:165], v[172:173]
    v_pk_mul_f32 v[174:175], v[166:167], v[174:175]
    v_pk_mul_f32 v[176:177], v[168:169], v[176:177]
    v_pk_mul_f32 v[178:179], v[170:171], v[178:179]
    v_pk_add_f32 v[244:245], v[244:245], 1.0 op_sel_hi:[1,0]
    v_pk_add_f32 v[246:247], v[246:247], 1.0 op_sel_hi:[1,0]
    v_pk_add_f32 v[248:249], v[248:249], 1.0 op_sel_hi:[1,0]
    v_pk_add_f32 v[250:251], v[250:251], 1.0 op_sel_hi:[1,0]
    v_rcp_f32 v244, v244
    v_rcp_f32 v245, v245
    v_rcp_f32 v246, v246
    v_rcp_f32 v247, v247
    v_rcp_f32 v248, v248
    v_rcp_f32 v249, v249
    v_rcp_f32 v250, v250
    v_rcp_f32 v251, v251
    v_pk_mul_f32 v[172:173], v[172:173], v[244:245]
    v_pk_mul_f32 v[174:175], v[174:175], v[246:247]
    v_pk_mul_f32 v[176:177], v[176:177], v[248:249]
    v_pk_mul_f32 v[178:179], v[178:179], v[250:251]
    v_cvt_pk_bf16_f32 v164, v172, v173
    v_cvt_pk_bf16_f32 v166, v176, v177
    v_cvt_pk_bf16_f32 v165, v174, v175
    v_cvt_pk_bf16_f32 v167, v178, v179
    v_permlane16_swap_b32 v164, v166
    s_nop 0
    v_permlane16_swap_b32 v165, v167
    buffer_store_dwordx4 v[164:167], v14, s[32:35], s43 offen offset:1024 sc1
    v_pk_mul_f32 v[244:245], v[180:181], v[180:181]
    v_pk_mul_f32 v[246:247], v[182:183], v[182:183]
    v_pk_mul_f32 v[248:249], v[184:185], v[184:185]
    v_pk_mul_f32 v[250:251], v[186:187], v[186:187]
    v_pk_fma_f32 v[244:245], v[244:245], v[26:27], v[24:25]
    v_pk_fma_f32 v[246:247], v[246:247], v[26:27], v[24:25]
    v_pk_fma_f32 v[248:249], v[248:249], v[26:27], v[24:25]
    v_pk_fma_f32 v[250:251], v[250:251], v[26:27], v[24:25]
    v_pk_mul_f32 v[244:245], v[244:245], v[180:181]
    v_pk_mul_f32 v[246:247], v[246:247], v[182:183]
    v_pk_mul_f32 v[248:249], v[248:249], v[184:185]
    v_pk_mul_f32 v[250:251], v[250:251], v[186:187]
    v_exp_f32 v244, v244
    v_exp_f32 v245, v245
    v_exp_f32 v246, v246
    v_exp_f32 v247, v247
    v_exp_f32 v248, v248
    v_exp_f32 v249, v249
    v_exp_f32 v250, v250
    v_exp_f32 v251, v251
    v_pk_mul_f32 v[188:189], v[180:181], v[188:189]
    v_pk_mul_f32 v[190:191], v[182:183], v[190:191]
    v_pk_mul_f32 v[192:193], v[184:185], v[192:193]
    v_pk_mul_f32 v[194:195], v[186:187], v[194:195]
    v_pk_add_f32 v[244:245], v[244:245], 1.0 op_sel_hi:[1,0]
    v_pk_add_f32 v[246:247], v[246:247], 1.0 op_sel_hi:[1,0]
    v_pk_add_f32 v[248:249], v[248:249], 1.0 op_sel_hi:[1,0]
    v_pk_add_f32 v[250:251], v[250:251], 1.0 op_sel_hi:[1,0]
    v_rcp_f32 v244, v244
    v_rcp_f32 v245, v245
    v_rcp_f32 v246, v246
    v_rcp_f32 v247, v247
    v_rcp_f32 v248, v248
    v_rcp_f32 v249, v249
    v_rcp_f32 v250, v250
    v_rcp_f32 v251, v251
    v_pk_mul_f32 v[188:189], v[188:189], v[244:245]
    v_pk_mul_f32 v[190:191], v[190:191], v[246:247]
    v_pk_mul_f32 v[192:193], v[192:193], v[248:249]
    v_pk_mul_f32 v[194:195], v[194:195], v[250:251]
    v_cvt_pk_bf16_f32 v180, v188, v189
    v_cvt_pk_bf16_f32 v182, v192, v193
    v_cvt_pk_bf16_f32 v181, v190, v191
    v_cvt_pk_bf16_f32 v183, v194, v195
    v_permlane16_swap_b32 v180, v182
    s_nop 0
    v_permlane16_swap_b32 v181, v183
    buffer_store_dwordx4 v[180:183], v14, s[32:35], s42 offen offset:2048 sc1
    v_pk_mul_f32 v[244:245], v[196:197], v[196:197]
    v_pk_mul_f32 v[246:247], v[198:199], v[198:199]
    v_pk_mul_f32 v[248:249], v[200:201], v[200:201]
    v_pk_mul_f32 v[250:251], v[202:203], v[202:203]
    v_pk_fma_f32 v[244:245], v[244:245], v[26:27], v[24:25]
    v_pk_fma_f32 v[246:247], v[246:247], v[26:27], v[24:25]
    v_pk_fma_f32 v[248:249], v[248:249], v[26:27], v[24:25]
    v_pk_fma_f32 v[250:251], v[250:251], v[26:27], v[24:25]
    v_pk_mul_f32 v[244:245], v[244:245], v[196:197]
    v_pk_mul_f32 v[246:247], v[246:247], v[198:199]
    v_pk_mul_f32 v[248:249], v[248:249], v[200:201]
    v_pk_mul_f32 v[250:251], v[250:251], v[202:203]
    v_exp_f32 v244, v244
    v_exp_f32 v245, v245
    v_exp_f32 v246, v246
    v_exp_f32 v247, v247
    v_exp_f32 v248, v248
    v_exp_f32 v249, v249
    v_exp_f32 v250, v250
    v_exp_f32 v251, v251
    v_pk_mul_f32 v[204:205], v[196:197], v[204:205]
    v_pk_mul_f32 v[206:207], v[198:199], v[206:207]
    v_pk_mul_f32 v[208:209], v[200:201], v[208:209]
    v_pk_mul_f32 v[210:211], v[202:203], v[210:211]
    v_pk_add_f32 v[244:245], v[244:245], 1.0 op_sel_hi:[1,0]
    v_pk_add_f32 v[246:247], v[246:247], 1.0 op_sel_hi:[1,0]
    v_pk_add_f32 v[248:249], v[248:249], 1.0 op_sel_hi:[1,0]
    v_pk_add_f32 v[250:251], v[250:251], 1.0 op_sel_hi:[1,0]
    v_rcp_f32 v244, v244
    v_rcp_f32 v245, v245
    v_rcp_f32 v246, v246
    v_rcp_f32 v247, v247
    v_rcp_f32 v248, v248
    v_rcp_f32 v249, v249
    v_rcp_f32 v250, v250
    v_rcp_f32 v251, v251
    v_pk_mul_f32 v[204:205], v[204:205], v[244:245]
    v_pk_mul_f32 v[206:207], v[206:207], v[246:247]
    v_pk_mul_f32 v[208:209], v[208:209], v[248:249]
    v_pk_mul_f32 v[210:211], v[210:211], v[250:251]
    v_cvt_pk_bf16_f32 v196, v204, v205
    v_cvt_pk_bf16_f32 v198, v208, v209
    v_cvt_pk_bf16_f32 v197, v206, v207
    v_cvt_pk_bf16_f32 v199, v210, v211
    v_permlane16_swap_b32 v196, v198
    s_nop 0
    v_permlane16_swap_b32 v197, v199
    buffer_store_dwordx4 v[196:199], v14, s[32:35], s43 offen offset:2048 sc1
    s_branch L2C
L1C_idle:
    s_mov_b32 s65, 0
    s_mov_b32 s24, s76
    s_mov_b32 s25, s77
    s_mov_b32 s26, 0x100
    s_mov_b32 s27, 0x20000
    v_mov_b32 v21, 0
    s_cmp_lg_u32 s55, 4
    s_cbranch_scc1 L1_noinit
    s_add_u32 s36, s78, 0x800000
    s_addc_u32 s37, s79, 0
    s_mov_b32 s38, 0x8000
    s_mov_b32 s39, 0x20000
    v_mov_b32 v32, 0
    v_mov_b32 v33, 0
    v_mov_b32 v34, 0
    v_mov_b32 v35, 0
    v_lshlrev_b32 v20, 4, v1
    s_and_b32 s42, s2, 7
    s_lshl_b32 s42, s42, 2
    s_add_u32 s42, s42, s45
    s_mul_i32 s42, s42, 1024
    buffer_store_dwordx4 v[32:35], v20, s[36:39], s42 offen sc1
    v_mov_b32 v22, 1
L1_noinit:
    s_waitcnt vmcnt(0)
    s_cmp_lg_u32 s55, 4
    s_cbranch_scc1 L1_noinit2
    s_mov_b64 exec, 1
    buffer_atomic_add v22, v21, s[24:27], 0 offen sc1
    s_mov_b64 exec, -1
L1_noinit2:
    s_barrier
    s_barrier
    s_cmp_lg_u32 s45, 0
    s_cbranch_scc1 L2C
L1C_idle_go:
    buffer_load_dword v22, v21, s[24:27], 0 offen sc1
    s_waitcnt vmcnt(0)
    v_cmp_gt_u32 vcc, 32, v22
    s_cbranch_vccz L2C
    s_sleep 8
    s_branch L1C_idle_go
L_exit:
    s_endpgm
.section .rodata,"a"
.p2align 6
.amdhsa_kernel gated_mix__spectral_fnet__geglu_ffn__prompt_kernel
  .amdhsa_next_free_vgpr 256
  .amdhsa_next_free_sgpr 102
  .amdhsa_accum_offset 256
  .amdhsa_group_segment_fixed_size 0
  .amdhsa_kernarg_size 104
  .amdhsa_user_sgpr_count 2
  .amdhsa_user_sgpr_kernarg_segment_ptr 1
  .amdhsa_system_sgpr_workgroup_id_x 1
.end_amdhsa_kernel
```
